```python
import torch

def _softmax(x, axis=-1):
    return torch.softmax(x, dim=axis)

def _gelu(x):
    return torch.nn.functional.gelu(x, approximate='tanh')

def _silu(x):
    return torch.nn.functional.silu(x)

def _sigmoid(x):
    return torch.sigmoid(x)

def _layernorm(x, axis=-1, eps=1e-05):
    m = x.mean(dim=axis, keepdim=True)
    v = x.var(dim=axis, keepdim=True, unbiased=False)
    return (x - m) / torch.sqrt(v + eps)

def _scatter_add(tgt, idx, src, axis=0):
    return tgt.clone().index_add_(axis, idx, src)

def _segment_sum(src, seg, n):
    out = torch.zeros((n,) + src.shape[1:], dtype=src.dtype)
    return out.index_add_(0, seg, src)

def _pad(x, pw):
    flat = tuple((v for pair in reversed(pw) for v in pair))
    return torch.nn.functional.pad(x, flat)
kernel_name = 'adaLN_cond__sliding_block__swiglu_ffn__prompt'

def setup_inputs():

    _w = lambda a: (lambda t: t.to(torch.bfloat16) if t.is_floating_point() else t)(torch.as_tensor(a))

    def _A_setup():
        B, S, D = (1, 2048, 640)
        return {'x': _w((lambda *s: torch.randn(*s, dtype=torch.bfloat16) * 0.05)(B, S, D)), 'wqkv': _w((lambda *s: torch.randn(*s, dtype=torch.bfloat16) * 0.05)(D, 3 * D)), 'wo': _w((lambda *s: torch.randn(*s, dtype=torch.bfloat16) * 0.05)(D, D))}
    _A_in = _A_setup()

    def _B_setup():
        B, S, D, F = (1, 2048, 640, 1728)
        return {'x': _w((lambda *s: torch.randn(*s, dtype=torch.bfloat16) * 0.05)(B, S, D)), 'w_gate': _w((lambda *s: torch.randn(*s, dtype=torch.bfloat16) * 0.05)(D, F)), 'w_up': _w((lambda *s: torch.randn(*s, dtype=torch.bfloat16) * 0.05)(D, F)), 'w_down': _w((lambda *s: torch.randn(*s, dtype=torch.bfloat16) * 0.05)(F, D))}
    _B_in = _B_setup()
    return {'A_x': _A_in['x'], 'A_wqkv': _A_in['wqkv'], 'A_wo': _A_in['wo'], 'B_x': _B_in['x'], 'B_w_gate': _B_in['w_gate'], 'B_w_up': _B_in['w_up'], 'B_w_down': _B_in['w_down'], 'c': _w((lambda *s: torch.randn(*s, dtype=torch.bfloat16) * 0.1)(1, 640) * 8.0), 'w_mod': _w((lambda *s: torch.randn(*s, dtype=torch.bfloat16) * 0.1)(640, 6 * 640) * 640 ** (-0.5) * 8.0)}

def reference(A_x, A_wqkv, A_wo, B_x, B_w_gate, B_w_up, B_w_down, c, w_mod):

    def _A_ref(x, wqkv, wo):
        B, S, D = x.shape
        H = 32
        Dh = D // H
        W = 256
        qkv = (lambda x, *d: x.permute(*d))((x @ wqkv).reshape(B, S, 3, H, Dh), 2, 0, 3, 1, 4)
        q, k, v = (qkv[0], qkv[1], qkv[2])
        scores = torch.einsum('bhqd,bhkd->bhqk', q, k) * Dh ** (-0.5)
        idx = torch.arange(S)
        mask = (idx[:, None] - idx[None, :] >= 0) & (idx[:, None] - idx[None, :] < W)
        scores = torch.where(mask[None, None], scores, -1000000000.0)
        p = _softmax(scores, axis=-1)
        o = torch.einsum('bhqk,bhkd->bhqd', p, v)
        return (lambda x, *d: x.permute(*d))(o, 0, 2, 1, 3).reshape(B, S, D) @ wo

    def _B_ref(x, w_gate, w_up, w_down):
        g = _silu(x @ w_gate)
        u = x @ w_up
        return g * u @ w_down
    x = A_x
    mod = (_silu(c) @ w_mod).reshape(c.shape[0], 6, 1, -1)
    sa, ca, ga, sb, cb, gb = (mod[:, 0].clone(), mod[:, 1].clone(), mod[:, 2].clone(), mod[:, 3].clone(), mod[:, 4].clone(), mod[:, 5].clone())
    h = _layernorm(x, axis=-1) * (1 + ca) + sa
    x = x + ga * _A_ref(h, A_wqkv, A_wo)
    h = _layernorm(x, axis=-1) * (1 + cb) + sb
    x = x + gb * _B_ref(h, B_w_gate, B_w_up, B_w_down)
    return x
```

```asm
; @launch grid=(256,1,1) block=(512,1,1) lds=163840
.amdgcn_target "amdgcn-amd-amdhsa--gfx950"
.text
.p2align 8
.globl adaLN_cond__sliding_block__swiglu_ffn__prompt_kernel
.type adaLN_cond__sliding_block__swiglu_ffn__prompt_kernel,@function
adaLN_cond__sliding_block__swiglu_ffn__prompt_kernel:
    s_cmp_ge_u32 s2, 256
    s_cbranch_scc1 adaLN_cond__sliding_block__swiglu_ffn__prompt_kernel_end_1
    s_load_dwordx16 s[4:19], s[0:1], 0
    s_load_dwordx8 s[20:27], s[0:1], 64
    v_lshrrev_b32 v1, 6, v0
    v_and_b32 v0, 63, v0
    v_readfirstlane_b32 s3, v1
    v_lshlrev_b32 v2, 2, v0
    v_add_u32 v2, 162816, v2
    v_mov_b32 v3, 0
    ds_write_b32 v2, v3
    s_mov_b32 s101, 0
    s_and_b32 s40, s2, 24
    s_cmp_eq_u32 s40, 0
    s_cbranch_scc1 adaLN_cond__sliding_block__swiglu_ffn__prompt_kernel_nh_2
    s_mov_b32 s101, 1
    s_mov_b64 exec, 0
    s_cmp_eq_u32 s3, 0
    s_cbranch_scc1 hop_pad_0
    s_cmp_eq_u32 s3, 1
    s_cbranch_scc1 hop_pad_1
    s_cmp_eq_u32 s3, 2
    s_cbranch_scc1 hop_pad_2
    s_cmp_eq_u32 s3, 3
    s_cbranch_scc1 hop_pad_3
    s_cmp_eq_u32 s3, 4
    s_cbranch_scc1 hop_pad_4
    s_cmp_eq_u32 s3, 5
    s_cbranch_scc1 hop_pad_5
    s_cmp_eq_u32 s3, 6
    s_cbranch_scc1 hop_pad_6
    s_cmp_eq_u32 s3, 7
    s_cbranch_scc1 hop_pad_7
hop_ret_1:
    s_mov_b64 exec, -1
    s_mov_b32 s101, 0
    s_branch adaLN_cond__sliding_block__swiglu_ffn__prompt_kernel_nh_2
hop_back:
    s_cmp_eq_u32 s101, 1
    s_cbranch_scc1 hop_ret_1
    s_cmp_eq_u32 s101, 2
    s_cbranch_scc1 hop_ret_2
    s_cmp_eq_u32 s101, 3
    s_cbranch_scc1 hop_ret_3
    s_cmp_eq_u32 s101, 4
    s_cbranch_scc1 hop_ret_4
    s_cmp_eq_u32 s101, 5
    s_cbranch_scc1 hop_ret_5
    s_endpgm
adaLN_cond__sliding_block__swiglu_ffn__prompt_kernel_nh_2:
    s_and_b32 s40, s2, 7
    s_lshr_b32 s41, s2, 3
    s_lshr_b32 s42, s40, 2
    s_lshl_b32 s42, s42, 3
    s_and_b32 s43, s41, 7
    s_add_u32 s60, s42, s43
    s_and_b32 s42, s40, 3
    s_lshl_b32 s42, s42, 2
    s_lshr_b32 s43, s41, 3
    s_add_u32 s61, s42, s43
    s_and_b32 s66, s3, 3
    s_waitcnt lgkmcnt(0)
    s_load_dwordx2 s[64:65], s[26:27], 0xc0000
    s_mov_b32 s28, s26
    s_and_b32 s29, s27, 0xffff
    s_mov_b32 s30, 0x2600000
    s_mov_b32 s31, 0x20000
    s_mov_b64 s[10:11], 1
    s_mov_b32 s24, s60
    s_and_b32 s40, s60, 3
    s_cmp_ge_u32 s40, 2
    s_cbranch_scc1 adaLN_cond__sliding_block__swiglu_ffn__prompt_kernel_n0_7
    s_cmp_eq_u32 s40, 1
    s_cbranch_scc1 adaLN_cond__sliding_block__swiglu_ffn__prompt_kernel_h1_9
    s_lshl_b32 s52, s60, 2
    s_add_u32 s52, s52, s61
    s_mov_b32 s32, s20
    s_and_b32 s33, s21, 0xffff
    s_mov_b32 s34, 0x4b0000
    s_mov_b32 s35, 0x20000
    s_mov_b32 s36, s18
    s_and_b32 s37, s19, 0xffff
    s_mov_b32 s38, 0x500
    s_mov_b32 s39, 0x20000
    s_mul_hi_u32 s50, s52, 0xccccccd
    s_mul_i32 s42, s50, 20
    s_sub_u32 s51, s52, s42
    s_mul_i32 s42, s50, 192
    s_add_u32 s43, s42, 64
    s_cmp_eq_u32 s50, 0
    s_cselect_b32 s42, 0, s43
    s_cselect_b32 s46, 0, 0x40000000
    s_lshl_b32 s43, s3, 3
    s_add_u32 s42, s42, s43
    v_and_b32 v1, 7, v0
    v_lshrrev_b32 v2, 3, v0
    v_add_u32 v4, s42, v2
    v_mul_u32_u24 v5, 7680, v4
    v_lshl_add_u32 v5, v1, 4, v5
    v_lshlrev_b32 v4, 1, v4
    s_lshl_b32 s44, s51, 7
    buffer_load_dwordx4 v[16:19], v5, s[32:35], s44 offen nt
    s_add_u32 s44, s44, 491520
    buffer_load_ushort v8, v4, s[36:39], 0 offen offset:0
    buffer_load_ushort v9, v4, s[36:39], 0 offen offset:128
    buffer_load_ushort v10, v4, s[36:39], 0 offen offset:256
    buffer_load_ushort v11, v4, s[36:39], s46 offen offset:384
    buffer_load_dwordx4 v[20:23], v5, s[32:35], s44 offen nt
    s_add_u32 s44, s44, 491520
    buffer_load_dwordx4 v[24:27], v5, s[32:35], s44 offen nt
    s_add_u32 s44, s44, 491520
    s_add_u32 s44, s44, s46
    buffer_load_dwordx4 v[28:31], v5, s[32:35], s44 offen nt
    s_barrier
    s_cmp_lt_u32 s52, 60
    s_cbranch_scc1 adaLN_cond__sliding_block__swiglu_ffn__prompt_kernel_ni_11
    s_waitcnt lgkmcnt(0)
    s_add_u32 s64, s64, 0x9E3779B1
    s_add_u32 s65, s65, 0x85EBCA77
    s_lshl_b32 s42, s3, 6
    v_add_u32 v6, s42, v0
    v_lshlrev_b32 v6, 7, v6
    s_mov_b32 s42, 790528
    s_cmp_lt_u32 s3, 4
    s_cselect_b32 s42, s42, 0x40000000
    s_cmp_eq_u32 s52, 60
    s_cselect_b32 s42, s42, 0x40000000
    v_mov_b32 v12, s64
    v_mov_b32 v13, s65
    buffer_store_dwordx2 v[12:13], v6, s[28:31], s42 offen sc1
    s_lshl_b32 s42, s3, 12
    s_add_u32 s42, s42, 131072
    s_cmp_eq_u32 s52, 61
    s_cselect_b32 s42, s42, 0x40000000
    v_lshlrev_b32 v6, 4, v0
    v_mov_b32 v52, 0
    v_mov_b32 v53, 0
    v_mov_b32 v54, 0
    v_mov_b32 v55, 0
    buffer_store_dwordx4 v[52:55], v6, s[28:31], s42 offen offset:0 sc1
    buffer_store_dwordx4 v[52:55], v6, s[28:31], s42 offen offset:1024 sc1
    buffer_store_dwordx4 v[52:55], v6, s[28:31], s42 offen offset:2048 sc1
    buffer_store_dwordx4 v[52:55], v6, s[28:31], s42 offen offset:3072 sc1
    s_waitcnt vmcnt(0)
    s_branch adaLN_cond__sliding_block__swiglu_ffn__prompt_kernel_in_12
adaLN_cond__sliding_block__swiglu_ffn__prompt_kernel_ni_11:
    s_waitcnt vmcnt(3)
    v_lshlrev_b32 v8, 16, v8
    v_mul_f32 v40, 0xbfb8aa3b, v8
    v_lshlrev_b32 v9, 16, v9
    v_mul_f32 v41, 0xbfb8aa3b, v9
    v_lshlrev_b32 v10, 16, v10
    v_mul_f32 v42, 0xbfb8aa3b, v10
    v_lshlrev_b32 v11, 16, v11
    v_mul_f32 v43, 0xbfb8aa3b, v11
    v_exp_f32 v40, v40
    v_exp_f32 v41, v41
    v_exp_f32 v42, v42
    v_exp_f32 v43, v43
    v_add_f32 v40, 1.0, v40
    v_add_f32 v41, 1.0, v41
    v_add_f32 v42, 1.0, v42
    v_add_f32 v43, 1.0, v43
    v_rcp_f32 v40, v40
    v_rcp_f32 v41, v41
    v_rcp_f32 v42, v42
    v_rcp_f32 v43, v43
    v_mul_f32 v8, v40, v8
    v_mul_f32 v9, v41, v9
    v_mul_f32 v10, v42, v10
    v_mul_f32 v11, v43, v11
    v_cvt_pk_bf16_f32 v8, v8, v8
    v_lshlrev_b32 v8, 16, v8
    v_cvt_pk_bf16_f32 v9, v9, v9
    v_lshlrev_b32 v9, 16, v9
    v_cvt_pk_bf16_f32 v10, v10, v10
    v_lshlrev_b32 v10, 16, v10
    v_cvt_pk_bf16_f32 v11, v11, v11
    v_lshlrev_b32 v11, 16, v11
    v_lshlrev_b32 v48, 16, v16
    v_and_b32 v49, 0xffff0000, v16
    v_mul_f32 v40, v48, v8
    v_mul_f32 v41, v49, v8
    v_lshlrev_b32 v48, 16, v17
    v_and_b32 v49, 0xffff0000, v17
    v_mul_f32 v42, v48, v8
    v_mul_f32 v43, v49, v8
    v_lshlrev_b32 v48, 16, v18
    v_and_b32 v49, 0xffff0000, v18
    v_mul_f32 v44, v48, v8
    v_mul_f32 v45, v49, v8
    v_lshlrev_b32 v48, 16, v19
    v_and_b32 v49, 0xffff0000, v19
    v_mul_f32 v46, v48, v8
    v_mul_f32 v47, v49, v8
    s_waitcnt vmcnt(2)
    v_lshlrev_b32 v48, 16, v20
    v_and_b32 v49, 0xffff0000, v20
    v_fmac_f32 v40, v48, v9
    v_fmac_f32 v41, v49, v9
    v_lshlrev_b32 v48, 16, v21
    v_and_b32 v49, 0xffff0000, v21
    v_fmac_f32 v42, v48, v9
    v_fmac_f32 v43, v49, v9
    v_lshlrev_b32 v48, 16, v22
    v_and_b32 v49, 0xffff0000, v22
    v_fmac_f32 v44, v48, v9
    v_fmac_f32 v45, v49, v9
    v_lshlrev_b32 v48, 16, v23
    v_and_b32 v49, 0xffff0000, v23
    v_fmac_f32 v46, v48, v9
    v_fmac_f32 v47, v49, v9
    s_waitcnt vmcnt(1)
    v_lshlrev_b32 v48, 16, v24
    v_and_b32 v49, 0xffff0000, v24
    v_fmac_f32 v40, v48, v10
    v_fmac_f32 v41, v49, v10
    v_lshlrev_b32 v48, 16, v25
    v_and_b32 v49, 0xffff0000, v25
    v_fmac_f32 v42, v48, v10
    v_fmac_f32 v43, v49, v10
    v_lshlrev_b32 v48, 16, v26
    v_and_b32 v49, 0xffff0000, v26
    v_fmac_f32 v44, v48, v10
    v_fmac_f32 v45, v49, v10
    v_lshlrev_b32 v48, 16, v27
    v_and_b32 v49, 0xffff0000, v27
    v_fmac_f32 v46, v48, v10
    v_fmac_f32 v47, v49, v10
    s_waitcnt vmcnt(0)
    v_lshlrev_b32 v48, 16, v28
    v_and_b32 v49, 0xffff0000, v28
    v_fmac_f32 v40, v48, v11
    v_fmac_f32 v41, v49, v11
    v_lshlrev_b32 v48, 16, v29
    v_and_b32 v49, 0xffff0000, v29
    v_fmac_f32 v42, v48, v11
    v_fmac_f32 v43, v49, v11
    v_lshlrev_b32 v48, 16, v30
    v_and_b32 v49, 0xffff0000, v30
    v_fmac_f32 v44, v48, v11
    v_fmac_f32 v45, v49, v11
    v_lshlrev_b32 v48, 16, v31
    v_and_b32 v49, 0xffff0000, v31
    v_fmac_f32 v46, v48, v11
    v_fmac_f32 v47, v49, v11
    v_permlane32_swap_b32 v40, v44
    v_permlane32_swap_b32 v41, v45
    v_permlane32_swap_b32 v42, v46
    v_permlane32_swap_b32 v43, v47
    v_add_f32 v40, v40, v44
    v_add_f32 v41, v41, v45
    v_add_f32 v42, v42, v46
    v_add_f32 v43, v43, v47
    s_nop 0
    v_permlane16_swap_b32 v40, v42
    v_permlane16_swap_b32 v41, v43
    v_add_f32 v40, v40, v42
    v_add_f32 v41, v41, v43
    s_nop 0
    v_add_f32_dpp v40, v40, v40 row_ror:8 row_mask:0xf bank_mask:0xf
    v_add_f32_dpp v41, v41, v41 row_ror:8 row_mask:0xf bank_mask:0xf
    v_lshrrev_b32 v48, 4, v0
    v_lshlrev_b32 v48, 3, v48
    v_and_b32 v49, 7, v0
    v_lshl_add_u32 v48, v49, 5, v48
    s_lshl_b32 s45, s3, 8
    s_add_u32 s45, s45, 152576
    v_add_u32 v48, s45, v48
    ds_write_b64 v48, v[40:41]
    s_waitcnt lgkmcnt(0)
    s_waitcnt lgkmcnt(0)
    s_add_u32 s64, s64, 0x9E3779B1
    s_add_u32 s65, s65, 0x85EBCA77
adaLN_cond__sliding_block__swiglu_ffn__prompt_kernel_in_12:
    v_mov_b32 v250, 162816
    v_mov_b32 v251, 1
    s_mov_b64 exec, 1
    ds_add_rtn_u32 v251, v250, v251
    s_mov_b64 exec, -1
    s_waitcnt lgkmcnt(0)
    v_readfirstlane_b32 s56, v251
    s_nop 0
    s_cmp_lg_u32 s56, 7
    s_cbranch_scc1 adaLN_cond__sliding_block__swiglu_ffn__prompt_kernel_nomod_13
    v_and_b32 v48, 15, v0
    v_lshlrev_b32 v48, 4, v48
    v_lshrrev_b32 v49, 4, v0
    v_lshl_add_u32 v49, v49, 9, v48
    v_add_u32 v49, 152576, v49
    ds_read_b128 v[16:19], v49 offset:0
    ds_read_b128 v[20:23], v49 offset:256
    s_lshl_b32 s42, s52, 8
    s_add_u32 s42, s42, 393216
    s_movk_i32 s43, 0xff
    s_lshr_b32 s44, s64, 0
    v_mov_b32 v24, s44
    s_lshr_b32 s44, s64, 8
    v_mov_b32 v25, s44
    s_lshr_b32 s44, s64, 16
    v_mov_b32 v26, s44
    s_lshr_b32 s44, s64, 24
    v_mov_b32 v27, s44
    s_waitcnt lgkmcnt(0)
    v_pk_add_f32 v[16:17], v[16:17], v[20:21]
    v_pk_add_f32 v[18:19], v[18:19], v[22:23]
    v_mov_b32 v20, v16
    v_mov_b32 v21, v17
    v_mov_b32 v22, v18
    v_mov_b32 v23, v19
    v_permlane16_swap_b32 v16, v20
    v_permlane16_swap_b32 v17, v21
    v_permlane16_swap_b32 v18, v22
    v_permlane16_swap_b32 v19, v23
    v_pk_add_f32 v[16:17], v[16:17], v[20:21]
    v_pk_add_f32 v[18:19], v[18:19], v[22:23]
    v_mov_b32 v20, v16
    v_mov_b32 v21, v17
    v_mov_b32 v22, v18
    v_mov_b32 v23, v19
    v_permlane32_swap_b32 v16, v20
    v_permlane32_swap_b32 v17, v21
    v_permlane32_swap_b32 v18, v22
    v_permlane32_swap_b32 v19, v23
    v_pk_add_f32 v[16:17], v[16:17], v[20:21]
    v_pk_add_f32 v[18:19], v[18:19], v[22:23]
    v_bfi_b32 v16, s43, v24, v16
    v_bfi_b32 v17, s43, v25, v17
    v_bfi_b32 v18, s43, v26, v18
    v_bfi_b32 v19, s43, v27, v19
    s_mov_b64 exec, 0xffff
    buffer_store_dwordx4 v[16:19], v48, s[28:31], s42 offen sc1
    s_mov_b64 exec, -1
adaLN_cond__sliding_block__swiglu_ffn__prompt_kernel_nomod_13:
    s_barrier
    s_mov_b32 s101, 2
    s_mov_b64 exec, 0
    s_cmp_eq_u32 s3, 0
    s_cbranch_scc1 hop_pad_0
    s_cmp_eq_u32 s3, 1
    s_cbranch_scc1 hop_pad_1
    s_cmp_eq_u32 s3, 2
    s_cbranch_scc1 hop_pad_2
    s_cmp_eq_u32 s3, 3
    s_cbranch_scc1 hop_pad_3
    s_cmp_eq_u32 s3, 4
    s_cbranch_scc1 hop_pad_4
    s_cmp_eq_u32 s3, 5
    s_cbranch_scc1 hop_pad_5
    s_cmp_eq_u32 s3, 6
    s_cbranch_scc1 hop_pad_6
    s_cmp_eq_u32 s3, 7
    s_cbranch_scc1 hop_pad_7
hop_ret_2:
    s_mov_b64 exec, -1
    s_mov_b32 s101, 0
    s_branch adaLN_cond__sliding_block__swiglu_ffn__prompt_kernel_p1_3
adaLN_cond__sliding_block__swiglu_ffn__prompt_kernel_n0_7:
    s_cmp_lg_u32 s3, 3
    s_cbranch_scc1 adaLN_cond__sliding_block__swiglu_ffn__prompt_kernel_nt_14
    s_getpc_b64 s[42:43]
adaLN_cond__sliding_block__swiglu_ffn__prompt_kernel_pc_15:
    s_sub_u32 s42, s42, adaLN_cond__sliding_block__swiglu_ffn__prompt_kernel_pc_15-adaLN_cond__sliding_block__swiglu_ffn__prompt_kernel
    s_subb_u32 s43, s43, 0
    s_lshr_b32 s41, s2, 5
    s_lshl_b32 s41, s41, 13
    v_lshlrev_b32 v2, 7, v0
    v_add_u32 v2, s41, v2
    v_min_u32 v2, adaLN_cond__sliding_block__swiglu_ffn__prompt_kernel_end_1-adaLN_cond__sliding_block__swiglu_ffn__prompt_kernel, v2
    global_load_dword v241, v2, s[42:43]
    v_lshlrev_b32 v2, 20, v0
    buffer_load_dword v241, v2, s[28:31], 0 offen
    s_mov_b32 s32, s22
    s_and_b32 s33, s23, 0xffff
    s_mov_b32 s34, 0x280000
    s_mov_b32 s35, 0x20000
    buffer_load_dword v241, v2, s[32:35], 0 offen
adaLN_cond__sliding_block__swiglu_ffn__prompt_kernel_nt_14:
    s_barrier
    s_cmp_lt_u32 s3, 4
    s_cbranch_scc1 adaLN_cond__sliding_block__swiglu_ffn__prompt_kernel_nf_8
    s_cmp_lt_u32 s61, 15
    s_cbranch_scc1 adaLN_cond__sliding_block__swiglu_ffn__prompt_kernel_ld1_4
adaLN_cond__sliding_block__swiglu_ffn__prompt_kernel_nf_8:
    s_waitcnt lgkmcnt(0)
    s_add_u32 s64, s64, 0x9E3779B1
    s_add_u32 s65, s65, 0x85EBCA77
    s_branch adaLN_cond__sliding_block__swiglu_ffn__prompt_kernel_p1_3
.p2align 12
adaLN_cond__sliding_block__swiglu_ffn__prompt_kernel_h1_9:
hop_pad_0:
    s_cbranch_execz hop_back
    s_lshr_b32 s52, s60, 2
    s_lshl_b32 s52, s52, 4
    s_add_u32 s52, s52, s61
    s_mov_b32 s32, s4
    s_and_b32 s33, s5, 0xffff
    s_mov_b32 s34, 0x280000
    s_mov_b32 s35, 0x20000
    v_and_b32 v1, 7, v0
    v_lshrrev_b32 v2, 3, v0
    v_mul_u32_u24 v3, 1280, v2
    v_lshl_add_u32 v3, v1, 4, v3
    s_lshr_b32 s53, s3, 1
    s_and_b32 s54, s3, 1
    s_lshl_b32 s40, s52, 2
    s_add_u32 s40, s40, s53
    s_mul_i32 s40, s40, 10240
    s_mul_i32 s41, s54, 640
    s_add_u32 s40, s40, s41
    s_mul_i32 s41, s3, 5120
    s_add_u32 s41, s41, 98304
    s_add_u32 m0, s41, 0
    s_nop 0
    buffer_load_dwordx4 v3, s[32:35], s40 offen nt lds
    s_add_u32 s40, s40, 128
    s_add_u32 m0, s41, 1024
    s_nop 0
    buffer_load_dwordx4 v3, s[32:35], s40 offen nt lds
    s_add_u32 s40, s40, 128
    s_add_u32 m0, s41, 2048
    s_nop 0
    buffer_load_dwordx4 v3, s[32:35], s40 offen nt lds
    s_add_u32 s40, s40, 128
    s_add_u32 m0, s41, 3072
    s_nop 0
    buffer_load_dwordx4 v3, s[32:35], s40 offen nt lds
    s_add_u32 s40, s40, 128
    s_add_u32 m0, s41, 4096
    s_nop 0
    buffer_load_dwordx4 v3, s[32:35], s40 offen nt lds
    s_lshr_b32 s50, s3, 2
    s_add_u32 s50, s50, 8
    v_mov_b32 v4, s3
    v_mov_b32 v5, s50
    v_cmp_le_u32 vcc, 32, v0
    s_nop 1
    v_cndmask_b32 v4, v4, v5, vcc
    v_bfe_u32 v5, v0, 4, 1
    v_mad_u32_u24 v4, v5, 10, v4
    v_cvt_f32_u32 v14, v5
    v_and_b32 v5, 15, v0
    v_lshlrev_b32 v5, 4, v5
    v_lshl_add_u32 v4, v4, 8, v5
    s_lshl_b32 s49, s3, 10
    s_add_u32 s49, s49, 147456
    v_lshlrev_b32 v5, 4, v0
    v_add_u32 v5, s49, v5
    v_lshlrev_b32 v7, 5, v2
    v_add_u32 v7, s49, v7
    v_lshlrev_b32 v15, 9, v2
    v_lshl_add_u32 v15, v1, 4, v15
    s_mul_i32 s48, s52, 40960
    s_add_u32 s48, s48, 35651584
    s_lshl_b32 s49, s3, 12
    s_add_u32 s49, s49, s48
    s_lshl_b32 s51, s50, 12
    s_add_u32 s51, s51, s48
    s_lshl_b32 s48, s66, 7
    s_add_u32 s51, s51, s48
    v_lshrrev_b32 v94, 5, v0
    v_lshlrev_b32 v94, 8, v94
    v_lshlrev_b32 v92, 4, v1
    v_add_u32 v92, 155648, v92
    s_lshl_b32 s48, s53, 4
    s_add_u32 s48, s48, s54
    s_lshl_b32 s48, s48, 3
    v_add_u32 v91, s48, v92
    s_lshl_b32 s48, s66, 7
    v_add_u32 v90, s48, v92
    v_lshlrev_b32 v89, 7, v1
    v_lshl_add_u32 v89, v2, 4, v89
    v_add_u32 v89, 98304, v89
    s_mul_i32 s48, s66, 10
    s_add_u32 s48, s48, s50
    s_lshl_b32 s48, s48, 10
    v_add_u32 v88, s48, v89
    s_lshl_b32 s48, s3, 10
    v_add_u32 v89, s48, v89
    s_mov_b32 s36, s6
    s_and_b32 s37, s7, 0xffff
    s_mov_b32 s38, 0x258000
    s_mov_b32 s39, 0x20000
    v_lshrrev_b32 v200, 4, v0
    v_and_b32 v201, 15, v0
    v_lshlrev_b32 v202, 2, v200
    v_xor_b32 v201, v201, v202
    v_mul_u32_u24 v200, 3840, v200
    v_lshl_add_u32 v200, v201, 4, v200
    s_mul_i32 s68, s66, 61440
    s_lshl_b32 s69, s61, 8
    s_add_u32 s68, s68, s69
    s_lshl_b32 s69, s66, 12
    v_lshlrev_b32 v13, 7, v1
    v_lshl_add_u32 v13, v2, 4, v13
    v_add_u32 v13, s41, v13
    s_mov_b32 s55, 0x3f803f80
    v_mov_b32 v8, 0
    v_mov_b32 v9, 0
    v_mov_b32 v10, 0
    v_mov_b32 v11, 0
    s_waitcnt lgkmcnt(0)
    s_add_u32 s64, s64, 0x9E3779B1
    s_add_u32 s65, s65, 0x85EBCA77
    s_waitcnt vmcnt(4)
    ds_read_b128 v[96:99], v13 offset:0
    s_waitcnt vmcnt(3)
    ds_read_b128 v[100:103], v13 offset:1024
    s_waitcnt lgkmcnt(1)
    v_dot2c_f32_bf16 v8, s55, v96
    v_dot2c_f32_bf16 v9, v96, v96
    v_dot2c_f32_bf16 v10, s55, v97
    v_dot2c_f32_bf16 v11, v97, v97
    v_dot2c_f32_bf16 v8, s55, v98
    v_dot2c_f32_bf16 v9, v98, v98
    v_dot2c_f32_bf16 v10, s55, v99
    v_dot2c_f32_bf16 v11, v99, v99
    s_waitcnt vmcnt(2)
    ds_read_b128 v[104:107], v13 offset:2048
    s_waitcnt lgkmcnt(1)
    v_dot2c_f32_bf16 v8, s55, v100
    v_dot2c_f32_bf16 v9, v100, v100
    v_dot2c_f32_bf16 v10, s55, v101
    v_dot2c_f32_bf16 v11, v101, v101
    v_dot2c_f32_bf16 v8, s55, v102
    v_dot2c_f32_bf16 v9, v102, v102
    v_dot2c_f32_bf16 v10, s55, v103
    v_dot2c_f32_bf16 v11, v103, v103
    s_waitcnt vmcnt(1)
    ds_read_b128 v[108:111], v13 offset:3072
    s_waitcnt lgkmcnt(1)
    v_dot2c_f32_bf16 v8, s55, v104
    v_dot2c_f32_bf16 v9, v104, v104
    v_dot2c_f32_bf16 v10, s55, v105
    v_dot2c_f32_bf16 v11, v105, v105
    v_dot2c_f32_bf16 v8, s55, v106
    v_dot2c_f32_bf16 v9, v106, v106
    v_dot2c_f32_bf16 v10, s55, v107
    v_dot2c_f32_bf16 v11, v107, v107
    s_waitcnt vmcnt(0)
    ds_read_b128 v[112:115], v13 offset:4096
    s_waitcnt lgkmcnt(1)
    v_dot2c_f32_bf16 v8, s55, v108
    v_dot2c_f32_bf16 v9, v108, v108
    v_dot2c_f32_bf16 v10, s55, v109
    v_dot2c_f32_bf16 v11, v109, v109
    v_dot2c_f32_bf16 v8, s55, v110
    v_dot2c_f32_bf16 v9, v110, v110
    v_dot2c_f32_bf16 v10, s55, v111
    v_dot2c_f32_bf16 v11, v111, v111
    s_waitcnt lgkmcnt(0)
    v_dot2c_f32_bf16 v8, s55, v112
    v_dot2c_f32_bf16 v9, v112, v112
    v_dot2c_f32_bf16 v10, s55, v113
    v_dot2c_f32_bf16 v11, v113, v113
    v_dot2c_f32_bf16 v8, s55, v114
    v_dot2c_f32_bf16 v9, v114, v114
    v_dot2c_f32_bf16 v10, s55, v115
    v_dot2c_f32_bf16 v11, v115, v115
    s_nop 1
    v_add_f32 v8, v8, v10
    v_add_f32 v9, v9, v11
    s_nop 0
    v_add_f32_dpp v8, v8, v8 row_ror:8 row_mask:0xf bank_mask:0xf
    v_add_f32_dpp v9, v9, v9 row_ror:8 row_mask:0xf bank_mask:0xf
    v_mov_b32 v10, v8
    v_mov_b32 v11, v9
    s_nop 0
    v_permlane16_swap_b32 v8, v10
    v_permlane16_swap_b32 v9, v11
    v_add_f32 v8, v8, v10
    v_add_f32 v9, v9, v11
    v_mov_b32 v10, v8
    v_mov_b32 v11, v9
    s_nop 0
    v_permlane32_swap_b32 v8, v10
    v_permlane32_swap_b32 v9, v11
    v_add_f32 v8, v8, v10
    v_add_f32 v9, v9, v11
    ds_write_b64 v91, v[8:9]
    s_waitcnt lgkmcnt(0)
    s_barrier
    ds_read_b128 v[120:123], v92 offset:0
    ds_read_b128 v[124:127], v92 offset:128
    ds_read_b128 v[128:131], v92 offset:256
    ds_read_b128 v[132:135], v92 offset:384
    ds_read_b128 v[136:139], v90 offset:0
    ds_read_b128 v[96:99], v89 offset:0
    ds_read_b128 v[100:103], v89 offset:10240
    ds_read_b128 v[104:107], v89 offset:20480
    ds_read_b128 v[108:111], v89 offset:30720
    ds_read_b128 v[112:115], v88 offset:0
    s_mov_b32 s42, 0xbacccccd
    s_mov_b32 s43, 0x3acccccd
    s_waitcnt lgkmcnt(5)
    v_pk_add_f32 v[120:121], v[120:121], v[122:123]
    v_pk_add_f32 v[124:125], v[124:125], v[126:127]
    v_pk_add_f32 v[128:129], v[128:129], v[130:131]
    v_pk_add_f32 v[132:133], v[132:133], v[134:135]
    v_pk_add_f32 v[136:137], v[136:137], v[138:139]
    v_pk_mul_f32 v[120:121], v[120:121], s[42:43]
    v_pk_mul_f32 v[124:125], v[124:125], s[42:43]
    v_pk_mul_f32 v[128:129], v[128:129], s[42:43]
    v_pk_mul_f32 v[132:133], v[132:133], s[42:43]
    v_pk_mul_f32 v[136:137], v[136:137], s[42:43]
    v_fma_f32 v121, -v120, v120, v121
    v_fma_f32 v125, -v124, v124, v125
    v_fma_f32 v129, -v128, v128, v129
    v_fma_f32 v133, -v132, v132, v133
    v_fma_f32 v137, -v136, v136, v137
    v_max_f32 v121, 0, v121
    v_max_f32 v125, 0, v125
    v_max_f32 v129, 0, v129
    v_max_f32 v133, 0, v133
    v_max_f32 v137, 0, v137
    v_add_f32 v121, 0x3727c5ac, v121
    v_add_f32 v125, 0x3727c5ac, v125
    v_add_f32 v129, 0x3727c5ac, v129
    v_add_f32 v133, 0x3727c5ac, v133
    v_add_f32 v137, 0x3727c5ac, v137
    v_rsq_f32 v121, v121
    v_rsq_f32 v125, v125
    v_rsq_f32 v129, v129
    v_rsq_f32 v133, v133
    v_rsq_f32 v137, v137
    v_mul_f32 v120, v120, v121
    v_mul_f32 v124, v124, v125
    v_mul_f32 v128, v128, v129
    v_mul_f32 v132, v132, v133
    v_mul_f32 v136, v136, v137
    s_waitcnt lgkmcnt(0)
    v_lshlrev_b32 v144, 16, v96
    v_and_b32 v145, 0xffff0000, v96
    v_pk_fma_f32 v[144:145], v[144:145], v[120:121], v[120:121] op_sel:[0,1,0] op_sel_hi:[1,1,0]
    v_lshlrev_b32 v146, 16, v97
    v_and_b32 v147, 0xffff0000, v97
    v_pk_fma_f32 v[146:147], v[146:147], v[120:121], v[120:121] op_sel:[0,1,0] op_sel_hi:[1,1,0]
    v_lshlrev_b32 v148, 16, v98
    v_and_b32 v149, 0xffff0000, v98
    v_pk_fma_f32 v[148:149], v[148:149], v[120:121], v[120:121] op_sel:[0,1,0] op_sel_hi:[1,1,0]
    v_lshlrev_b32 v150, 16, v99
    v_and_b32 v151, 0xffff0000, v99
    v_pk_fma_f32 v[150:151], v[150:151], v[120:121], v[120:121] op_sel:[0,1,0] op_sel_hi:[1,1,0]
    v_lshlrev_b32 v152, 16, v100
    v_and_b32 v153, 0xffff0000, v100
    v_pk_fma_f32 v[152:153], v[152:153], v[124:125], v[124:125] op_sel:[0,1,0] op_sel_hi:[1,1,0]
    v_lshlrev_b32 v154, 16, v101
    v_and_b32 v155, 0xffff0000, v101
    v_pk_fma_f32 v[154:155], v[154:155], v[124:125], v[124:125] op_sel:[0,1,0] op_sel_hi:[1,1,0]
    v_lshlrev_b32 v156, 16, v102
    v_and_b32 v157, 0xffff0000, v102
    v_pk_fma_f32 v[156:157], v[156:157], v[124:125], v[124:125] op_sel:[0,1,0] op_sel_hi:[1,1,0]
    v_lshlrev_b32 v158, 16, v103
    v_and_b32 v159, 0xffff0000, v103
    v_pk_fma_f32 v[158:159], v[158:159], v[124:125], v[124:125] op_sel:[0,1,0] op_sel_hi:[1,1,0]
    v_lshlrev_b32 v160, 16, v104
    v_and_b32 v161, 0xffff0000, v104
    v_pk_fma_f32 v[160:161], v[160:161], v[128:129], v[128:129] op_sel:[0,1,0] op_sel_hi:[1,1,0]
    v_lshlrev_b32 v162, 16, v105
    v_and_b32 v163, 0xffff0000, v105
    v_pk_fma_f32 v[162:163], v[162:163], v[128:129], v[128:129] op_sel:[0,1,0] op_sel_hi:[1,1,0]
    v_lshlrev_b32 v164, 16, v106
    v_and_b32 v165, 0xffff0000, v106
    v_pk_fma_f32 v[164:165], v[164:165], v[128:129], v[128:129] op_sel:[0,1,0] op_sel_hi:[1,1,0]
    v_lshlrev_b32 v166, 16, v107
    v_and_b32 v167, 0xffff0000, v107
    v_pk_fma_f32 v[166:167], v[166:167], v[128:129], v[128:129] op_sel:[0,1,0] op_sel_hi:[1,1,0]
    v_lshlrev_b32 v168, 16, v108
    v_and_b32 v169, 0xffff0000, v108
    v_pk_fma_f32 v[168:169], v[168:169], v[132:133], v[132:133] op_sel:[0,1,0] op_sel_hi:[1,1,0]
    v_lshlrev_b32 v170, 16, v109
    v_and_b32 v171, 0xffff0000, v109
    v_pk_fma_f32 v[170:171], v[170:171], v[132:133], v[132:133] op_sel:[0,1,0] op_sel_hi:[1,1,0]
    v_lshlrev_b32 v172, 16, v110
    v_and_b32 v173, 0xffff0000, v110
    v_pk_fma_f32 v[172:173], v[172:173], v[132:133], v[132:133] op_sel:[0,1,0] op_sel_hi:[1,1,0]
    v_lshlrev_b32 v174, 16, v111
    v_and_b32 v175, 0xffff0000, v111
    v_pk_fma_f32 v[174:175], v[174:175], v[132:133], v[132:133] op_sel:[0,1,0] op_sel_hi:[1,1,0]
    v_lshlrev_b32 v176, 16, v112
    v_and_b32 v177, 0xffff0000, v112
    v_pk_fma_f32 v[176:177], v[176:177], v[136:137], v[136:137] op_sel:[0,1,0] op_sel_hi:[1,1,0]
    v_lshlrev_b32 v178, 16, v113
    v_and_b32 v179, 0xffff0000, v113
    v_pk_fma_f32 v[178:179], v[178:179], v[136:137], v[136:137] op_sel:[0,1,0] op_sel_hi:[1,1,0]
    v_lshlrev_b32 v180, 16, v114
    v_and_b32 v181, 0xffff0000, v114
    v_pk_fma_f32 v[180:181], v[180:181], v[136:137], v[136:137] op_sel:[0,1,0] op_sel_hi:[1,1,0]
    v_lshlrev_b32 v182, 16, v115
    v_and_b32 v183, 0xffff0000, v115
    v_pk_fma_f32 v[182:183], v[182:183], v[136:137], v[136:137] op_sel:[0,1,0] op_sel_hi:[1,1,0]
    s_cmp_ge_u32 s61, 15
    s_cselect_b32 s42, 0x40000000, s68
    s_lshr_b32 s43, s3, 2
    s_mul_i32 s44, s43, 245760
    s_add_u32 s42, s42, s44
    s_lshl_b32 s43, s43, 14
    s_add_u32 s43, s43, s69
    s_add_u32 s44, s42, 0
    s_add_u32 m0, s43, 0
    s_nop 0
    buffer_load_dwordx4 v200, s[36:39], s44 offen  lds
    s_add_u32 s44, s44, 14336
    buffer_load_dwordx4 v200, s[36:39], s44 offen offset:1024  lds
    s_add_u32 s44, s44, 14336
    buffer_load_dwordx4 v200, s[36:39], s44 offen offset:2048  lds
    s_add_u32 s44, s44, 14336
    buffer_load_dwordx4 v200, s[36:39], s44 offen offset:3072  lds
    s_lshr_b32 s44, s64, 0
    s_lshr_b32 s45, s64, 8
    s_lshr_b32 s46, s64, 16
    s_lshr_b32 s47, s64, 24
    s_mov_b32 s58, 0
adaLN_cond__sliding_block__swiglu_ffn__prompt_kernel_gp_16:
    s_mov_b32 s48, 393216
    buffer_load_dwordx4 v[16:19], v4, s[28:31], s48 offen sc1
    s_mov_b32 s48, 398336
    buffer_load_dwordx4 v[20:23], v4, s[28:31], s48 offen sc1
    s_mov_b32 s48, 403456
    buffer_load_dwordx4 v[24:27], v4, s[28:31], s48 offen sc1
    s_mov_b32 s48, 408576
    buffer_load_dwordx4 v[28:31], v94, s[28:31], s48 offen sc1
    v_mov_b32 v93, 0
    s_waitcnt vmcnt(3)
    v_xor_b32 v32, s44, v16
    v_xor_b32 v33, s45, v17
    v_xor_b32 v34, s46, v18
    v_xor_b32 v35, s47, v19
    v_or3_b32 v93, v93, v32, v33
    v_or3_b32 v93, v93, v34, v35
    s_waitcnt vmcnt(2)
    v_xor_b32 v32, s44, v20
    v_xor_b32 v33, s45, v21
    v_xor_b32 v34, s46, v22
    v_xor_b32 v35, s47, v23
    v_or3_b32 v93, v93, v32, v33
    v_or3_b32 v93, v93, v34, v35
    s_waitcnt vmcnt(1)
    v_xor_b32 v32, s44, v24
    v_xor_b32 v33, s45, v25
    v_xor_b32 v34, s46, v26
    v_xor_b32 v35, s47, v27
    v_or3_b32 v93, v93, v32, v33
    v_or3_b32 v93, v93, v34, v35
    s_waitcnt vmcnt(0)
    v_xor_b32 v32, s44, v28
    v_xor_b32 v33, s45, v29
    v_xor_b32 v34, s46, v30
    v_xor_b32 v35, s47, v31
    v_or3_b32 v93, v93, v32, v33
    v_or3_b32 v93, v93, v34, v35
    v_and_b32 v93, 0xff, v93
    v_cmp_ne_u32 vcc, 0, v93
    s_nop 4
    s_cbranch_vccz adaLN_cond__sliding_block__swiglu_ffn__prompt_kernel_gd_17
    s_add_u32 s58, s58, 1
    s_sleep 4
    s_cmp_lt_u32 s58, 0x8000
    s_cbranch_scc1 adaLN_cond__sliding_block__swiglu_ffn__prompt_kernel_gp_16
adaLN_cond__sliding_block__swiglu_ffn__prompt_kernel_gd_17:
    v_and_b32 v16, 0xffffff00, v16
    v_and_b32 v17, 0xffffff00, v17
    v_and_b32 v18, 0xffffff00, v18
    v_and_b32 v19, 0xffffff00, v19
    v_and_b32 v20, 0xffffff00, v20
    v_and_b32 v21, 0xffffff00, v21
    v_and_b32 v22, 0xffffff00, v22
    v_and_b32 v23, 0xffffff00, v23
    v_and_b32 v24, 0xffffff00, v24
    v_and_b32 v25, 0xffffff00, v25
    v_and_b32 v26, 0xffffff00, v26
    v_and_b32 v27, 0xffffff00, v27
    v_pk_add_f32 v[16:17], v[16:17], v[20:21]
    v_pk_add_f32 v[18:19], v[18:19], v[22:23]
    v_pk_add_f32 v[16:17], v[16:17], v[24:25]
    v_pk_add_f32 v[18:19], v[18:19], v[26:27]
    v_cvt_pk_bf16_f32 v20, v16, v17
    v_cvt_pk_bf16_f32 v22, v18, v19
    v_lshlrev_b32 v16, 16, v20
    v_and_b32 v17, 0xffff0000, v20
    v_lshlrev_b32 v18, 16, v22
    v_and_b32 v19, 0xffff0000, v22
    v_add_f32 v16, v14, v16
    v_add_f32 v17, v14, v17
    v_add_f32 v18, v14, v18
    v_add_f32 v19, v14, v19
    v_cvt_pk_bf16_f32 v20, v16, v17
    v_cvt_pk_bf16_f32 v22, v18, v19
    v_lshlrev_b32 v16, 16, v20
    v_and_b32 v17, 0xffff0000, v20
    v_lshlrev_b32 v18, 16, v22
    v_and_b32 v19, 0xffff0000, v22
    ds_write_b128 v5, v[16:19]
    ds_read_b128 v[44:47], v7 offset:0
    ds_read_b128 v[48:51], v7 offset:16
    ds_read_b128 v[52:55], v7 offset:256
    ds_read_b128 v[56:59], v7 offset:272
    ds_read_b128 v[60:63], v7 offset:512
    ds_read_b128 v[64:67], v7 offset:528
    ds_read_b128 v[68:71], v7 offset:768
    ds_read_b128 v[72:75], v7 offset:784
    s_waitcnt lgkmcnt(4)
    v_pk_fma_f32 v[144:145], v[144:145], v[52:53], v[44:45]
    v_pk_fma_f32 v[146:147], v[146:147], v[54:55], v[46:47]
    v_pk_fma_f32 v[148:149], v[148:149], v[56:57], v[48:49]
    v_pk_fma_f32 v[150:151], v[150:151], v[58:59], v[50:51]
    v_cvt_pk_bf16_f32 v96, v144, v145
    v_cvt_pk_bf16_f32 v97, v146, v147
    v_cvt_pk_bf16_f32 v98, v148, v149
    v_cvt_pk_bf16_f32 v99, v150, v151
    buffer_store_dwordx4 v[96:99], v15, s[28:31], s49 offen offset:0 sc1
    v_pk_fma_f32 v[152:153], v[152:153], v[52:53], v[44:45]
    v_pk_fma_f32 v[154:155], v[154:155], v[54:55], v[46:47]
    v_pk_fma_f32 v[156:157], v[156:157], v[56:57], v[48:49]
    v_pk_fma_f32 v[158:159], v[158:159], v[58:59], v[50:51]
    v_cvt_pk_bf16_f32 v100, v152, v153
    v_cvt_pk_bf16_f32 v101, v154, v155
    v_cvt_pk_bf16_f32 v102, v156, v157
    v_cvt_pk_bf16_f32 v103, v158, v159
    buffer_store_dwordx4 v[100:103], v15, s[28:31], s49 offen offset:128 sc1
    v_pk_fma_f32 v[160:161], v[160:161], v[52:53], v[44:45]
    v_pk_fma_f32 v[162:163], v[162:163], v[54:55], v[46:47]
    v_pk_fma_f32 v[164:165], v[164:165], v[56:57], v[48:49]
    v_pk_fma_f32 v[166:167], v[166:167], v[58:59], v[50:51]
    v_cvt_pk_bf16_f32 v104, v160, v161
    v_cvt_pk_bf16_f32 v105, v162, v163
    v_cvt_pk_bf16_f32 v106, v164, v165
    v_cvt_pk_bf16_f32 v107, v166, v167
    buffer_store_dwordx4 v[104:107], v15, s[28:31], s49 offen offset:256 sc1
    v_pk_fma_f32 v[168:169], v[168:169], v[52:53], v[44:45]
    v_pk_fma_f32 v[170:171], v[170:171], v[54:55], v[46:47]
    v_pk_fma_f32 v[172:173], v[172:173], v[56:57], v[48:49]
    v_pk_fma_f32 v[174:175], v[174:175], v[58:59], v[50:51]
    v_cvt_pk_bf16_f32 v108, v168, v169
    v_cvt_pk_bf16_f32 v109, v170, v171
    v_cvt_pk_bf16_f32 v110, v172, v173
    v_cvt_pk_bf16_f32 v111, v174, v175
    buffer_store_dwordx4 v[108:111], v15, s[28:31], s49 offen offset:384 sc1
    s_waitcnt lgkmcnt(0)
    v_pk_fma_f32 v[176:177], v[176:177], v[68:69], v[60:61]
    v_pk_fma_f32 v[178:179], v[178:179], v[70:71], v[62:63]
    v_pk_fma_f32 v[180:181], v[180:181], v[72:73], v[64:65]
    v_pk_fma_f32 v[182:183], v[182:183], v[74:75], v[66:67]
    v_cvt_pk_bf16_f32 v112, v176, v177
    v_cvt_pk_bf16_f32 v113, v178, v179
    v_cvt_pk_bf16_f32 v114, v180, v181
    v_cvt_pk_bf16_f32 v115, v182, v183
    buffer_store_dwordx4 v[112:115], v15, s[28:31], s51 offen offset:0 sc1
    s_cmp_lt_u32 s3, 4
    s_cbranch_scc1 adaLN_cond__sliding_block__swiglu_ffn__prompt_kernel_hs_10
    s_cmp_lt_u32 s61, 15
    s_cbranch_scc1 adaLN_cond__sliding_block__swiglu_ffn__prompt_kernel_ld1_4
adaLN_cond__sliding_block__swiglu_ffn__prompt_kernel_hs_10:
    s_lshr_b32 s52, s52, 2
    s_waitcnt vmcnt(0)
    s_barrier
    s_cmp_lg_u32 s3, 1
    s_cbranch_scc1 adaLN_cond__sliding_block__swiglu_ffn__prompt_kernel_sig_18
    s_lshl_b32 s57, s52, 7
    s_add_u32 s57, s57, 790528
    s_atomic_add_x2 s[10:11], s[26:27], s57
adaLN_cond__sliding_block__swiglu_ffn__prompt_kernel_sig_18:
adaLN_cond__sliding_block__swiglu_ffn__prompt_kernel_p1_3:
hop_pad_1:
    s_cbranch_execz hop_back
    s_cmp_lt_u32 s3, 4
    s_cbranch_scc1 adaLN_cond__sliding_block__swiglu_ffn__prompt_kernel_cc_19
adaLN_cond__sliding_block__swiglu_ffn__prompt_kernel_ld1_4:
    s_cmp_ge_u32 s61, 15
    s_cbranch_scc1 adaLN_cond__sliding_block__swiglu_ffn__prompt_kernel_idle_20
    s_mov_b32 s36, s6
    s_and_b32 s37, s7, 0xffff
    s_mov_b32 s38, 0x258000
    s_mov_b32 s39, 0x20000
    v_lshrrev_b32 v4, 4, v0
    v_and_b32 v5, 15, v0
    v_lshlrev_b32 v6, 2, v4
    v_xor_b32 v5, v5, v6
    v_mul_u32_u24 v4, 3840, v4
    v_lshl_add_u32 v4, v5, 4, v4
    s_mul_i32 s68, s66, 61440
    s_lshl_b32 s69, s61, 8
    s_add_u32 s68, s68, s69
    s_lshl_b32 s69, s66, 12
    s_and_b32 s40, s60, 3
    s_cmp_eq_u32 s40, 1
    s_cbranch_scc1 adaLN_cond__sliding_block__swiglu_ffn__prompt_kernel_c0_21
    s_cmp_eq_u32 s40, 0
    s_cbranch_scc1 adaLN_cond__sliding_block__swiglu_ffn__prompt_kernel_nt_23
    s_and_b32 s41, s60, 1
    s_lshr_b32 s42, s60, 2
    s_and_b32 s42, s42, 1
    s_lshl_b32 s42, s42, 1
    s_add_u32 s41, s41, s42
    s_lshl_b32 s41, s41, 2
    s_add_u32 s41, s41, s66
    s_mul_i32 s41, s41, 153600
    s_lshl_b32 s42, s61, 8
    s_add_u32 s41, s41, s42
    v_lshrrev_b32 v1, 1, v0
    v_mul_u32_u24 v1, 3840, v1
    v_and_b32 v2, 1, v0
    v_lshl_add_u32 v1, v2, 7, v1
    s_mov_b32 exec_hi, 0xff
    buffer_load_dword v241, v1, s[36:39], s41 offen
    s_add_u32 s41, s41, 76800
    buffer_load_dword v241, v1, s[36:39], s41 offen
    s_add_u32 s41, s41, 76800
    s_mov_b32 exec_hi, -1
adaLN_cond__sliding_block__swiglu_ffn__prompt_kernel_nt_23:
    s_add_u32 s40, s60, 2
    s_lshr_b32 s40, s40, 2
    s_sub_u32 s40, s60, s40
    s_mul_i32 s40, s40, 15
    s_add_u32 s40, s40, s61
    s_lshl_b32 s25, s40, 2
    s_add_u32 s25, s25, s66
    s_mul_i32 s67, s66, 4096
    s_add_u32 s67, s67, 114688
    v_lshrrev_b32 v14, 3, v0
    v_and_b32 v15, 7, v0
    v_mul_u32_u24 v8, 3456, v14
    v_lshl_add_u32 v8, v15, 4, v8
    v_mul_u32_u24 v9, 1280, v14
    v_lshl_add_u32 v9, v15, 4, v9
    v_bfe_u32 v14, v0, 2, 2
    v_and_b32 v15, 3, v0
    v_lshlrev_b32 v15, 3, v15
    v_lshl_add_u32 v15, v14, 7, v15
    v_add_u32 v15, s67, v15
    v_lshrrev_b32 v14, 4, v0
    v_lshl_add_u32 v10, v14, 10, v15
    v_bfe_u32 v13, v0, 4, 1
    v_lshrrev_b32 v14, 5, v0
    v_lshl_add_u32 v11, v14, 11, v15
    v_lshl_add_u32 v11, v13, 9, v11
    v_lshl_add_u32 v12, v13, 11, v15
    v_lshl_add_u32 v12, v14, 10, v12
    s_mov_b32 s40, s25
    s_mul_hi_u32 s41, s40, 0x97b425f
    s_mul_i32 s43, s41, 27
    s_sub_u32 s42, s40, s43
    s_lshr_b32 s45, s41, 1
    s_and_b32 s44, s41, 1
    s_lshl_b32 s18, s45, 6
    s_add_u32 s18, s18, 109824
    s_lshl_b32 s19, s42, 3
    s_add_u32 s19, s19, s44
    s_lshl_b32 s19, s19, 7
    s_add_u32 s19, s19, 131072
    s_mul_i32 s43, s45, 110592
    s_lshl_b32 s45, s42, 7
    s_add_u32 s43, s43, s45
    s_mov_b32 s32, s12
    s_and_b32 s33, s13, 0xffff
    s_mov_b32 s34, 0x21c000
    s_mov_b32 s35, 0x20000
    s_cmp_eq_u32 s44, 0
    s_cbranch_scc1 adaLN_cond__sliding_block__swiglu_ffn__prompt_kernel_up_27
    s_mov_b32 s32, s14
    s_and_b32 s33, s15, 0xffff
    s_mov_b32 s34, 0x21c000
    s_mov_b32 s35, 0x20000
adaLN_cond__sliding_block__swiglu_ffn__prompt_kernel_up_27:
    s_add_u32 m0, s67, 0
    s_nop 0
    buffer_load_dwordx4 v8, s[32:35], s43 offen nt lds
    s_add_u32 s43, s43, 26624
    buffer_load_dwordx4 v8, s[32:35], s43 offen offset:1024 nt lds
    s_add_u32 s43, s43, 26624
    buffer_load_dwordx4 v8, s[32:35], s43 offen offset:2048 nt lds
    s_add_u32 s43, s43, 26624
    buffer_load_dwordx4 v8, s[32:35], s43 offen offset:3072 nt lds
    s_mul_i32 s43, s42, 163840
    s_lshl_b32 s44, s41, 10
    s_add_u32 s43, s43, s44
    s_add_u32 s46, s43, 5242880
    s_add_u32 s47, s43, 5283840
    s_add_u32 s48, s43, 5324800
    s_add_u32 s49, s43, 5365760
    v_add_u32 v14, 0, v10
    v_add_u32 v15, 512, v10
    s_mov_b32 s20, 0x40000000
    s_mov_b32 s21, 0x40000000
    s_cmp_ge_u32 s25, 560
    s_cbranch_scc1 adaLN_cond__sliding_block__swiglu_ffn__prompt_kernel_c_29
    s_cmp_ge_u32 s25, 360
    s_cbranch_scc1 adaLN_cond__sliding_block__swiglu_ffn__prompt_kernel_b_28
    s_add_u32 s40, s25, 720
    s_mul_hi_u32 s41, s40, 0x97b425f
    s_mul_i32 s43, s41, 27
    s_sub_u32 s42, s40, s43
    s_lshr_b32 s45, s41, 1
    s_and_b32 s44, s41, 1
    s_lshl_b32 s20, s45, 6
    s_add_u32 s20, s20, 109824
    s_lshl_b32 s21, s42, 3
    s_add_u32 s21, s21, s44
    s_lshl_b32 s21, s21, 7
    s_add_u32 s21, s21, 131072
    s_mul_i32 s43, s45, 110592
    s_lshl_b32 s45, s42, 7
    s_add_u32 s43, s43, s45
    s_mov_b32 s32, s12
    s_and_b32 s33, s13, 0xffff
    s_mov_b32 s34, 0x21c000
    s_mov_b32 s35, 0x20000
    s_cmp_eq_u32 s44, 0
    s_cbranch_scc1 adaLN_cond__sliding_block__swiglu_ffn__prompt_kernel_up_31
    s_mov_b32 s32, s14
    s_and_b32 s33, s15, 0xffff
    s_mov_b32 s34, 0x21c000
    s_mov_b32 s35, 0x20000
adaLN_cond__sliding_block__swiglu_ffn__prompt_kernel_up_31:
    s_add_u32 m0, s67, 16384
    s_nop 0
    buffer_load_dwordx4 v8, s[32:35], s43 offen nt lds
    s_add_u32 s43, s43, 26624
    buffer_load_dwordx4 v8, s[32:35], s43 offen offset:1024 nt lds
    s_add_u32 s43, s43, 26624
    buffer_load_dwordx4 v8, s[32:35], s43 offen offset:2048 nt lds
    s_add_u32 s43, s43, 26624
    buffer_load_dwordx4 v8, s[32:35], s43 offen offset:3072 nt lds
    s_mul_i32 s43, s42, 163840
    s_lshl_b32 s44, s41, 10
    s_add_u32 s43, s43, s44
    s_add_u32 s52, s43, 5242880
    s_add_u32 s53, s43, 5283840
    s_add_u32 s54, s43, 5324800
    s_add_u32 s55, s43, 5365760
    v_add_u32 v16, 16384, v10
    v_add_u32 v17, 16896, v10
    s_branch adaLN_cond__sliding_block__swiglu_ffn__prompt_kernel_j_30
adaLN_cond__sliding_block__swiglu_ffn__prompt_kernel_b_28:
    s_sub_u32 s40, s25, 360
    s_mov_b32 s32, s8
    s_and_b32 s33, s9, 0xffff
    s_mov_b32 s34, 0xc8000
    s_mov_b32 s35, 0x20000
    s_mul_hi_u32 s41, s40, 0x1999999a
    s_mul_i32 s43, s41, 10
    s_sub_u32 s42, s40, s43
    s_mul_i32 s43, s41, 40960
    s_lshl_b32 s44, s42, 7
    s_add_u32 s43, s43, s44
    s_lshl_b32 s43, s41, 2
    s_add_u32 s43, s43, 0
    s_bfe_u32 s44, s43, 0x40001
    s_mul_i32 s44, s44, 40
    s_lshr_b32 s45, s43, 5
    s_mul_i32 s45, s45, 20
    s_add_u32 s44, s44, s45
    s_add_u32 s44, s44, 0
    s_mul_i32 s45, s43, 40
    s_sub_u32 s45, s45, 2544
    s_cmp_ge_u32 s43, 64
    s_cselect_b32 s44, s45, s44
    s_cselect_b32 s45, 16, 4
    s_mul_i32 s45, s45, 1280
    s_mul_i32 s43, s44, 1280
    s_lshl_b32 s44, s42, 7
    s_add_u32 s43, s43, s44
    v_lshrrev_b32 v13, 5, v0
    v_mul_u32_u24 v13, s45, v13
    v_add_u32 v13, v13, v9
    s_add_u32 m0, s67, 16384
    s_nop 0
    buffer_load_dwordx4 v13, s[32:35], s43 offen nt lds
    s_lshl_b32 s43, s41, 2
    s_add_u32 s43, s43, 1
    s_bfe_u32 s44, s43, 0x40001
    s_mul_i32 s44, s44, 40
    s_lshr_b32 s45, s43, 5
    s_mul_i32 s45, s45, 20
    s_add_u32 s44, s44, s45
    s_add_u32 s44, s44, 4
    s_mul_i32 s45, s43, 40
    s_sub_u32 s45, s45, 2544
    s_cmp_ge_u32 s43, 64
    s_cselect_b32 s44, s45, s44
    s_cselect_b32 s45, 16, 4
    s_mul_i32 s45, s45, 1280
    s_mul_i32 s43, s44, 1280
    s_lshl_b32 s44, s42, 7
    s_add_u32 s43, s43, s44
    v_lshrrev_b32 v13, 5, v0
    v_mul_u32_u24 v13, s45, v13
    v_add_u32 v13, v13, v9
    s_add_u32 m0, s67, 17408
    s_nop 0
    buffer_load_dwordx4 v13, s[32:35], s43 offen nt lds
    s_lshl_b32 s43, s41, 2
    s_add_u32 s43, s43, 2
    s_bfe_u32 s44, s43, 0x40001
    s_mul_i32 s44, s44, 40
    s_lshr_b32 s45, s43, 5
    s_mul_i32 s45, s45, 20
    s_add_u32 s44, s44, s45
    s_add_u32 s44, s44, 0
    s_mul_i32 s45, s43, 40
hop_pad_2:
    s_cbranch_execz hop_back
    s_sub_u32 s45, s45, 2544
    s_cmp_ge_u32 s43, 64
    s_cselect_b32 s44, s45, s44
    s_cselect_b32 s45, 16, 4
    s_mul_i32 s45, s45, 1280
    s_mul_i32 s43, s44, 1280
    s_lshl_b32 s44, s42, 7
    s_add_u32 s43, s43, s44
    v_lshrrev_b32 v13, 5, v0
    v_mul_u32_u24 v13, s45, v13
    v_add_u32 v13, v13, v9
    s_add_u32 m0, s67, 18432
    s_nop 0
    buffer_load_dwordx4 v13, s[32:35], s43 offen nt lds
    s_lshl_b32 s43, s41, 2
    s_add_u32 s43, s43, 3
    s_bfe_u32 s44, s43, 0x40001
    s_mul_i32 s44, s44, 40
    s_lshr_b32 s45, s43, 5
    s_mul_i32 s45, s45, 20
    s_add_u32 s44, s44, s45
    s_add_u32 s44, s44, 4
    s_mul_i32 s45, s43, 40
    s_sub_u32 s45, s45, 2544
    s_cmp_ge_u32 s43, 64
    s_cselect_b32 s44, s45, s44
    s_cselect_b32 s45, 16, 4
    s_mul_i32 s45, s45, 1280
    s_mul_i32 s43, s44, 1280
    s_lshl_b32 s44, s42, 7
    s_add_u32 s43, s43, s44
    v_lshrrev_b32 v13, 5, v0
    v_mul_u32_u24 v13, s45, v13
    v_add_u32 v13, v13, v9
    s_add_u32 m0, s67, 19456
    s_nop 0
    buffer_load_dwordx4 v13, s[32:35], s43 offen nt lds
    s_lshl_b32 s43, s42, 2
    s_add_u32 s43, s43, 0
    s_mul_hi_u32 s44, s43, 0x33333334
    s_mul_i32 s56, s44, 5
    s_sub_u32 s45, s43, s56
    s_mul_i32 s44, s44, 20
    s_add_u32 s44, s44, s41
    s_mul_i32 s44, s44, 5
    s_add_u32 s44, s44, s45
    s_lshl_b32 s44, s44, 10
    s_add_u32 s52, s44, 1048576
    s_lshl_b32 s43, s42, 2
    s_add_u32 s43, s43, 1
    s_mul_hi_u32 s44, s43, 0x33333334
    s_mul_i32 s56, s44, 5
    s_sub_u32 s45, s43, s56
    s_mul_i32 s44, s44, 20
    s_add_u32 s44, s44, s41
    s_mul_i32 s44, s44, 5
    s_add_u32 s44, s44, s45
    s_lshl_b32 s44, s44, 10
    s_add_u32 s53, s44, 1048576
    s_lshl_b32 s43, s42, 2
    s_add_u32 s43, s43, 2
    s_mul_hi_u32 s44, s43, 0x33333334
    s_mul_i32 s56, s44, 5
    s_sub_u32 s45, s43, s56
    s_mul_i32 s44, s44, 20
    s_add_u32 s44, s44, s41
    s_mul_i32 s44, s44, 5
    s_add_u32 s44, s44, s45
    s_lshl_b32 s44, s44, 10
    s_add_u32 s54, s44, 1048576
    s_lshl_b32 s43, s42, 2
    s_add_u32 s43, s43, 3
    s_mul_hi_u32 s44, s43, 0x33333334
    s_mul_i32 s56, s44, 5
    s_sub_u32 s45, s43, s56
    s_mul_i32 s44, s44, 20
    s_add_u32 s44, s44, s41
    s_mul_i32 s44, s44, 5
    s_add_u32 s44, s44, s45
    s_lshl_b32 s44, s44, 10
    s_add_u32 s55, s44, 1048576
    v_add_u32 v16, 16384, v10
    v_add_u32 v17, 16896, v10
    s_branch adaLN_cond__sliding_block__swiglu_ffn__prompt_kernel_j_30
adaLN_cond__sliding_block__swiglu_ffn__prompt_kernel_c_29:
    s_sub_u32 s40, s25, 128
    s_mov_b32 s32, s16
    s_and_b32 s33, s17, 0xffff
    s_mov_b32 s34, 0x21c000
    s_mov_b32 s35, 0x20000
    s_mul_hi_u32 s41, s40, 0x1999999a
    s_mul_i32 s43, s41, 10
    s_sub_u32 s42, s40, s43
    s_mul_i32 s43, s41, 40960
    s_lshl_b32 s44, s42, 7
    s_add_u32 s43, s43, s44
    s_add_u32 m0, s67, 16384
    s_nop 0
    buffer_load_dwordx4 v9, s[32:35], s43 offen nt lds
    s_add_u32 s43, s43, 9216
    buffer_load_dwordx4 v9, s[32:35], s43 offen offset:1024 nt lds
    s_add_u32 s43, s43, 9216
    buffer_load_dwordx4 v9, s[32:35], s43 offen offset:2048 nt lds
    s_add_u32 s43, s43, 9216
    buffer_load_dwordx4 v9, s[32:35], s43 offen offset:3072 nt lds
    s_lshl_b32 s43, s42, 2
    s_add_u32 s43, s43, 0
    s_mul_hi_u32 s44, s43, 0x33333334
    s_mul_i32 s56, s44, 5
    s_sub_u32 s45, s43, s56
    s_mul_i32 s44, s44, 54
    s_add_u32 s44, s44, s41
    s_mul_i32 s44, s44, 5
    s_add_u32 s44, s44, s45
    s_lshl_b32 s44, s44, 10
    s_add_u32 s52, s44, 2097152
    s_cmp_ge_u32 s40, 540
    s_cselect_b32 s52, 0x40000000, s52
    s_lshl_b32 s43, s42, 2
    s_add_u32 s43, s43, 1
    s_mul_hi_u32 s44, s43, 0x33333334
    s_mul_i32 s56, s44, 5
    s_sub_u32 s45, s43, s56
    s_mul_i32 s44, s44, 54
    s_add_u32 s44, s44, s41
    s_mul_i32 s44, s44, 5
    s_add_u32 s44, s44, s45
    s_lshl_b32 s44, s44, 10
    s_add_u32 s53, s44, 2097152
    s_cmp_ge_u32 s40, 540
    s_cselect_b32 s53, 0x40000000, s53
    s_lshl_b32 s43, s42, 2
    s_add_u32 s43, s43, 2
    s_mul_hi_u32 s44, s43, 0x33333334
    s_mul_i32 s56, s44, 5
    s_sub_u32 s45, s43, s56
    s_mul_i32 s44, s44, 54
    s_add_u32 s44, s44, s41
    s_mul_i32 s44, s44, 5
    s_add_u32 s44, s44, s45
    s_lshl_b32 s44, s44, 10
    s_add_u32 s54, s44, 2097152
    s_cmp_ge_u32 s40, 540
    s_cselect_b32 s54, 0x40000000, s54
    s_lshl_b32 s43, s42, 2
    s_add_u32 s43, s43, 3
    s_mul_hi_u32 s44, s43, 0x33333334
    s_mul_i32 s56, s44, 5
    s_sub_u32 s45, s43, s56
    s_mul_i32 s44, s44, 54
    s_add_u32 s44, s44, s41
    s_mul_i32 s44, s44, 5
    s_add_u32 s44, s44, s45
    s_lshl_b32 s44, s44, 10
    s_add_u32 s55, s44, 2097152
    s_cmp_ge_u32 s40, 540
    s_cselect_b32 s55, 0x40000000, s55
    v_add_u32 v16, 16384, v10
    v_add_u32 v17, 16896, v10
adaLN_cond__sliding_block__swiglu_ffn__prompt_kernel_j_30:
    s_sub_u32 s40, s25, 360
    s_cmp_lt_u32 s40, 200
    s_mov_b32 s6, s46
    s_cselect_b32 s12, 0x40000000, s52
    s_cselect_b32 s52, s52, 0x40000000
    s_mov_b32 s7, s47
    s_cselect_b32 s13, 0x40000000, s53
    s_cselect_b32 s53, s53, 0x40000000
    s_mov_b32 s8, s48
    s_cselect_b32 s14, 0x40000000, s54
    s_cselect_b32 s54, s54, 0x40000000
    s_mov_b32 s9, s49
    s_cselect_b32 s15, 0x40000000, s55
    s_cselect_b32 s55, s55, 0x40000000
    s_add_u32 s44, s68, 0
    s_add_u32 m0, s69, 0
    s_nop 0
    buffer_load_dwordx4 v4, s[36:39], s44 offen  lds
    s_add_u32 s44, s44, 14336
    buffer_load_dwordx4 v4, s[36:39], s44 offen offset:1024  lds
    s_add_u32 s44, s44, 14336
    buffer_load_dwordx4 v4, s[36:39], s44 offen offset:2048  lds
    s_add_u32 s44, s44, 14336
    buffer_load_dwordx4 v4, s[36:39], s44 offen offset:3072  lds
    s_add_u32 s44, s68, 245760
    s_add_u32 m0, s69, 16384
    s_nop 0
    buffer_load_dwordx4 v4, s[36:39], s44 offen  lds
    s_add_u32 s44, s44, 14336
    buffer_load_dwordx4 v4, s[36:39], s44 offen offset:1024  lds
    s_add_u32 s44, s44, 14336
    buffer_load_dwordx4 v4, s[36:39], s44 offen offset:2048  lds
    s_add_u32 s44, s44, 14336
    buffer_load_dwordx4 v4, s[36:39], s44 offen offset:3072  lds
    s_add_u32 s44, s68, 491520
    s_add_u32 m0, s69, 32768
    s_nop 0
    buffer_load_dwordx4 v4, s[36:39], s44 offen  lds
    s_add_u32 s44, s44, 14336
    buffer_load_dwordx4 v4, s[36:39], s44 offen offset:1024  lds
    s_add_u32 s44, s44, 14336
    buffer_load_dwordx4 v4, s[36:39], s44 offen offset:2048  lds
    s_add_u32 s44, s44, 14336
    buffer_load_dwordx4 v4, s[36:39], s44 offen offset:3072  lds
    s_add_u32 s44, s68, 737280
    s_add_u32 m0, s69, 49152
    s_nop 0
    buffer_load_dwordx4 v4, s[36:39], s44 offen  lds
    s_add_u32 s44, s44, 14336
    buffer_load_dwordx4 v4, s[36:39], s44 offen offset:1024  lds
    s_add_u32 s44, s44, 14336
    buffer_load_dwordx4 v4, s[36:39], s44 offen offset:2048  lds
    s_add_u32 s44, s44, 14336
    buffer_load_dwordx4 v4, s[36:39], s44 offen offset:3072  lds
    s_add_u32 s44, s68, 983040
    s_add_u32 m0, s69, 65536
    s_nop 0
    buffer_load_dwordx4 v4, s[36:39], s44 offen  lds
    s_add_u32 s44, s44, 14336
    buffer_load_dwordx4 v4, s[36:39], s44 offen offset:1024  lds
    s_add_u32 s44, s44, 14336
    buffer_load_dwordx4 v4, s[36:39], s44 offen offset:2048  lds
    s_add_u32 s44, s44, 14336
    buffer_load_dwordx4 v4, s[36:39], s44 offen offset:3072  lds
    s_add_u32 s44, s68, 1228800
    s_add_u32 m0, s69, 81920
    s_nop 0
    buffer_load_dwordx4 v4, s[36:39], s44 offen  lds
    s_add_u32 s44, s44, 14336
    buffer_load_dwordx4 v4, s[36:39], s44 offen offset:1024  lds
    s_add_u32 s44, s44, 14336
    buffer_load_dwordx4 v4, s[36:39], s44 offen offset:2048  lds
    s_add_u32 s44, s44, 14336
    buffer_load_dwordx4 v4, s[36:39], s44 offen offset:3072  lds
    s_add_u32 s44, s68, 1474560
    s_add_u32 m0, s69, 98304
    s_nop 0
    buffer_load_dwordx4 v4, s[36:39], s44 offen  lds
    s_add_u32 s44, s44, 14336
    buffer_load_dwordx4 v4, s[36:39], s44 offen offset:1024  lds
    s_add_u32 s44, s44, 14336
    buffer_load_dwordx4 v4, s[36:39], s44 offen offset:2048  lds
    s_add_u32 s44, s44, 14336
    buffer_load_dwordx4 v4, s[36:39], s44 offen offset:3072  lds
    s_and_b32 s40, s60, 3
    s_cmp_eq_u32 s40, 0
    s_cbranch_scc1 adaLN_cond__sliding_block__swiglu_ffn__prompt_kernel_nn_32
    s_waitcnt lgkmcnt(0)
    s_add_u32 s64, s64, 0x9E3779B1
    s_add_u32 s65, s65, 0x85EBCA77
adaLN_cond__sliding_block__swiglu_ffn__prompt_kernel_nn_32:
    s_waitcnt vmcnt(28)
    ds_read_b64_tr_b16 v[96:97], v14 offset:0
    ds_read_b64_tr_b16 v[98:99], v15 offset:0
    ds_read_b64_tr_b16 v[100:101], v14 offset:32
    ds_read_b64_tr_b16 v[102:103], v15 offset:32
    ds_read_b64_tr_b16 v[104:105], v14 offset:64
    ds_read_b64_tr_b16 v[106:107], v15 offset:64
    ds_read_b64_tr_b16 v[108:109], v14 offset:96
    ds_read_b64_tr_b16 v[110:111], v15 offset:96
    s_waitcnt lgkmcnt(0)
    ds_read_b64_tr_b16 v[112:113], v16 offset:0
    ds_read_b64_tr_b16 v[114:115], v17 offset:0
    ds_read_b64_tr_b16 v[116:117], v16 offset:32
    ds_read_b64_tr_b16 v[118:119], v17 offset:32
    ds_read_b64_tr_b16 v[120:121], v16 offset:64
    ds_read_b64_tr_b16 v[122:123], v17 offset:64
    ds_read_b64_tr_b16 v[124:125], v16 offset:96
    ds_read_b64_tr_b16 v[126:127], v17 offset:96
    s_waitcnt lgkmcnt(0)
    s_add_u32 s44, s68, 1720320
    s_add_u32 m0, s69, 114688
    s_nop 0
    buffer_load_dwordx4 v4, s[36:39], s44 offen  lds
    s_add_u32 s44, s44, 14336
    buffer_load_dwordx4 v4, s[36:39], s44 offen offset:1024  lds
    s_add_u32 s44, s44, 14336
    buffer_load_dwordx4 v4, s[36:39], s44 offen offset:2048  lds
    s_add_u32 s44, s44, 14336
    buffer_load_dwordx4 v4, s[36:39], s44 offen offset:3072  lds
    s_add_u32 s44, s68, 1966080
    s_add_u32 m0, s69, 131072
    s_nop 0
    buffer_load_dwordx4 v4, s[36:39], s44 offen  lds
    s_add_u32 s44, s44, 14336
    buffer_load_dwordx4 v4, s[36:39], s44 offen offset:1024  lds
    s_add_u32 s44, s44, 14336
    buffer_load_dwordx4 v4, s[36:39], s44 offen offset:2048  lds
    s_add_u32 s44, s44, 14336
    buffer_load_dwordx4 v4, s[36:39], s44 offen offset:3072  lds
    v_lshlrev_b32 v13, 4, v0
    s_waitcnt vmcnt(0)
    s_barrier
    s_barrier
    s_add_u32 s44, s68, 2211840
    s_add_u32 m0, s69, 0
    s_nop 0
    buffer_load_dwordx4 v4, s[36:39], s44 offen  lds
    s_add_u32 s44, s44, 14336
    buffer_load_dwordx4 v4, s[36:39], s44 offen offset:1024  lds
    s_add_u32 s44, s44, 14336
    buffer_load_dwordx4 v4, s[36:39], s44 offen offset:2048  lds
    s_add_u32 s44, s44, 14336
    buffer_load_dwordx4 v4, s[36:39], s44 offen offset:3072  lds
    v_lshlrev_b32 v13, 4, v0
    s_barrier
    s_cmp_lg_u32 s66, 0
    s_cbranch_scc1 adaLN_cond__sliding_block__swiglu_ffn__prompt_kernel_ca_33
    s_lshl_b32 s57, s60, 7
    s_add_u32 s57, s57, 802816
    s_mov_b64 s[50:51], 0
    s_atomic_add_x2 s[50:51], s[26:27], s57 glc
adaLN_cond__sliding_block__swiglu_ffn__prompt_kernel_ca_33:
    v_lshlrev_b32 v13, 4, v0
    s_barrier
    v_lshlrev_b32 v13, 4, v0
    s_cmp_lg_u32 s66, 0
    s_cbranch_scc1 adaLN_cond__sliding_block__swiglu_ffn__prompt_kernel_cp_34
    s_waitcnt lgkmcnt(0)
    s_sub_u32 s50, s50, s64
    s_subb_u32 s51, s51, s65
    s_cmp_eq_u64 s[50:51], 4
    s_cbranch_scc1 adaLN_cond__sliding_block__swiglu_ffn__prompt_kernel_cp_34
    s_lshl_b32 s57, s60, 7
    s_add_u32 s57, s57, 802816
    s_waitcnt lgkmcnt(0)
    s_mov_b32 s56, 0
adaLN_cond__sliding_block__swiglu_ffn__prompt_kernel_poll_35:
    s_mov_b64 s[58:59], 0
    s_atomic_add_x2 s[58:59], s[26:27], s57 glc
    s_waitcnt lgkmcnt(0)
    s_sub_u32 s58, s58, s64
    s_subb_u32 s59, s59, s65
    s_cmp_eq_u64 s[58:59], 4
    s_cbranch_scc1 adaLN_cond__sliding_block__swiglu_ffn__prompt_kernel_pdone_36
    s_add_u32 s56, s56, 1
    s_sleep 1
    s_cmp_lt_u32 s56, 0x8000
    s_cbranch_scc1 adaLN_cond__sliding_block__swiglu_ffn__prompt_kernel_poll_35
adaLN_cond__sliding_block__swiglu_ffn__prompt_kernel_pdone_36:
adaLN_cond__sliding_block__swiglu_ffn__prompt_kernel_cp_34:
    s_waitcnt vmcnt(0)
    s_barrier
    v_bfe_u32 v20, v0, 2, 1
    v_xor_b32 v20, 1, v20
    v_mul_u32_u24 v20, 1280, v20
    v_lshrrev_b32 v21, 4, v0
    v_lshl_add_u32 v20, v21, 4, v20
    buffer_load_dwordx4 v[24:27], v20, s[28:31], s18 offen sc1
    buffer_load_dwordx4 v[28:31], v20, s[28:31], s20 offen sc1
    v_lshlrev_b32 v13, 4, v0
    buffer_store_dwordx4 v[112:115], v13, s[28:31], s52 offen sc1
    buffer_store_dwordx4 v[116:119], v13, s[28:31], s53 offen sc1
    buffer_store_dwordx4 v[120:123], v13, s[28:31], s54 offen sc1
    buffer_store_dwordx4 v[124:127], v13, s[28:31], s55 offen sc1
    s_waitcnt vmcnt(4)
    v_lshlrev_b32 v21, 2, v0
    v_mfma_f32_16x16x32_bf16 v[160:163], v[24:27], v[96:99], 0
    v_mfma_f32_16x16x32_bf16 v[164:167], v[24:27], v[100:103], 0
    v_mfma_f32_16x16x32_bf16 v[168:171], v[24:27], v[104:107], 0
    v_mfma_f32_16x16x32_bf16 v[172:175], v[24:27], v[108:111], 0
    v_mfma_f32_16x16x32_bf16 v[176:179], v[28:31], v[112:115], 0
    v_mfma_f32_16x16x32_bf16 v[180:183], v[28:31], v[116:119], 0
    v_mfma_f32_16x16x32_bf16 v[184:187], v[28:31], v[120:123], 0
    v_mfma_f32_16x16x32_bf16 v[188:191], v[28:31], v[124:127], 0
    s_mov_b32 exec_hi, 0
    buffer_atomic_add_f32 v160, v21, s[28:31], s19 offen offset:0
    buffer_atomic_add_f32 v164, v21, s[28:31], s19 offen offset:256
    buffer_atomic_add_f32 v168, v21, s[28:31], s19 offen offset:512
    buffer_atomic_add_f32 v172, v21, s[28:31], s19 offen offset:768
    buffer_atomic_add_f32 v176, v21, s[28:31], s21 offen offset:0
    buffer_atomic_add_f32 v180, v21, s[28:31], s21 offen offset:256
    buffer_atomic_add_f32 v184, v21, s[28:31], s21 offen offset:512
    buffer_atomic_add_f32 v188, v21, s[28:31], s21 offen offset:768
    s_mov_b32 exec_hi, -1
    s_branch adaLN_cond__sliding_block__swiglu_ffn__prompt_kernel_p2_5
adaLN_cond__sliding_block__swiglu_ffn__prompt_kernel_c0_21:
hop_pad_3:
    s_cbranch_execz hop_back
    s_add_u32 s44, s68, 491520
    s_add_u32 m0, s69, 32768
    s_nop 0
    buffer_load_dwordx4 v4, s[36:39], s44 offen  lds
    s_add_u32 s44, s44, 14336
    buffer_load_dwordx4 v4, s[36:39], s44 offen offset:1024  lds
    s_add_u32 s44, s44, 14336
    buffer_load_dwordx4 v4, s[36:39], s44 offen offset:2048  lds
    s_add_u32 s44, s44, 14336
    buffer_load_dwordx4 v4, s[36:39], s44 offen offset:3072  lds
    s_add_u32 s44, s68, 737280
    s_add_u32 m0, s69, 49152
    s_nop 0
    buffer_load_dwordx4 v4, s[36:39], s44 offen  lds
    s_add_u32 s44, s44, 14336
    buffer_load_dwordx4 v4, s[36:39], s44 offen offset:1024  lds
    s_add_u32 s44, s44, 14336
    buffer_load_dwordx4 v4, s[36:39], s44 offen offset:2048  lds
    s_add_u32 s44, s44, 14336
    buffer_load_dwordx4 v4, s[36:39], s44 offen offset:3072  lds
    s_lshr_b32 s52, s52, 2
    s_waitcnt vmcnt(8)
    s_barrier
    s_cmp_lg_u32 s3, 1
    s_cbranch_scc1 adaLN_cond__sliding_block__swiglu_ffn__prompt_kernel_sig_37
    s_lshl_b32 s57, s52, 7
    s_add_u32 s57, s57, 790528
    s_atomic_add_x2 s[10:11], s[26:27], s57
adaLN_cond__sliding_block__swiglu_ffn__prompt_kernel_sig_37:
    s_add_u32 s44, s68, 983040
    s_add_u32 m0, s69, 65536
    s_nop 0
    buffer_load_dwordx4 v4, s[36:39], s44 offen  lds
    s_add_u32 s44, s44, 14336
    buffer_load_dwordx4 v4, s[36:39], s44 offen offset:1024  lds
    s_add_u32 s44, s44, 14336
    buffer_load_dwordx4 v4, s[36:39], s44 offen offset:2048  lds
    s_add_u32 s44, s44, 14336
    buffer_load_dwordx4 v4, s[36:39], s44 offen offset:3072  lds
    s_add_u32 s44, s68, 1228800
    s_add_u32 m0, s69, 81920
    s_nop 0
    buffer_load_dwordx4 v4, s[36:39], s44 offen  lds
    s_add_u32 s44, s44, 14336
    buffer_load_dwordx4 v4, s[36:39], s44 offen offset:1024  lds
    s_add_u32 s44, s44, 14336
    buffer_load_dwordx4 v4, s[36:39], s44 offen offset:2048  lds
    s_add_u32 s44, s44, 14336
    buffer_load_dwordx4 v4, s[36:39], s44 offen offset:3072  lds
    s_barrier
    s_add_u32 s44, s68, 1474560
    s_add_u32 m0, s69, 98304
    s_nop 0
    buffer_load_dwordx4 v4, s[36:39], s44 offen  lds
    s_add_u32 s44, s44, 14336
    buffer_load_dwordx4 v4, s[36:39], s44 offen offset:1024  lds
    s_add_u32 s44, s44, 14336
    buffer_load_dwordx4 v4, s[36:39], s44 offen offset:2048  lds
    s_add_u32 s44, s44, 14336
    buffer_load_dwordx4 v4, s[36:39], s44 offen offset:3072  lds
    s_add_u32 s44, s68, 1720320
    s_add_u32 m0, s69, 114688
    s_nop 0
    buffer_load_dwordx4 v4, s[36:39], s44 offen  lds
    s_add_u32 s44, s44, 14336
    buffer_load_dwordx4 v4, s[36:39], s44 offen offset:1024  lds
    s_add_u32 s44, s44, 14336
    buffer_load_dwordx4 v4, s[36:39], s44 offen offset:2048  lds
    s_add_u32 s44, s44, 14336
    buffer_load_dwordx4 v4, s[36:39], s44 offen offset:3072  lds
    s_waitcnt vmcnt(16)
    s_barrier
    s_add_u32 s44, s68, 1966080
    s_add_u32 m0, s69, 131072
    s_nop 0
    buffer_load_dwordx4 v4, s[36:39], s44 offen  lds
    s_add_u32 s44, s44, 14336
    buffer_load_dwordx4 v4, s[36:39], s44 offen offset:1024  lds
    s_add_u32 s44, s44, 14336
    buffer_load_dwordx4 v4, s[36:39], s44 offen offset:2048  lds
    s_add_u32 s44, s44, 14336
    buffer_load_dwordx4 v4, s[36:39], s44 offen offset:3072  lds
    s_add_u32 s44, s68, 2211840
    s_add_u32 m0, s69, 0
    s_nop 0
    buffer_load_dwordx4 v4, s[36:39], s44 offen  lds
    s_add_u32 s44, s44, 14336
    buffer_load_dwordx4 v4, s[36:39], s44 offen offset:1024  lds
    s_add_u32 s44, s44, 14336
    buffer_load_dwordx4 v4, s[36:39], s44 offen offset:2048  lds
    s_add_u32 s44, s44, 14336
    buffer_load_dwordx4 v4, s[36:39], s44 offen offset:3072  lds
    s_waitcnt vmcnt(16)
    s_barrier
    s_waitcnt vmcnt(8)
    s_barrier
    s_waitcnt vmcnt(0)
    s_barrier
    s_mov_b32 s101, 3
    s_mov_b64 exec, 0
    s_cmp_eq_u32 s66, 0
    s_cbranch_scc1 hop_pad_8
    s_cmp_eq_u32 s66, 1
    s_cbranch_scc1 hop_pad_9
    s_cmp_eq_u32 s66, 2
    s_cbranch_scc1 hop_pad_10
    s_cmp_eq_u32 s66, 3
    s_cbranch_scc1 hop_pad_11
hop_ret_3:
    s_mov_b64 exec, -1
    s_mov_b32 s101, 0
    s_mov_b32 s6, 0x40000000
    s_mov_b32 s12, 0x40000000
    s_mov_b32 s7, 0x40000000
    s_mov_b32 s13, 0x40000000
    s_mov_b32 s8, 0x40000000
    s_mov_b32 s14, 0x40000000
    s_mov_b32 s9, 0x40000000
    s_mov_b32 s15, 0x40000000
    s_branch adaLN_cond__sliding_block__swiglu_ffn__prompt_kernel_p2_5
adaLN_cond__sliding_block__swiglu_ffn__prompt_kernel_idle_20:
    s_mov_b32 s6, 0x40000000
    s_mov_b32 s12, 0x40000000
    s_mov_b32 s7, 0x40000000
    s_mov_b32 s13, 0x40000000
    s_mov_b32 s8, 0x40000000
    s_mov_b32 s14, 0x40000000
    s_mov_b32 s9, 0x40000000
    s_mov_b32 s15, 0x40000000
    s_and_b32 s40, s60, 3
    s_cmp_eq_u32 s40, 1
    s_cbranch_scc1 adaLN_cond__sliding_block__swiglu_ffn__prompt_kernel_p2_5
    s_add_u32 s40, s60, 2
    s_lshr_b32 s40, s40, 2
    s_sub_u32 s40, s60, s40
    s_mul_i32 s25, s40, 36
    s_add_u32 s25, s25, s66
    s_mul_i32 s67, s66, 36864
    s_add_u32 s67, s67, 0
    v_lshrrev_b32 v14, 3, v0
    v_and_b32 v15, 7, v0
    v_mul_u32_u24 v8, 3456, v14
    v_lshl_add_u32 v8, v15, 4, v8
    v_mul_u32_u24 v9, 1280, v14
    v_lshl_add_u32 v9, v15, 4, v9
    v_bfe_u32 v14, v0, 2, 2
    v_and_b32 v15, 3, v0
    v_lshlrev_b32 v15, 3, v15
    v_lshl_add_u32 v15, v14, 7, v15
    v_add_u32 v15, s67, v15
    v_lshrrev_b32 v14, 4, v0
    v_lshl_add_u32 v10, v14, 10, v15
    v_bfe_u32 v13, v0, 4, 1
    v_lshrrev_b32 v14, 5, v0
    v_lshl_add_u32 v11, v14, 11, v15
    v_lshl_add_u32 v11, v13, 9, v11
    v_lshl_add_u32 v12, v13, 11, v15
    v_lshl_add_u32 v12, v14, 10, v12
    s_mov_b32 s50, 0
adaLN_cond__sliding_block__swiglu_ffn__prompt_kernel_il_38:
    s_lshl_b32 s40, s50, 2
    s_add_u32 s40, s40, s25
    s_mov_b32 s32, s16
    s_and_b32 s33, s17, 0xffff
    s_mov_b32 s34, 0x21c000
    s_mov_b32 s35, 0x20000
    s_mul_hi_u32 s41, s40, 0x1999999a
    s_mul_i32 s43, s41, 10
    s_sub_u32 s42, s40, s43
    s_mul_i32 s43, s41, 40960
    s_lshl_b32 s44, s42, 7
    s_add_u32 s43, s43, s44
    s_add_u32 m0, s67, 0
    s_nop 0
    buffer_load_dwordx4 v9, s[32:35], s43 offen nt lds
    s_add_u32 s43, s43, 9216
    buffer_load_dwordx4 v9, s[32:35], s43 offen offset:1024 nt lds
    s_add_u32 s43, s43, 9216
    buffer_load_dwordx4 v9, s[32:35], s43 offen offset:2048 nt lds
    s_add_u32 s43, s43, 9216
    buffer_load_dwordx4 v9, s[32:35], s43 offen offset:3072 nt lds
    s_add_u32 s67, s67, 4096
    s_add_u32 s50, s50, 1
    s_cmp_lt_u32 s50, 9
    s_cbranch_scc1 adaLN_cond__sliding_block__swiglu_ffn__prompt_kernel_il_38
    s_waitcnt vmcnt(0)
    s_mov_b32 s50, 0
adaLN_cond__sliding_block__swiglu_ffn__prompt_kernel_io_42:
    s_lshl_b32 s40, s50, 2
    s_add_u32 s40, s40, s25
    s_mov_b32 s32, s16
    s_and_b32 s33, s17, 0xffff
    s_mov_b32 s34, 0x21c000
    s_mov_b32 s35, 0x20000
    s_mul_hi_u32 s41, s40, 0x1999999a
    s_mul_i32 s43, s41, 10
    s_sub_u32 s42, s40, s43
    s_mul_i32 s43, s41, 40960
    s_lshl_b32 s44, s42, 7
    s_add_u32 s43, s43, s44
    s_lshl_b32 s43, s42, 2
    s_add_u32 s43, s43, 0
    s_mul_hi_u32 s44, s43, 0x33333334
    s_mul_i32 s56, s44, 5
    s_sub_u32 s45, s43, s56
    s_mul_i32 s44, s44, 54
    s_add_u32 s44, s44, s41
    s_mul_i32 s44, s44, 5
    s_add_u32 s44, s44, s45
    s_lshl_b32 s44, s44, 10
    s_add_u32 s46, s44, 2097152
    s_cmp_ge_u32 s40, 540
    s_cselect_b32 s46, 0x40000000, s46
    s_lshl_b32 s43, s42, 2
    s_add_u32 s43, s43, 1
    s_mul_hi_u32 s44, s43, 0x33333334
    s_mul_i32 s56, s44, 5
    s_sub_u32 s45, s43, s56
    s_mul_i32 s44, s44, 54
    s_add_u32 s44, s44, s41
    s_mul_i32 s44, s44, 5
    s_add_u32 s44, s44, s45
    s_lshl_b32 s44, s44, 10
    s_add_u32 s47, s44, 2097152
    s_cmp_ge_u32 s40, 540
    s_cselect_b32 s47, 0x40000000, s47
    s_lshl_b32 s43, s42, 2
    s_add_u32 s43, s43, 2
    s_mul_hi_u32 s44, s43, 0x33333334
    s_mul_i32 s56, s44, 5
    s_sub_u32 s45, s43, s56
    s_mul_i32 s44, s44, 54
    s_add_u32 s44, s44, s41
    s_mul_i32 s44, s44, 5
    s_add_u32 s44, s44, s45
    s_lshl_b32 s44, s44, 10
    s_add_u32 s48, s44, 2097152
    s_cmp_ge_u32 s40, 540
    s_cselect_b32 s48, 0x40000000, s48
    s_lshl_b32 s43, s42, 2
    s_add_u32 s43, s43, 3
    s_mul_hi_u32 s44, s43, 0x33333334
    s_mul_i32 s56, s44, 5
    s_sub_u32 s45, s43, s56
    s_mul_i32 s44, s44, 54
    s_add_u32 s44, s44, s41
    s_mul_i32 s44, s44, 5
    s_add_u32 s44, s44, s45
    s_lshl_b32 s44, s44, 10
    s_add_u32 s49, s44, 2097152
    s_cmp_ge_u32 s40, 540
    s_cselect_b32 s49, 0x40000000, s49
    v_add_u32 v14, 0, v10
    v_add_u32 v15, 512, v10
    ds_read_b64_tr_b16 v[96:97], v14 offset:0
    ds_read_b64_tr_b16 v[98:99], v15 offset:0
    ds_read_b64_tr_b16 v[100:101], v14 offset:32
    ds_read_b64_tr_b16 v[102:103], v15 offset:32
    ds_read_b64_tr_b16 v[104:105], v14 offset:64
    ds_read_b64_tr_b16 v[106:107], v15 offset:64
    ds_read_b64_tr_b16 v[108:109], v14 offset:96
    ds_read_b64_tr_b16 v[110:111], v15 offset:96
    s_waitcnt lgkmcnt(0)
    v_lshlrev_b32 v13, 4, v0
    buffer_store_dwordx4 v[96:99], v13, s[28:31], s46 offen sc1
    buffer_store_dwordx4 v[100:103], v13, s[28:31], s47 offen sc1
    buffer_store_dwordx4 v[104:107], v13, s[28:31], s48 offen sc1
    buffer_store_dwordx4 v[108:111], v13, s[28:31], s49 offen sc1
    v_add_u32 v10, 4096, v10
    s_add_u32 s50, s50, 1
    s_cmp_lt_u32 s50, 9
    s_cbranch_scc1 adaLN_cond__sliding_block__swiglu_ffn__prompt_kernel_io_42
    s_branch adaLN_cond__sliding_block__swiglu_ffn__prompt_kernel_p2_5
adaLN_cond__sliding_block__swiglu_ffn__prompt_kernel_cc_19:
hop_pad_4:
    s_cbranch_execz hop_back
    s_and_b32 s40, s60, 3
    s_cmp_eq_u32 s40, 1
    s_cbranch_scc1 adaLN_cond__sliding_block__swiglu_ffn__prompt_kernel_ms_46
    s_cmp_ge_u32 s61, 15
    s_cbranch_scc1 adaLN_cond__sliding_block__swiglu_ffn__prompt_kernel_ms_46
    s_add_u32 s40, s60, 2
    s_lshr_b32 s40, s40, 2
    s_sub_u32 s40, s60, s40
    s_mul_i32 s40, s40, 15
    s_add_u32 s40, s40, s61
    s_sub_u32 s52, 179, s40
    s_cmp_ge_u32 s52, 160
    s_cbranch_scc1 adaLN_cond__sliding_block__swiglu_ffn__prompt_kernel_ms_46
    s_mov_b32 s32, s20
    s_and_b32 s33, s21, 0xffff
    s_mov_b32 s34, 0x4b0000
    s_mov_b32 s35, 0x20000
    s_mov_b32 s36, s18
    s_and_b32 s37, s19, 0xffff
    s_mov_b32 s38, 0x500
    s_mov_b32 s39, 0x20000
    s_mul_hi_u32 s50, s52, 0x6666667
    s_mul_i32 s42, s50, 40
    s_sub_u32 s51, s52, s42
    s_mul_i32 s42, s50, 160
    s_mul_i32 s43, s66, 40
    s_add_u32 s42, s42, s43
    v_lshrrev_b32 v5, 3, v0
    v_and_b32 v6, 7, v0
    v_add_u32 v5, s42, v5
    v_mul_u32_u24 v7, 7680, v5
    v_lshl_add_u32 v7, v6, 4, v7
    v_lshlrev_b32 v5, 1, v5
    s_lshl_b32 s44, s51, 7
    s_add_u32 s44, s44, 2560
    buffer_load_ushort v32, v5, s[36:39], 0 offen offset:0
    buffer_load_ushort v33, v5, s[36:39], 0 offen offset:16
    buffer_load_ushort v34, v5, s[36:39], 0 offen offset:32
    buffer_load_ushort v35, v5, s[36:39], 0 offen offset:48
    buffer_load_ushort v36, v5, s[36:39], 0 offen offset:64
    buffer_load_dwordx4 v[40:43], v7, s[32:35], s44 offen nt
    s_add_u32 s44, s44, 61440
    buffer_load_dwordx4 v[44:47], v7, s[32:35], s44 offen nt
    s_add_u32 s44, s44, 61440
    buffer_load_dwordx4 v[48:51], v7, s[32:35], s44 offen nt
hop_pad_5:
    s_cbranch_execz hop_back
    s_add_u32 s44, s44, 61440
    buffer_load_dwordx4 v[52:55], v7, s[32:35], s44 offen nt
    s_add_u32 s44, s44, 61440
    buffer_load_dwordx4 v[56:59], v7, s[32:35], s44 offen nt
    s_waitcnt vmcnt(5)
    v_lshlrev_b32 v32, 16, v32
    v_mul_f32 v64, 0xbfb8aa3b, v32
    v_lshlrev_b32 v33, 16, v33
    v_mul_f32 v65, 0xbfb8aa3b, v33
    v_lshlrev_b32 v34, 16, v34
    v_mul_f32 v66, 0xbfb8aa3b, v34
    v_lshlrev_b32 v35, 16, v35
    v_mul_f32 v67, 0xbfb8aa3b, v35
    v_lshlrev_b32 v36, 16, v36
    v_mul_f32 v68, 0xbfb8aa3b, v36
    v_exp_f32 v64, v64
    v_exp_f32 v65, v65
    v_exp_f32 v66, v66
    v_exp_f32 v67, v67
    v_exp_f32 v68, v68
    v_add_f32 v64, 1.0, v64
    v_add_f32 v65, 1.0, v65
    v_add_f32 v66, 1.0, v66
    v_add_f32 v67, 1.0, v67
    v_add_f32 v68, 1.0, v68
    v_rcp_f32 v64, v64
    v_rcp_f32 v65, v65
    v_rcp_f32 v66, v66
    v_rcp_f32 v67, v67
    v_rcp_f32 v68, v68
    v_mul_f32 v32, v64, v32
    v_mul_f32 v33, v65, v33
    v_mul_f32 v34, v66, v34
    v_mul_f32 v35, v67, v35
    v_mul_f32 v36, v68, v36
    v_cvt_pk_bf16_f32 v32, v32, v32
    v_lshlrev_b32 v32, 16, v32
    v_cvt_pk_bf16_f32 v33, v33, v33
    v_lshlrev_b32 v33, 16, v33
    v_cvt_pk_bf16_f32 v34, v34, v34
    v_lshlrev_b32 v34, 16, v34
    v_cvt_pk_bf16_f32 v35, v35, v35
    v_lshlrev_b32 v35, 16, v35
    v_cvt_pk_bf16_f32 v36, v36, v36
    v_lshlrev_b32 v36, 16, v36
    s_waitcnt vmcnt(0)
    v_lshlrev_b32 v72, 16, v40
    v_and_b32 v73, 0xffff0000, v40
    v_mul_f32 v64, v72, v32
    v_mul_f32 v65, v73, v32
    v_lshlrev_b32 v72, 16, v41
    v_and_b32 v73, 0xffff0000, v41
    v_mul_f32 v66, v72, v32
    v_mul_f32 v67, v73, v32
    v_lshlrev_b32 v72, 16, v42
    v_and_b32 v73, 0xffff0000, v42
    v_mul_f32 v68, v72, v32
    v_mul_f32 v69, v73, v32
    v_lshlrev_b32 v72, 16, v43
    v_and_b32 v73, 0xffff0000, v43
    v_mul_f32 v70, v72, v32
    v_mul_f32 v71, v73, v32
    v_lshlrev_b32 v72, 16, v44
    v_and_b32 v73, 0xffff0000, v44
    v_fmac_f32 v64, v72, v33
    v_fmac_f32 v65, v73, v33
    v_lshlrev_b32 v72, 16, v45
    v_and_b32 v73, 0xffff0000, v45
    v_fmac_f32 v66, v72, v33
    v_fmac_f32 v67, v73, v33
    v_lshlrev_b32 v72, 16, v46
    v_and_b32 v73, 0xffff0000, v46
    v_fmac_f32 v68, v72, v33
    v_fmac_f32 v69, v73, v33
    v_lshlrev_b32 v72, 16, v47
    v_and_b32 v73, 0xffff0000, v47
    v_fmac_f32 v70, v72, v33
    v_fmac_f32 v71, v73, v33
    v_lshlrev_b32 v72, 16, v48
    v_and_b32 v73, 0xffff0000, v48
    v_fmac_f32 v64, v72, v34
    v_fmac_f32 v65, v73, v34
    v_lshlrev_b32 v72, 16, v49
    v_and_b32 v73, 0xffff0000, v49
    v_fmac_f32 v66, v72, v34
    v_fmac_f32 v67, v73, v34
    v_lshlrev_b32 v72, 16, v50
    v_and_b32 v73, 0xffff0000, v50
    v_fmac_f32 v68, v72, v34
    v_fmac_f32 v69, v73, v34
    v_lshlrev_b32 v72, 16, v51
    v_and_b32 v73, 0xffff0000, v51
    v_fmac_f32 v70, v72, v34
    v_fmac_f32 v71, v73, v34
    v_lshlrev_b32 v72, 16, v52
    v_and_b32 v73, 0xffff0000, v52
    v_fmac_f32 v64, v72, v35
    v_fmac_f32 v65, v73, v35
    v_lshlrev_b32 v72, 16, v53
    v_and_b32 v73, 0xffff0000, v53
    v_fmac_f32 v66, v72, v35
    v_fmac_f32 v67, v73, v35
    v_lshlrev_b32 v72, 16, v54
    v_and_b32 v73, 0xffff0000, v54
    v_fmac_f32 v68, v72, v35
    v_fmac_f32 v69, v73, v35
    v_lshlrev_b32 v72, 16, v55
    v_and_b32 v73, 0xffff0000, v55
    v_fmac_f32 v70, v72, v35
    v_fmac_f32 v71, v73, v35
    v_lshlrev_b32 v72, 16, v56
    v_and_b32 v73, 0xffff0000, v56
    v_fmac_f32 v64, v72, v36
    v_fmac_f32 v65, v73, v36
    v_lshlrev_b32 v72, 16, v57
    v_and_b32 v73, 0xffff0000, v57
    v_fmac_f32 v66, v72, v36
    v_fmac_f32 v67, v73, v36
    v_lshlrev_b32 v72, 16, v58
    v_and_b32 v73, 0xffff0000, v58
    v_fmac_f32 v68, v72, v36
    v_fmac_f32 v69, v73, v36
    v_lshlrev_b32 v72, 16, v59
    v_and_b32 v73, 0xffff0000, v59
    v_fmac_f32 v70, v72, v36
    v_fmac_f32 v71, v73, v36
    v_permlane32_swap_b32 v64, v68
    v_permlane32_swap_b32 v65, v69
    v_permlane32_swap_b32 v66, v70
    v_permlane32_swap_b32 v67, v71
    v_add_f32 v64, v64, v68
    v_add_f32 v65, v65, v69
    v_add_f32 v66, v66, v70
    v_add_f32 v67, v67, v71
    s_nop 0
    v_permlane16_swap_b32 v64, v66
    v_permlane16_swap_b32 v65, v67
    v_add_f32 v64, v64, v66
    v_add_f32 v65, v65, v67
    s_nop 0
    v_add_f32_dpp v64, v64, v64 row_ror:8 row_mask:0xf bank_mask:0xf
    v_add_f32_dpp v65, v65, v65 row_ror:8 row_mask:0xf bank_mask:0xf
    v_lshrrev_b32 v72, 4, v0
    v_lshlrev_b32 v72, 3, v72
    v_and_b32 v73, 7, v0
    v_lshl_add_u32 v72, v73, 5, v72
    s_lshl_b32 s45, s66, 8
    s_add_u32 s45, s45, 147456
    v_add_u32 v72, s45, v72
    ds_write_b64 v72, v[64:65]
    s_waitcnt lgkmcnt(0)
    v_mov_b32 v250, 162824
    v_mov_b32 v251, 1
    s_mov_b64 exec, 1
    ds_add_rtn_u32 v251, v250, v251
    s_mov_b64 exec, -1
    s_waitcnt lgkmcnt(0)
    v_readfirstlane_b32 s56, v251
    s_nop 0
    s_cmp_lg_u32 s56, 3
    s_cbranch_scc1 adaLN_cond__sliding_block__swiglu_ffn__prompt_kernel_ms_46
    v_lshlrev_b32 v72, 3, v0
    v_add_u32 v72, 147456, v72
    v_lshlrev_b32 v73, 4, v0
    ds_read_b64 v[64:65], v72 offset:0
    ds_read_b64 v[66:67], v72 offset:256
    ds_read_b64 v[68:69], v72 offset:512
    ds_read_b64 v[70:71], v72 offset:768
    s_lshl_b32 s42, s52, 9
    s_waitcnt lgkmcnt(0)
    v_pk_add_f32 v[64:65], v[64:65], v[66:67]
    v_pk_add_f32 v[68:69], v[68:69], v[70:71]
    v_pk_add_f32 v[64:65], v[64:65], v[68:69]
    v_mov_b32 v66, s64
    v_mov_b32 v67, s65
    s_mov_b32 exec_hi, 0
    buffer_store_dwordx4 v[64:67], v73, s[28:31], s42 offen sc1
    s_mov_b32 exec_hi, -1
adaLN_cond__sliding_block__swiglu_ffn__prompt_kernel_ms_46:
    s_and_b32 s40, s60, 3
    s_cmp_eq_u32 s40, 1
    s_cbranch_scc1 adaLN_cond__sliding_block__swiglu_ffn__prompt_kernel_h2_47
    s_mov_b32 s101, 4
    s_mov_b64 exec, 0
    s_cmp_eq_u32 s66, 0
    s_cbranch_scc1 hop_pad_8
    s_cmp_eq_u32 s66, 1
    s_cbranch_scc1 hop_pad_9
    s_cmp_eq_u32 s66, 2
    s_cbranch_scc1 hop_pad_10
    s_cmp_eq_u32 s66, 3
    s_cbranch_scc1 hop_pad_11
hop_ret_4:
    s_mov_b64 exec, -1
    s_mov_b32 s101, 0
adaLN_cond__sliding_block__swiglu_ffn__prompt_kernel_h2_47:
    v_lshlrev_b32 v1, 4, v0
    v_bfe_u32 v12, v0, 2, 2
    v_bfe_u32 v13, v0, 4, 1
    v_and_b32 v14, 3, v0
    v_lshrrev_b32 v15, 5, v0
    v_lshlrev_b32 v2, 6, v12
    v_lshl_add_u32 v2, v13, 5, v2
    v_lshl_add_u32 v2, v14, 3, v2
    v_lshl_add_u32 v2, v12, 8, v2
    v_lshl_add_u32 v8, v15, 11, v2
    v_xor_b32 v9, 64, v8
    v_xor_b32 v10, 128, v8
    v_xor_b32 v11, 192, v8
    v_and_b32 v14, 31, v0
    v_add_u32 v13, 0, v15
    v_lshlrev_b32 v12, 2, v13
    v_xor_b32 v12, v12, v14
    v_lshlrev_b32 v12, 3, v12
    v_lshl_add_u32 v4, v13, 8, v12
    v_add_u32 v13, 2, v15
    v_lshlrev_b32 v12, 2, v13
    v_xor_b32 v12, v12, v14
    v_lshlrev_b32 v12, 3, v12
    v_lshl_add_u32 v5, v13, 8, v12
    v_add_u32 v13, 4, v15
    v_lshlrev_b32 v12, 2, v13
    v_xor_b32 v12, v12, v14
    v_lshlrev_b32 v12, 3, v12
    v_lshl_add_u32 v6, v13, 8, v12
    v_add_u32 v13, 6, v15
    v_lshlrev_b32 v12, 2, v13
    v_xor_b32 v12, v12, v14
    v_lshlrev_b32 v12, 3, v12
    v_lshl_add_u32 v7, v13, 8, v12
    s_lshl_b32 s44, s60, 2
    s_add_u32 s44, s44, s66
    s_mul_i32 s45, s44, 40960
    s_add_u32 s45, s45, 35651584
    s_mul_i32 s48, s44, 122880
    s_lshl_b32 s49, s61, 13
    s_add_u32 s48, s48, s49
    s_add_u32 s48, s48, 10485760
    s_add_u32 s49, s48, 4096
    s_mov_b32 s46, 1.0
    s_cmp_lt_u32 s61, 5
    s_cselect_b32 s46, 0x3ea52b5c, s46
    s_mov_b32 s47, s46
    s_cmp_lt_u32 s61, 15
    s_cbranch_scc1 adaLN_cond__sliding_block__swiglu_ffn__prompt_kernel_work_48
    s_and_b32 s45, s60, 3
    s_cmp_lg_u32 s45, 1
    s_cbranch_scc1 adaLN_cond__sliding_block__swiglu_ffn__prompt_kernel_work_48
    s_sub_u32 s44, s60, 1
    s_add_u32 s44, s44, s66
    s_mul_i32 s45, s44, 1280
    s_lshr_b32 s46, s60, 2
    s_cmp_eq_u32 s46, 2
    s_cselect_b32 s46, 1.0, 0
    s_mov_b32 exec_hi, 0xff
    s_mov_b32 s58, 0
adaLN_cond__sliding_block__swiglu_ffn__prompt_kernel_gp_49:
    s_add_u32 s47, s45, 0
    buffer_load_dwordx4 v[32:35], v1, s[28:31], s47 offen offset:0 sc1
    s_add_u32 s47, s45, 20480
    buffer_load_dwordx4 v[36:39], v1, s[28:31], s47 offen offset:0 sc1
    s_add_u32 s47, s45, 40960
    buffer_load_dwordx4 v[40:43], v1, s[28:31], s47 offen offset:0 sc1
    s_add_u32 s47, s45, 61440
    buffer_load_dwordx4 v[44:47], v1, s[28:31], s47 offen offset:0 sc1
    s_add_u32 s47, s45, 0
    buffer_load_dwordx4 v[48:51], v1, s[28:31], s47 offen offset:640 sc1
    s_add_u32 s47, s45, 20480
    buffer_load_dwordx4 v[52:55], v1, s[28:31], s47 offen offset:640 sc1
    s_add_u32 s47, s45, 40960
    buffer_load_dwordx4 v[56:59], v1, s[28:31], s47 offen offset:640 sc1
    s_add_u32 s47, s45, 61440
    buffer_load_dwordx4 v[60:63], v1, s[28:31], s47 offen offset:640 sc1
    s_waitcnt vmcnt(7)
    v_xor_b32 v34, s64, v34
    v_xor_b32 v35, s65, v35
    v_or_b32 v9, v34, v35
    s_waitcnt vmcnt(6)
    v_xor_b32 v38, s64, v38
    v_xor_b32 v39, s65, v39
    v_or3_b32 v9, v9, v38, v39
    s_waitcnt vmcnt(5)
    v_xor_b32 v42, s64, v42
    v_xor_b32 v43, s65, v43
    v_or3_b32 v9, v9, v42, v43
    s_waitcnt vmcnt(4)
    v_xor_b32 v46, s64, v46
    v_xor_b32 v47, s65, v47
    v_or3_b32 v9, v9, v46, v47
    s_waitcnt vmcnt(3)
    v_xor_b32 v50, s64, v50
    v_xor_b32 v51, s65, v51
    v_or3_b32 v9, v9, v50, v51
    s_waitcnt vmcnt(2)
    v_xor_b32 v54, s64, v54
    v_xor_b32 v55, s65, v55
    v_or3_b32 v9, v9, v54, v55
    s_waitcnt vmcnt(1)
    v_xor_b32 v58, s64, v58
    v_xor_b32 v59, s65, v59
    v_or3_b32 v9, v9, v58, v59
    s_waitcnt vmcnt(0)
    v_xor_b32 v62, s64, v62
    v_xor_b32 v63, s65, v63
    v_or3_b32 v9, v9, v62, v63
    v_cmp_ne_u32 vcc, 0, v9
    s_nop 4
    s_cbranch_vccz adaLN_cond__sliding_block__swiglu_ffn__prompt_kernel_gd_50
    s_add_u32 s58, s58, 1
    s_sleep 8
    s_cmp_lt_u32 s58, 0x8000
    s_cbranch_scc1 adaLN_cond__sliding_block__swiglu_ffn__prompt_kernel_gp_49
adaLN_cond__sliding_block__swiglu_ffn__prompt_kernel_gd_50:
    v_lshlrev_b32 v2, 3, v0
    v_lshlrev_b32 v3, 2, v0
    s_mul_i32 s45, s44, 640
    s_add_u32 s45, s45, 98304
    s_mul_i32 s47, s44, 320
    s_add_u32 s47, s47, 108544
    v_pk_add_f32 v[32:33], v[32:33], v[36:37]
    v_pk_add_f32 v[40:41], v[40:41], v[44:45]
    v_pk_add_f32 v[32:33], v[32:33], v[40:41]
    v_cvt_pk_bf16_f32 v34, v32, v33
    v_lshlrev_b32 v32, 16, v34
    v_and_b32 v33, 0xffff0000, v34
    v_add_f32 v32, s46, v32
    v_add_f32 v33, s46, v33
    v_cvt_pk_bf16_f32 v34, v32, v33
    v_lshlrev_b32 v32, 16, v34
    v_and_b32 v33, 0xffff0000, v34
    buffer_store_dwordx2 v[32:33], v2, s[28:31], s45 offen offset:0 sc1
    buffer_store_dword v34, v3, s[28:31], s47 offen offset:0 sc1
    v_pk_add_f32 v[48:49], v[48:49], v[52:53]
    v_pk_add_f32 v[56:57], v[56:57], v[60:61]
    v_pk_add_f32 v[48:49], v[48:49], v[56:57]
    v_cvt_pk_bf16_f32 v50, v48, v49
    v_lshlrev_b32 v48, 16, v50
    v_and_b32 v49, 0xffff0000, v50
    v_add_f32 v48, s46, v48
    v_add_f32 v49, s46, v49
    v_cvt_pk_bf16_f32 v50, v48, v49
    v_lshlrev_b32 v48, 16, v50
    v_and_b32 v49, 0xffff0000, v50
    buffer_store_dwordx2 v[48:49], v2, s[28:31], s45 offen offset:320 sc1
    buffer_store_dword v50, v3, s[28:31], s47 offen offset:160 sc1
    s_mov_b64 exec, -1
    s_mov_b32 s45, 0
    s_waitcnt vmcnt(0)
    v_mov_b32 v250, 162836
    v_mov_b32 v251, 1
    s_mov_b64 exec, 1
    ds_add_rtn_u32 v251, v250, v251
    s_mov_b64 exec, -1
    s_waitcnt lgkmcnt(0)
    v_readfirstlane_b32 s56, v251
    s_nop 0
    s_cmp_lg_u32 s56, 3
    s_cbranch_scc1 adaLN_cond__sliding_block__swiglu_ffn__prompt_kernel_sig_51
    s_lshl_b32 s57, s45, 7
    s_add_u32 s57, s57, 802816
    s_atomic_add_x2 s[10:11], s[26:27], s57
    s_add_u32 s57, s57, 128
    s_atomic_add_x2 s[10:11], s[26:27], s57
    s_add_u32 s57, s57, 128
    s_atomic_add_x2 s[10:11], s[26:27], s57
    s_add_u32 s57, s57, 128
    s_atomic_add_x2 s[10:11], s[26:27], s57
    s_add_u32 s57, s57, 128
    s_atomic_add_x2 s[10:11], s[26:27], s57
    s_add_u32 s57, s57, 128
    s_atomic_add_x2 s[10:11], s[26:27], s57
    s_add_u32 s57, s57, 128
    s_atomic_add_x2 s[10:11], s[26:27], s57
    s_add_u32 s57, s57, 128
    s_atomic_add_x2 s[10:11], s[26:27], s57
    s_add_u32 s57, s57, 128
    s_atomic_add_x2 s[10:11], s[26:27], s57
    s_add_u32 s57, s57, 128
    s_atomic_add_x2 s[10:11], s[26:27], s57
    s_add_u32 s57, s57, 128
    s_atomic_add_x2 s[10:11], s[26:27], s57
    s_add_u32 s57, s57, 128
    s_atomic_add_x2 s[10:11], s[26:27], s57
    s_add_u32 s57, s57, 128
    s_atomic_add_x2 s[10:11], s[26:27], s57
    s_add_u32 s57, s57, 128
    s_atomic_add_x2 s[10:11], s[26:27], s57
    s_add_u32 s57, s57, 128
    s_atomic_add_x2 s[10:11], s[26:27], s57
    s_add_u32 s57, s57, 128
    s_atomic_add_x2 s[10:11], s[26:27], s57
adaLN_cond__sliding_block__swiglu_ffn__prompt_kernel_sig_51:
    s_branch adaLN_cond__sliding_block__swiglu_ffn__prompt_kernel_p2_5
adaLN_cond__sliding_block__swiglu_ffn__prompt_kernel_work_48:
hop_pad_6:
    s_cbranch_execz hop_back
    s_cmp_lg_u32 s3, 0
    s_cbranch_scc1 adaLN_cond__sliding_block__swiglu_ffn__prompt_kernel_np_52
    s_lshl_b32 s57, s60, 7
    s_add_u32 s57, s57, 790528
    s_waitcnt lgkmcnt(0)
    s_mov_b32 s56, 0
adaLN_cond__sliding_block__swiglu_ffn__prompt_kernel_poll_53:
    s_mov_b64 s[58:59], 0
    s_atomic_add_x2 s[58:59], s[26:27], s57 glc
    s_waitcnt lgkmcnt(0)
    s_sub_u32 s58, s58, s64
    s_subb_u32 s59, s59, s65
    s_cmp_eq_u64 s[58:59], 4
    s_cbranch_scc1 adaLN_cond__sliding_block__swiglu_ffn__prompt_kernel_pdone_54
    s_add_u32 s56, s56, 1
    s_sleep 1
    s_cmp_lt_u32 s56, 0x8000
    s_cbranch_scc1 adaLN_cond__sliding_block__swiglu_ffn__prompt_kernel_poll_53
adaLN_cond__sliding_block__swiglu_ffn__prompt_kernel_pdone_54:
adaLN_cond__sliding_block__swiglu_ffn__prompt_kernel_np_52:
    s_cmp_ge_u32 s61, 15
    s_cbranch_scc1 adaLN_cond__sliding_block__swiglu_ffn__prompt_kernel_p2_5
    s_barrier
    buffer_load_dwordx4 v[112:115], v1, s[28:31], s45 offen offset:0 sc1
    buffer_load_dwordx4 v[116:119], v1, s[28:31], s45 offen offset:1024 sc1
    buffer_load_dwordx4 v[120:123], v1, s[28:31], s45 offen offset:2048 sc1
    buffer_load_dwordx4 v[124:127], v1, s[28:31], s45 offen offset:3072 sc1
    s_add_u32 s45, s45, 4096
    buffer_load_dwordx4 v[128:131], v1, s[28:31], s45 offen offset:0 sc1
    buffer_load_dwordx4 v[132:135], v1, s[28:31], s45 offen offset:1024 sc1
    buffer_load_dwordx4 v[136:139], v1, s[28:31], s45 offen offset:2048 sc1
    buffer_load_dwordx4 v[140:143], v1, s[28:31], s45 offen offset:3072 sc1
    s_add_u32 s45, s45, 4096
    buffer_load_dwordx4 v[144:147], v1, s[28:31], s45 offen offset:0 sc1
    buffer_load_dwordx4 v[148:151], v1, s[28:31], s45 offen offset:1024 sc1
    ds_read_b64_tr_b16 v[12:13], v8 offset:0
    ds_read_b64_tr_b16 v[14:15], v8 offset:1024
    ds_read_b64_tr_b16 v[16:17], v9 offset:0
    ds_read_b64_tr_b16 v[18:19], v9 offset:1024
    ds_read_b64_tr_b16 v[20:21], v10 offset:0
    ds_read_b64_tr_b16 v[22:23], v10 offset:1024
    ds_read_b64_tr_b16 v[24:25], v11 offset:0
    ds_read_b64_tr_b16 v[26:27], v11 offset:1024
    ds_read_b64_tr_b16 v[28:29], v8 offset:4096
    ds_read_b64_tr_b16 v[30:31], v8 offset:5120
    ds_read_b64_tr_b16 v[32:33], v9 offset:4096
    ds_read_b64_tr_b16 v[34:35], v9 offset:5120
    ds_read_b64_tr_b16 v[36:37], v10 offset:4096
    ds_read_b64_tr_b16 v[38:39], v10 offset:5120
    s_waitcnt vmcnt(9)
    s_waitcnt lgkmcnt(10)
    v_mfma_f32_32x32x16_bf16 v[48:63], v[12:15], v[112:115], 0
    ds_read_b64_tr_b16 v[40:41], v11 offset:4096
    ds_read_b64_tr_b16 v[42:43], v11 offset:5120
    v_mfma_f32_32x32x16_bf16 v[64:79], v[16:19], v[112:115], 0
    ds_read_b64_tr_b16 v[44:45], v8 offset:8192
    ds_read_b64_tr_b16 v[46:47], v8 offset:9216
    s_waitcnt lgkmcnt(10)
    v_mfma_f32_32x32x16_bf16 v[80:95], v[20:23], v[112:115], 0
    ds_read_b64_tr_b16 v[12:13], v9 offset:8192
    ds_read_b64_tr_b16 v[14:15], v9 offset:9216
    buffer_load_dwordx4 v[152:155], v1, s[28:31], s45 offen offset:2048 sc1
    v_mfma_f32_32x32x16_bf16 v[96:111], v[24:27], v[112:115], 0
    ds_read_b64_tr_b16 v[16:17], v10 offset:8192
    ds_read_b64_tr_b16 v[18:19], v10 offset:9216
    s_waitcnt vmcnt(9)
    s_waitcnt lgkmcnt(10)
    v_mfma_f32_32x32x16_bf16 v[48:63], v[28:31], v[116:119], v[48:63]
    ds_read_b64_tr_b16 v[20:21], v11 offset:8192
    ds_read_b64_tr_b16 v[22:23], v11 offset:9216
    v_mfma_f32_32x32x16_bf16 v[64:79], v[32:35], v[116:119], v[64:79]
    ds_read_b64_tr_b16 v[24:25], v8 offset:12288
    ds_read_b64_tr_b16 v[26:27], v8 offset:13312
    buffer_load_dwordx4 v[156:159], v1, s[28:31], s45 offen offset:3072 sc1
    s_waitcnt lgkmcnt(10)
    v_mfma_f32_32x32x16_bf16 v[80:95], v[36:39], v[116:119], v[80:95]
    ds_read_b64_tr_b16 v[28:29], v9 offset:12288
    ds_read_b64_tr_b16 v[30:31], v9 offset:13312
    v_mfma_f32_32x32x16_bf16 v[96:111], v[40:43], v[116:119], v[96:111]
    ds_read_b64_tr_b16 v[32:33], v10 offset:12288
    ds_read_b64_tr_b16 v[34:35], v10 offset:13312
    s_waitcnt vmcnt(9)
    s_waitcnt lgkmcnt(10)
    v_mfma_f32_32x32x16_bf16 v[48:63], v[44:47], v[120:123], v[48:63]
    ds_read_b64_tr_b16 v[36:37], v11 offset:12288
    ds_read_b64_tr_b16 v[38:39], v11 offset:13312
    s_add_u32 s45, s45, 4096
    buffer_load_dwordx4 v[160:163], v1, s[28:31], s45 offen offset:0 sc1
    v_mfma_f32_32x32x16_bf16 v[64:79], v[12:15], v[120:123], v[64:79]
    ds_read_b64_tr_b16 v[40:41], v8 offset:16384
    ds_read_b64_tr_b16 v[42:43], v8 offset:17408
    s_waitcnt lgkmcnt(10)
    v_mfma_f32_32x32x16_bf16 v[80:95], v[16:19], v[120:123], v[80:95]
    ds_read_b64_tr_b16 v[44:45], v9 offset:16384
    ds_read_b64_tr_b16 v[46:47], v9 offset:17408
    v_mfma_f32_32x32x16_bf16 v[96:111], v[20:23], v[120:123], v[96:111]
    ds_read_b64_tr_b16 v[12:13], v10 offset:16384
    ds_read_b64_tr_b16 v[14:15], v10 offset:17408
    buffer_load_dwordx4 v[164:167], v1, s[28:31], s45 offen offset:1024 sc1
    s_waitcnt vmcnt(10)
    s_waitcnt lgkmcnt(10)
    v_mfma_f32_32x32x16_bf16 v[48:63], v[24:27], v[124:127], v[48:63]
    ds_read_b64_tr_b16 v[16:17], v8 offset:20480
    ds_read_b64_tr_b16 v[18:19], v8 offset:21504
    v_mfma_f32_32x32x16_bf16 v[64:79], v[28:31], v[124:127], v[64:79]
    ds_read_b64_tr_b16 v[20:21], v9 offset:20480
    ds_read_b64_tr_b16 v[22:23], v9 offset:21504
    s_waitcnt lgkmcnt(10)
    v_mfma_f32_32x32x16_bf16 v[80:95], v[32:35], v[124:127], v[80:95]
    ds_read_b64_tr_b16 v[24:25], v10 offset:20480
    ds_read_b64_tr_b16 v[26:27], v10 offset:21504
    buffer_load_dwordx4 v[168:171], v1, s[28:31], s45 offen offset:2048 sc1
    v_mfma_f32_32x32x16_bf16 v[96:111], v[36:39], v[124:127], v[96:111]
    ds_read_b64_tr_b16 v[28:29], v8 offset:24576
    ds_read_b64_tr_b16 v[30:31], v8 offset:25600
    s_waitcnt vmcnt(10)
    s_waitcnt lgkmcnt(10)
    v_mfma_f32_32x32x16_bf16 v[48:63], v[40:43], v[128:131], v[48:63]
    ds_read_b64_tr_b16 v[32:33], v9 offset:24576
    ds_read_b64_tr_b16 v[34:35], v9 offset:25600
    v_mfma_f32_32x32x16_bf16 v[64:79], v[44:47], v[128:131], v[64:79]
    ds_read_b64_tr_b16 v[36:37], v10 offset:24576
    ds_read_b64_tr_b16 v[38:39], v10 offset:25600
    buffer_load_dwordx4 v[172:175], v1, s[28:31], s45 offen offset:3072 sc1
    s_waitcnt lgkmcnt(10)
    v_mfma_f32_32x32x16_bf16 v[80:95], v[12:15], v[128:131], v[80:95]
    ds_read_b64_tr_b16 v[40:41], v8 offset:28672
    ds_read_b64_tr_b16 v[42:43], v8 offset:29696
    s_waitcnt vmcnt(10)
    v_mfma_f32_32x32x16_bf16 v[48:63], v[16:19], v[132:135], v[48:63]
    ds_read_b64_tr_b16 v[44:45], v9 offset:28672
    ds_read_b64_tr_b16 v[46:47], v9 offset:29696
    s_waitcnt lgkmcnt(10)
    v_mfma_f32_32x32x16_bf16 v[64:79], v[20:23], v[132:135], v[64:79]
    ds_read_b64_tr_b16 v[12:13], v10 offset:28672
    ds_read_b64_tr_b16 v[14:15], v10 offset:29696
    s_add_u32 s45, s45, 4096
    buffer_load_dwordx4 v[176:179], v1, s[28:31], s45 offen offset:0 sc1
    v_mfma_f32_32x32x16_bf16 v[80:95], v[24:27], v[132:135], v[80:95]
    s_barrier
    ds_read_b64_tr_b16 v[16:17], v8 offset:32768
    ds_read_b64_tr_b16 v[18:19], v8 offset:33792
    s_waitcnt vmcnt(10)
    s_waitcnt lgkmcnt(10)
    v_mfma_f32_32x32x16_bf16 v[48:63], v[28:31], v[136:139], v[48:63]
    ds_read_b64_tr_b16 v[20:21], v9 offset:32768
    ds_read_b64_tr_b16 v[22:23], v9 offset:33792
    v_mfma_f32_32x32x16_bf16 v[64:79], v[32:35], v[136:139], v[64:79]
    ds_read_b64_tr_b16 v[24:25], v10 offset:32768
    ds_read_b64_tr_b16 v[26:27], v10 offset:33792
    buffer_load_dwordx4 v[180:183], v1, s[28:31], s45 offen offset:1024 sc1
    s_waitcnt lgkmcnt(10)
    v_mfma_f32_32x32x16_bf16 v[80:95], v[36:39], v[136:139], v[80:95]
    ds_read_b64_tr_b16 v[28:29], v8 offset:36864
    ds_read_b64_tr_b16 v[30:31], v8 offset:37888
    s_waitcnt vmcnt(10)
    v_mfma_f32_32x32x16_bf16 v[48:63], v[40:43], v[140:143], v[48:63]
    ds_read_b64_tr_b16 v[32:33], v9 offset:36864
    ds_read_b64_tr_b16 v[34:35], v9 offset:37888
    s_waitcnt lgkmcnt(10)
    v_mfma_f32_32x32x16_bf16 v[64:79], v[44:47], v[140:143], v[64:79]
    ds_read_b64_tr_b16 v[36:37], v10 offset:36864
    ds_read_b64_tr_b16 v[38:39], v10 offset:37888
    buffer_load_dwordx4 v[184:187], v1, s[28:31], s45 offen offset:2048 sc1
    v_mfma_f32_32x32x16_bf16 v[80:95], v[12:15], v[140:143], v[80:95]
    ds_read_b64_tr_b16 v[40:41], v8 offset:40960
    ds_read_b64_tr_b16 v[42:43], v8 offset:41984
    s_waitcnt vmcnt(10)
    s_waitcnt lgkmcnt(10)
    v_mfma_f32_32x32x16_bf16 v[48:63], v[16:19], v[144:147], v[48:63]
    ds_read_b64_tr_b16 v[44:45], v9 offset:40960
    ds_read_b64_tr_b16 v[46:47], v9 offset:41984
    v_mfma_f32_32x32x16_bf16 v[64:79], v[20:23], v[144:147], v[64:79]
    ds_read_b64_tr_b16 v[12:13], v10 offset:40960
    ds_read_b64_tr_b16 v[14:15], v10 offset:41984
    buffer_load_dwordx4 v[188:191], v1, s[28:31], s45 offen offset:3072 sc1
    s_waitcnt lgkmcnt(10)
    v_mfma_f32_32x32x16_bf16 v[80:95], v[24:27], v[144:147], v[80:95]
    ds_read_b64_tr_b16 v[16:17], v8 offset:45056
    ds_read_b64_tr_b16 v[18:19], v8 offset:46080
    s_waitcnt vmcnt(10)
    v_mfma_f32_32x32x16_bf16 v[48:63], v[28:31], v[148:151], v[48:63]
    ds_read_b64_tr_b16 v[20:21], v9 offset:45056
    ds_read_b64_tr_b16 v[22:23], v9 offset:46080
    s_waitcnt lgkmcnt(10)
    v_mfma_f32_32x32x16_bf16 v[64:79], v[32:35], v[148:151], v[64:79]
    ds_read_b64_tr_b16 v[24:25], v10 offset:45056
    ds_read_b64_tr_b16 v[26:27], v10 offset:46080
    s_add_u32 s45, s45, 4096
    buffer_load_dwordx4 v[192:195], v1, s[28:31], s45 offen offset:0 sc1
    v_mfma_f32_32x32x16_bf16 v[80:95], v[36:39], v[148:151], v[80:95]
    ds_read_b64_tr_b16 v[28:29], v8 offset:49152
    ds_read_b64_tr_b16 v[30:31], v8 offset:50176
    s_waitcnt vmcnt(10)
    s_waitcnt lgkmcnt(10)
    v_mfma_f32_32x32x16_bf16 v[48:63], v[40:43], v[152:155], v[48:63]
    ds_read_b64_tr_b16 v[32:33], v9 offset:49152
    ds_read_b64_tr_b16 v[34:35], v9 offset:50176
    v_mfma_f32_32x32x16_bf16 v[64:79], v[44:47], v[152:155], v[64:79]
    ds_read_b64_tr_b16 v[36:37], v10 offset:49152
    ds_read_b64_tr_b16 v[38:39], v10 offset:50176
    buffer_load_dwordx4 v[196:199], v1, s[28:31], s45 offen offset:1024 sc1
    s_waitcnt lgkmcnt(10)
    v_mfma_f32_32x32x16_bf16 v[80:95], v[12:15], v[152:155], v[80:95]
    ds_read_b64_tr_b16 v[40:41], v8 offset:53248
    ds_read_b64_tr_b16 v[42:43], v8 offset:54272
    s_waitcnt vmcnt(10)
    v_mfma_f32_32x32x16_bf16 v[48:63], v[16:19], v[156:159], v[48:63]
    ds_read_b64_tr_b16 v[44:45], v9 offset:53248
    ds_read_b64_tr_b16 v[46:47], v9 offset:54272
    s_waitcnt lgkmcnt(10)
    v_mfma_f32_32x32x16_bf16 v[64:79], v[20:23], v[156:159], v[64:79]
    ds_read_b64_tr_b16 v[12:13], v10 offset:53248
    ds_read_b64_tr_b16 v[14:15], v10 offset:54272
    buffer_load_dwordx4 v[200:203], v1, s[28:31], s45 offen offset:2048 sc1
    v_mfma_f32_32x32x16_bf16 v[80:95], v[24:27], v[156:159], v[80:95]
    ds_read_b64_tr_b16 v[16:17], v8 offset:57344
    ds_read_b64_tr_b16 v[18:19], v8 offset:58368
    s_waitcnt vmcnt(10)
    s_waitcnt lgkmcnt(10)
    v_mfma_f32_32x32x16_bf16 v[48:63], v[28:31], v[160:163], v[48:63]
    ds_read_b64_tr_b16 v[20:21], v9 offset:57344
    ds_read_b64_tr_b16 v[22:23], v9 offset:58368
    v_mfma_f32_32x32x16_bf16 v[64:79], v[32:35], v[160:163], v[64:79]
    ds_read_b64_tr_b16 v[24:25], v10 offset:57344
    ds_read_b64_tr_b16 v[26:27], v10 offset:58368
    buffer_load_dwordx4 v[204:207], v1, s[28:31], s45 offen offset:3072 sc1
    s_waitcnt lgkmcnt(10)
    v_mfma_f32_32x32x16_bf16 v[80:95], v[36:39], v[160:163], v[80:95]
    ds_read_b64_tr_b16 v[28:29], v8 offset:61440
    ds_read_b64_tr_b16 v[30:31], v8 offset:62464
    s_waitcnt vmcnt(10)
    v_mfma_f32_32x32x16_bf16 v[48:63], v[40:43], v[164:167], v[48:63]
    ds_read_b64_tr_b16 v[32:33], v9 offset:61440
    ds_read_b64_tr_b16 v[34:35], v9 offset:62464
    s_waitcnt lgkmcnt(10)
    v_mfma_f32_32x32x16_bf16 v[64:79], v[44:47], v[164:167], v[64:79]
    ds_read_b64_tr_b16 v[36:37], v10 offset:61440
    ds_read_b64_tr_b16 v[38:39], v10 offset:62464
    s_add_u32 s45, s45, 4096
    buffer_load_dwordx4 v[208:211], v1, s[28:31], s45 offen offset:0 sc1
    v_mfma_f32_32x32x16_bf16 v[80:95], v[12:15], v[164:167], v[80:95]
    s_barrier
    v_add_u32 v8, 0x10000, v8
    ds_read_b64_tr_b16 v[40:41], v8 offset:0
    ds_read_b64_tr_b16 v[42:43], v8 offset:1024
    s_waitcnt vmcnt(10)
    s_waitcnt lgkmcnt(10)
    v_mfma_f32_32x32x16_bf16 v[48:63], v[16:19], v[168:171], v[48:63]
    v_add_u32 v9, 0x10000, v9
    ds_read_b64_tr_b16 v[44:45], v9 offset:0
    ds_read_b64_tr_b16 v[46:47], v9 offset:1024
    v_mfma_f32_32x32x16_bf16 v[64:79], v[20:23], v[168:171], v[64:79]
    v_add_u32 v10, 0x10000, v10
    ds_read_b64_tr_b16 v[12:13], v10 offset:0
    ds_read_b64_tr_b16 v[14:15], v10 offset:1024
    buffer_load_dwordx4 v[212:215], v1, s[28:31], s45 offen offset:1024 sc1
    s_waitcnt lgkmcnt(10)
    v_mfma_f32_32x32x16_bf16 v[80:95], v[24:27], v[168:171], v[80:95]
    ds_read_b64_tr_b16 v[16:17], v8 offset:4096
    ds_read_b64_tr_b16 v[18:19], v8 offset:5120
    s_waitcnt vmcnt(10)
    v_mfma_f32_32x32x16_bf16 v[48:63], v[28:31], v[172:175], v[48:63]
    ds_read_b64_tr_b16 v[20:21], v9 offset:4096
    ds_read_b64_tr_b16 v[22:23], v9 offset:5120
    s_waitcnt lgkmcnt(10)
    v_mfma_f32_32x32x16_bf16 v[64:79], v[32:35], v[172:175], v[64:79]
    ds_read_b64_tr_b16 v[24:25], v10 offset:4096
    ds_read_b64_tr_b16 v[26:27], v10 offset:5120
    buffer_load_dwordx4 v[216:219], v1, s[28:31], s45 offen offset:2048 sc1
    v_mfma_f32_32x32x16_bf16 v[80:95], v[36:39], v[172:175], v[80:95]
    ds_read_b64_tr_b16 v[28:29], v8 offset:8192
    ds_read_b64_tr_b16 v[30:31], v8 offset:9216
    s_waitcnt vmcnt(10)
    s_waitcnt lgkmcnt(10)
    v_mfma_f32_32x32x16_bf16 v[48:63], v[40:43], v[176:179], v[48:63]
    ds_read_b64_tr_b16 v[32:33], v9 offset:8192
    ds_read_b64_tr_b16 v[34:35], v9 offset:9216
hop_pad_7:
    s_cbranch_execz hop_back
    v_mfma_f32_32x32x16_bf16 v[64:79], v[44:47], v[176:179], v[64:79]
    ds_read_b64_tr_b16 v[36:37], v10 offset:8192
    ds_read_b64_tr_b16 v[38:39], v10 offset:9216
    buffer_load_dwordx4 v[220:223], v1, s[28:31], s45 offen offset:3072 sc1
    s_waitcnt lgkmcnt(10)
    v_mfma_f32_32x32x16_bf16 v[80:95], v[12:15], v[176:179], v[80:95]
    ds_read_b64_tr_b16 v[40:41], v8 offset:12288
    ds_read_b64_tr_b16 v[42:43], v8 offset:13312
    s_waitcnt vmcnt(10)
    v_mfma_f32_32x32x16_bf16 v[48:63], v[16:19], v[180:183], v[48:63]
    ds_read_b64_tr_b16 v[44:45], v9 offset:12288
    ds_read_b64_tr_b16 v[46:47], v9 offset:13312
    s_waitcnt lgkmcnt(10)
    v_mfma_f32_32x32x16_bf16 v[64:79], v[20:23], v[180:183], v[64:79]
    ds_read_b64_tr_b16 v[12:13], v10 offset:12288
    ds_read_b64_tr_b16 v[14:15], v10 offset:13312
    s_add_u32 s45, s45, 4096
    buffer_load_dwordx4 v[224:227], v1, s[28:31], s45 offen offset:0 sc1
    v_mfma_f32_32x32x16_bf16 v[80:95], v[24:27], v[180:183], v[80:95]
    ds_read_b64_tr_b16 v[16:17], v8 offset:16384
    ds_read_b64_tr_b16 v[18:19], v8 offset:17408
    s_waitcnt vmcnt(10)
    s_waitcnt lgkmcnt(10)
    v_mfma_f32_32x32x16_bf16 v[48:63], v[28:31], v[184:187], v[48:63]
    ds_read_b64_tr_b16 v[20:21], v9 offset:16384
    ds_read_b64_tr_b16 v[22:23], v9 offset:17408
    v_mfma_f32_32x32x16_bf16 v[64:79], v[32:35], v[184:187], v[64:79]
    ds_read_b64_tr_b16 v[24:25], v10 offset:16384
    ds_read_b64_tr_b16 v[26:27], v10 offset:17408
    buffer_load_dwordx4 v[228:231], v1, s[28:31], s45 offen offset:1024 sc1
    s_waitcnt lgkmcnt(10)
    v_mfma_f32_32x32x16_bf16 v[80:95], v[36:39], v[184:187], v[80:95]
    ds_read_b64_tr_b16 v[28:29], v8 offset:20480
    ds_read_b64_tr_b16 v[30:31], v8 offset:21504
    s_waitcnt vmcnt(10)
    v_mfma_f32_32x32x16_bf16 v[48:63], v[40:43], v[188:191], v[48:63]
    ds_read_b64_tr_b16 v[32:33], v9 offset:20480
    ds_read_b64_tr_b16 v[34:35], v9 offset:21504
    s_waitcnt lgkmcnt(10)
    v_mfma_f32_32x32x16_bf16 v[64:79], v[44:47], v[188:191], v[64:79]
    ds_read_b64_tr_b16 v[36:37], v10 offset:20480
    ds_read_b64_tr_b16 v[38:39], v10 offset:21504
    buffer_load_dwordx4 v[232:235], v1, s[28:31], s45 offen offset:2048 sc1
    v_mfma_f32_32x32x16_bf16 v[80:95], v[12:15], v[188:191], v[80:95]
    ds_read_b64_tr_b16 v[40:41], v8 offset:24576
    ds_read_b64_tr_b16 v[42:43], v8 offset:25600
    s_waitcnt vmcnt(10)
    s_waitcnt lgkmcnt(10)
    v_mfma_f32_32x32x16_bf16 v[48:63], v[16:19], v[192:195], v[48:63]
    ds_read_b64_tr_b16 v[44:45], v9 offset:24576
    ds_read_b64_tr_b16 v[46:47], v9 offset:25600
    v_mfma_f32_32x32x16_bf16 v[64:79], v[20:23], v[192:195], v[64:79]
    ds_read_b64_tr_b16 v[12:13], v10 offset:24576
    ds_read_b64_tr_b16 v[14:15], v10 offset:25600
    buffer_load_dwordx4 v[236:239], v1, s[28:31], s45 offen offset:3072 sc1
    s_waitcnt lgkmcnt(10)
    v_mfma_f32_32x32x16_bf16 v[80:95], v[24:27], v[192:195], v[80:95]
    ds_read_b64_tr_b16 v[16:17], v8 offset:28672
    ds_read_b64_tr_b16 v[18:19], v8 offset:29696
    s_waitcnt vmcnt(10)
    v_mfma_f32_32x32x16_bf16 v[48:63], v[28:31], v[196:199], v[48:63]
    ds_read_b64_tr_b16 v[20:21], v9 offset:28672
    ds_read_b64_tr_b16 v[22:23], v9 offset:29696
    s_waitcnt lgkmcnt(10)
    v_mfma_f32_32x32x16_bf16 v[64:79], v[32:35], v[196:199], v[64:79]
    ds_read_b64_tr_b16 v[24:25], v10 offset:28672
    ds_read_b64_tr_b16 v[26:27], v10 offset:29696
    s_add_u32 s45, s45, 4096
    buffer_load_dwordx4 v[240:243], v1, s[28:31], s45 offen offset:0 sc1
    v_mfma_f32_32x32x16_bf16 v[80:95], v[36:39], v[196:199], v[80:95]
    s_barrier
    ds_read_b64_tr_b16 v[28:29], v8 offset:32768
    ds_read_b64_tr_b16 v[30:31], v8 offset:33792
    s_waitcnt vmcnt(10)
    s_waitcnt lgkmcnt(10)
    v_mfma_f32_32x32x16_bf16 v[48:63], v[40:43], v[200:203], v[48:63]
    ds_read_b64_tr_b16 v[32:33], v9 offset:32768
    ds_read_b64_tr_b16 v[34:35], v9 offset:33792
    v_mfma_f32_32x32x16_bf16 v[64:79], v[44:47], v[200:203], v[64:79]
    ds_read_b64_tr_b16 v[36:37], v10 offset:32768
    ds_read_b64_tr_b16 v[38:39], v10 offset:33792
    buffer_load_dwordx4 v[244:247], v1, s[28:31], s45 offen offset:1024 sc1
    s_waitcnt lgkmcnt(10)
    v_mfma_f32_32x32x16_bf16 v[80:95], v[12:15], v[200:203], v[80:95]
    ds_read_b64_tr_b16 v[40:41], v8 offset:36864
    ds_read_b64_tr_b16 v[42:43], v8 offset:37888
    s_waitcnt vmcnt(10)
    v_mfma_f32_32x32x16_bf16 v[48:63], v[16:19], v[204:207], v[48:63]
    ds_read_b64_tr_b16 v[44:45], v9 offset:36864
    ds_read_b64_tr_b16 v[46:47], v9 offset:37888
    s_waitcnt lgkmcnt(10)
    v_mfma_f32_32x32x16_bf16 v[64:79], v[20:23], v[204:207], v[64:79]
    ds_read_b64_tr_b16 v[12:13], v10 offset:36864
    ds_read_b64_tr_b16 v[14:15], v10 offset:37888
    buffer_load_dwordx4 v[248:251], v1, s[28:31], s45 offen offset:2048 sc1
    v_mfma_f32_32x32x16_bf16 v[80:95], v[24:27], v[204:207], v[80:95]
    ds_read_b64_tr_b16 v[16:17], v8 offset:40960
    ds_read_b64_tr_b16 v[18:19], v8 offset:41984
    s_waitcnt vmcnt(10)
    s_waitcnt lgkmcnt(10)
    v_mfma_f32_32x32x16_bf16 v[48:63], v[28:31], v[208:211], v[48:63]
    ds_read_b64_tr_b16 v[20:21], v9 offset:40960
    ds_read_b64_tr_b16 v[22:23], v9 offset:41984
    v_mfma_f32_32x32x16_bf16 v[64:79], v[32:35], v[208:211], v[64:79]
    ds_read_b64_tr_b16 v[24:25], v10 offset:40960
    ds_read_b64_tr_b16 v[26:27], v10 offset:41984
    buffer_load_dwordx4 v[252:255], v1, s[28:31], s45 offen offset:3072 sc1
    s_waitcnt lgkmcnt(10)
    v_mfma_f32_32x32x16_bf16 v[80:95], v[36:39], v[208:211], v[80:95]
    ds_read_b64_tr_b16 v[28:29], v8 offset:45056
    ds_read_b64_tr_b16 v[30:31], v8 offset:46080
    s_waitcnt vmcnt(10)
    v_mfma_f32_32x32x16_bf16 v[48:63], v[40:43], v[212:215], v[48:63]
    ds_read_b64_tr_b16 v[32:33], v9 offset:45056
    ds_read_b64_tr_b16 v[34:35], v9 offset:46080
    s_waitcnt lgkmcnt(10)
    v_mfma_f32_32x32x16_bf16 v[64:79], v[44:47], v[212:215], v[64:79]
    ds_read_b64_tr_b16 v[36:37], v10 offset:45056
    ds_read_b64_tr_b16 v[38:39], v10 offset:46080
    s_add_u32 s45, s45, 4096
    buffer_load_dwordx4 v[112:115], v1, s[28:31], s45 offen offset:0 sc1
    v_mfma_f32_32x32x16_bf16 v[80:95], v[12:15], v[212:215], v[80:95]
    ds_read_b64_tr_b16 v[40:41], v8 offset:49152
    ds_read_b64_tr_b16 v[42:43], v8 offset:50176
    s_waitcnt vmcnt(10)
    s_waitcnt lgkmcnt(10)
    v_mfma_f32_32x32x16_bf16 v[48:63], v[16:19], v[216:219], v[48:63]
    ds_read_b64_tr_b16 v[44:45], v9 offset:49152
    ds_read_b64_tr_b16 v[46:47], v9 offset:50176
    v_mfma_f32_32x32x16_bf16 v[64:79], v[20:23], v[216:219], v[64:79]
    ds_read_b64_tr_b16 v[12:13], v10 offset:49152
    ds_read_b64_tr_b16 v[14:15], v10 offset:50176
    buffer_load_dwordx4 v[116:119], v1, s[28:31], s45 offen offset:1024 sc1
    s_waitcnt lgkmcnt(10)
    v_mfma_f32_32x32x16_bf16 v[80:95], v[24:27], v[216:219], v[80:95]
    ds_read_b64_tr_b16 v[16:17], v8 offset:53248
    ds_read_b64_tr_b16 v[18:19], v8 offset:54272
    s_waitcnt vmcnt(10)
    v_mfma_f32_32x32x16_bf16 v[48:63], v[28:31], v[220:223], v[48:63]
    ds_read_b64_tr_b16 v[20:21], v9 offset:53248
    ds_read_b64_tr_b16 v[22:23], v9 offset:54272
    s_waitcnt lgkmcnt(10)
    v_mfma_f32_32x32x16_bf16 v[64:79], v[32:35], v[220:223], v[64:79]
    ds_read_b64_tr_b16 v[24:25], v10 offset:53248
    ds_read_b64_tr_b16 v[26:27], v10 offset:54272
    buffer_load_dwordx4 v[120:123], v1, s[28:31], s45 offen offset:2048 sc1
    v_mfma_f32_32x32x16_bf16 v[80:95], v[36:39], v[220:223], v[80:95]
    ds_read_b64_tr_b16 v[28:29], v8 offset:57344
    ds_read_b64_tr_b16 v[30:31], v8 offset:58368
    s_waitcnt vmcnt(10)
    s_waitcnt lgkmcnt(10)
    v_mfma_f32_32x32x16_bf16 v[48:63], v[40:43], v[224:227], v[48:63]
    ds_read_b64_tr_b16 v[32:33], v9 offset:57344
    ds_read_b64_tr_b16 v[34:35], v9 offset:58368
    v_mfma_f32_32x32x16_bf16 v[64:79], v[44:47], v[224:227], v[64:79]
    ds_read_b64_tr_b16 v[36:37], v10 offset:57344
    ds_read_b64_tr_b16 v[38:39], v10 offset:58368
    buffer_load_dwordx4 v[124:127], v1, s[28:31], s45 offen offset:3072 sc1
    s_waitcnt lgkmcnt(10)
    v_mfma_f32_32x32x16_bf16 v[80:95], v[12:15], v[224:227], v[80:95]
    ds_read_b64_tr_b16 v[40:41], v8 offset:61440
    ds_read_b64_tr_b16 v[42:43], v8 offset:62464
    s_waitcnt vmcnt(10)
    v_mfma_f32_32x32x16_bf16 v[48:63], v[16:19], v[228:231], v[48:63]
    ds_read_b64_tr_b16 v[44:45], v9 offset:61440
    ds_read_b64_tr_b16 v[46:47], v9 offset:62464
    s_waitcnt lgkmcnt(10)
    v_mfma_f32_32x32x16_bf16 v[64:79], v[20:23], v[228:231], v[64:79]
    ds_read_b64_tr_b16 v[12:13], v10 offset:61440
    ds_read_b64_tr_b16 v[14:15], v10 offset:62464
    v_mfma_f32_32x32x16_bf16 v[80:95], v[24:27], v[228:231], v[80:95]
    s_barrier
    v_add_u32 v8, 0x10000, v8
    ds_read_b64_tr_b16 v[16:17], v8 offset:0
    ds_read_b64_tr_b16 v[18:19], v8 offset:1024
    s_waitcnt vmcnt(9)
    s_waitcnt lgkmcnt(10)
    v_mfma_f32_32x32x16_bf16 v[48:63], v[28:31], v[232:235], v[48:63]
    v_add_u32 v9, 0x10000, v9
    ds_read_b64_tr_b16 v[20:21], v9 offset:0
    ds_read_b64_tr_b16 v[22:23], v9 offset:1024
    v_mfma_f32_32x32x16_bf16 v[64:79], v[32:35], v[232:235], v[64:79]
    v_add_u32 v10, 0x10000, v10
    ds_read_b64_tr_b16 v[24:25], v10 offset:0
    ds_read_b64_tr_b16 v[26:27], v10 offset:1024
    s_waitcnt lgkmcnt(10)
    v_mfma_f32_32x32x16_bf16 v[80:95], v[36:39], v[232:235], v[80:95]
    ds_read_b64_tr_b16 v[28:29], v8 offset:4096
    ds_read_b64_tr_b16 v[30:31], v8 offset:5120
    s_waitcnt vmcnt(8)
    v_mfma_f32_32x32x16_bf16 v[48:63], v[40:43], v[236:239], v[48:63]
    ds_read_b64_tr_b16 v[32:33], v9 offset:4096
    ds_read_b64_tr_b16 v[34:35], v9 offset:5120
    s_waitcnt lgkmcnt(10)
    v_mfma_f32_32x32x16_bf16 v[64:79], v[44:47], v[236:239], v[64:79]
    ds_read_b64_tr_b16 v[36:37], v10 offset:4096
    ds_read_b64_tr_b16 v[38:39], v10 offset:5120
    v_mfma_f32_32x32x16_bf16 v[80:95], v[12:15], v[236:239], v[80:95]
    ds_read_b64_tr_b16 v[40:41], v8 offset:8192
    ds_read_b64_tr_b16 v[42:43], v8 offset:9216
    s_waitcnt vmcnt(7)
    s_waitcnt lgkmcnt(10)
    v_mfma_f32_32x32x16_bf16 v[48:63], v[16:19], v[240:243], v[48:63]
    ds_read_b64_tr_b16 v[44:45], v9 offset:8192
    ds_read_b64_tr_b16 v[46:47], v9 offset:9216
    v_mfma_f32_32x32x16_bf16 v[64:79], v[20:23], v[240:243], v[64:79]
    ds_read_b64_tr_b16 v[12:13], v10 offset:8192
    ds_read_b64_tr_b16 v[14:15], v10 offset:9216
    s_waitcnt lgkmcnt(10)
    v_mfma_f32_32x32x16_bf16 v[80:95], v[24:27], v[240:243], v[80:95]
    ds_read_b64_tr_b16 v[16:17], v8 offset:12288
    ds_read_b64_tr_b16 v[18:19], v8 offset:13312
    s_waitcnt vmcnt(6)
    v_mfma_f32_32x32x16_bf16 v[48:63], v[28:31], v[244:247], v[48:63]
    ds_read_b64_tr_b16 v[20:21], v9 offset:12288
    ds_read_b64_tr_b16 v[22:23], v9 offset:13312
    s_waitcnt lgkmcnt(10)
    v_mfma_f32_32x32x16_bf16 v[64:79], v[32:35], v[244:247], v[64:79]
    ds_read_b64_tr_b16 v[24:25], v10 offset:12288
    ds_read_b64_tr_b16 v[26:27], v10 offset:13312
    v_mfma_f32_32x32x16_bf16 v[80:95], v[36:39], v[244:247], v[80:95]
    v_add_u32 v8, 0xfffe0000, v8
    ds_read_b64_tr_b16 v[28:29], v8 offset:0
    ds_read_b64_tr_b16 v[30:31], v8 offset:1024
    s_waitcnt vmcnt(5)
    s_waitcnt lgkmcnt(10)
    v_mfma_f32_32x32x16_bf16 v[48:63], v[40:43], v[248:251], v[48:63]
    v_add_u32 v9, 0xfffe0000, v9
    ds_read_b64_tr_b16 v[32:33], v9 offset:0
    ds_read_b64_tr_b16 v[34:35], v9 offset:1024
    v_mfma_f32_32x32x16_bf16 v[64:79], v[44:47], v[248:251], v[64:79]
    v_add_u32 v10, 0xfffe0000, v10
    ds_read_b64_tr_b16 v[36:37], v10 offset:0
    ds_read_b64_tr_b16 v[38:39], v10 offset:1024
    s_waitcnt lgkmcnt(10)
    v_mfma_f32_32x32x16_bf16 v[80:95], v[12:15], v[248:251], v[80:95]
    ds_read_b64_tr_b16 v[40:41], v8 offset:4096
    ds_read_b64_tr_b16 v[42:43], v8 offset:5120
    s_waitcnt vmcnt(4)
    v_mfma_f32_32x32x16_bf16 v[48:63], v[16:19], v[252:255], v[48:63]
    ds_read_b64_tr_b16 v[44:45], v9 offset:4096
    ds_read_b64_tr_b16 v[46:47], v9 offset:5120
    s_waitcnt lgkmcnt(10)
    v_mfma_f32_32x32x16_bf16 v[64:79], v[20:23], v[252:255], v[64:79]
    ds_read_b64_tr_b16 v[12:13], v10 offset:4096
    ds_read_b64_tr_b16 v[14:15], v10 offset:5120
    v_mfma_f32_32x32x16_bf16 v[80:95], v[24:27], v[252:255], v[80:95]
    ds_read_b64_tr_b16 v[16:17], v8 offset:8192
    ds_read_b64_tr_b16 v[18:19], v8 offset:9216
    s_waitcnt vmcnt(3)
    s_waitcnt lgkmcnt(10)
    v_mfma_f32_32x32x16_bf16 v[48:63], v[28:31], v[112:115], v[48:63]
    ds_read_b64_tr_b16 v[20:21], v9 offset:8192
    ds_read_b64_tr_b16 v[22:23], v9 offset:9216
    v_mfma_f32_32x32x16_bf16 v[64:79], v[32:35], v[112:115], v[64:79]
    ds_read_b64_tr_b16 v[24:25], v10 offset:8192
    ds_read_b64_tr_b16 v[26:27], v10 offset:9216
    s_waitcnt lgkmcnt(10)
    v_mfma_f32_32x32x16_bf16 v[80:95], v[36:39], v[112:115], v[80:95]
    ds_read_b64_tr_b16 v[28:29], v8 offset:12288
    ds_read_b64_tr_b16 v[30:31], v8 offset:13312
    s_waitcnt vmcnt(2)
    v_mfma_f32_32x32x16_bf16 v[48:63], v[40:43], v[116:119], v[48:63]
    ds_read_b64_tr_b16 v[32:33], v9 offset:12288
    ds_read_b64_tr_b16 v[34:35], v9 offset:13312
    s_waitcnt lgkmcnt(10)
    v_mfma_f32_32x32x16_bf16 v[64:79], v[44:47], v[116:119], v[64:79]
    ds_read_b64_tr_b16 v[36:37], v10 offset:12288
    ds_read_b64_tr_b16 v[38:39], v10 offset:13312
    v_mfma_f32_32x32x16_bf16 v[80:95], v[12:15], v[116:119], v[80:95]
    ds_read_b64_tr_b16 v[40:41], v11 offset:16384
    ds_read_b64_tr_b16 v[42:43], v11 offset:17408
    s_waitcnt vmcnt(1)
    s_waitcnt lgkmcnt(10)
    v_mfma_f32_32x32x16_bf16 v[48:63], v[16:19], v[120:123], v[48:63]
    ds_read_b64_tr_b16 v[44:45], v11 offset:20480
    ds_read_b64_tr_b16 v[46:47], v11 offset:21504
    v_mfma_f32_32x32x16_bf16 v[64:79], v[20:23], v[120:123], v[64:79]
    ds_read_b64_tr_b16 v[12:13], v11 offset:24576
    ds_read_b64_tr_b16 v[14:15], v11 offset:25600
    s_waitcnt lgkmcnt(10)
    v_mfma_f32_32x32x16_bf16 v[80:95], v[24:27], v[120:123], v[80:95]
    ds_read_b64_tr_b16 v[16:17], v11 offset:28672
    ds_read_b64_tr_b16 v[18:19], v11 offset:29696
    s_waitcnt vmcnt(0)
    v_mfma_f32_32x32x16_bf16 v[48:63], v[28:31], v[124:127], v[48:63]
    ds_read_b64_tr_b16 v[20:21], v11 offset:32768
    ds_read_b64_tr_b16 v[22:23], v11 offset:33792
    s_waitcnt lgkmcnt(10)
    v_mfma_f32_32x32x16_bf16 v[64:79], v[32:35], v[124:127], v[64:79]
    ds_read_b64_tr_b16 v[24:25], v11 offset:36864
    ds_read_b64_tr_b16 v[26:27], v11 offset:37888
    v_mfma_f32_32x32x16_bf16 v[80:95], v[36:39], v[124:127], v[80:95]
    ds_read_b64_tr_b16 v[28:29], v11 offset:40960
    ds_read_b64_tr_b16 v[30:31], v11 offset:41984
    s_waitcnt lgkmcnt(10)
    v_mfma_f32_32x32x16_bf16 v[96:111], v[40:43], v[128:131], v[96:111]
    ds_read_b64_tr_b16 v[32:33], v11 offset:45056
    ds_read_b64_tr_b16 v[34:35], v11 offset:46080
    v_mfma_f32_32x32x16_bf16 v[96:111], v[44:47], v[132:135], v[96:111]
    ds_read_b64_tr_b16 v[36:37], v11 offset:49152
    ds_read_b64_tr_b16 v[38:39], v11 offset:50176
    v_mul_f32 v48, s46, v48
    v_mul_f32 v49, s46, v49
    v_mul_f32 v50, s46, v50
    s_waitcnt lgkmcnt(10)
    v_mfma_f32_32x32x16_bf16 v[96:111], v[12:15], v[136:139], v[96:111]
    ds_read_b64_tr_b16 v[40:41], v11 offset:53248
    ds_read_b64_tr_b16 v[42:43], v11 offset:54272
    v_mul_f32 v51, s46, v51
    v_cvt_pk_bf16_f32 v48, v48, v49
    v_cvt_pk_bf16_f32 v49, v50, v51
    v_mfma_f32_32x32x16_bf16 v[96:111], v[16:19], v[140:143], v[96:111]
    ds_read_b64_tr_b16 v[44:45], v11 offset:57344
    ds_read_b64_tr_b16 v[46:47], v11 offset:58368
    buffer_store_dwordx2 v[48:49], v4, s[28:31], s48 offen offset:0 sc1
    v_mul_f32 v52, s46, v52
    v_mul_f32 v53, s46, v53
    s_waitcnt lgkmcnt(10)
    v_mfma_f32_32x32x16_bf16 v[96:111], v[20:23], v[144:147], v[96:111]
    ds_read_b64_tr_b16 v[12:13], v11 offset:61440
    ds_read_b64_tr_b16 v[14:15], v11 offset:62464
    v_mul_f32 v54, s46, v54
    v_mul_f32 v55, s46, v55
    v_cvt_pk_bf16_f32 v52, v52, v53
    v_mfma_f32_32x32x16_bf16 v[96:111], v[24:27], v[148:151], v[96:111]
    v_add_u32 v11, 0x10000, v11
    ds_read_b64_tr_b16 v[16:17], v11 offset:0
    ds_read_b64_tr_b16 v[18:19], v11 offset:1024
    v_cvt_pk_bf16_f32 v53, v54, v55
    buffer_store_dwordx2 v[52:53], v5, s[28:31], s48 offen offset:0 sc1
    v_mul_f32 v56, s46, v56
    s_waitcnt lgkmcnt(10)
    v_mfma_f32_32x32x16_bf16 v[96:111], v[28:31], v[152:155], v[96:111]
    ds_read_b64_tr_b16 v[20:21], v11 offset:4096
    ds_read_b64_tr_b16 v[22:23], v11 offset:5120
    v_mul_f32 v57, s46, v57
    v_mul_f32 v58, s46, v58
    v_mul_f32 v59, s46, v59
    v_mfma_f32_32x32x16_bf16 v[96:111], v[32:35], v[156:159], v[96:111]
    ds_read_b64_tr_b16 v[24:25], v11 offset:8192
    ds_read_b64_tr_b16 v[26:27], v11 offset:9216
    v_cvt_pk_bf16_f32 v56, v56, v57
    v_cvt_pk_bf16_f32 v57, v58, v59
    buffer_store_dwordx2 v[56:57], v6, s[28:31], s48 offen offset:0 sc1
    s_waitcnt lgkmcnt(10)
    v_mfma_f32_32x32x16_bf16 v[96:111], v[36:39], v[160:163], v[96:111]
    ds_read_b64_tr_b16 v[28:29], v11 offset:12288
    ds_read_b64_tr_b16 v[30:31], v11 offset:13312
    v_mul_f32 v60, s46, v60
    v_mul_f32 v61, s46, v61
    v_mul_f32 v62, s46, v62
    v_mfma_f32_32x32x16_bf16 v[96:111], v[40:43], v[164:167], v[96:111]
    ds_read_b64_tr_b16 v[32:33], v11 offset:16384
    ds_read_b64_tr_b16 v[34:35], v11 offset:17408
    v_mul_f32 v63, s46, v63
    v_cvt_pk_bf16_f32 v60, v60, v61
    v_cvt_pk_bf16_f32 v61, v62, v63
    s_waitcnt lgkmcnt(10)
    v_mfma_f32_32x32x16_bf16 v[96:111], v[44:47], v[168:171], v[96:111]
    ds_read_b64_tr_b16 v[36:37], v11 offset:20480
    ds_read_b64_tr_b16 v[38:39], v11 offset:21504
    buffer_store_dwordx2 v[60:61], v7, s[28:31], s48 offen offset:0 sc1
    v_mul_f32 v64, s46, v64
    v_mul_f32 v65, s46, v65
    v_mfma_f32_32x32x16_bf16 v[96:111], v[12:15], v[172:175], v[96:111]
    ds_read_b64_tr_b16 v[40:41], v11 offset:24576
    ds_read_b64_tr_b16 v[42:43], v11 offset:25600
    v_mul_f32 v66, s46, v66
    v_mul_f32 v67, s46, v67
    v_cvt_pk_bf16_f32 v64, v64, v65
    s_waitcnt lgkmcnt(10)
    v_mfma_f32_32x32x16_bf16 v[96:111], v[16:19], v[176:179], v[96:111]
    ds_read_b64_tr_b16 v[44:45], v11 offset:28672
    ds_read_b64_tr_b16 v[46:47], v11 offset:29696
    v_cvt_pk_bf16_f32 v65, v66, v67
    buffer_store_dwordx2 v[64:65], v4, s[28:31], s48 offen offset:2048 sc1
    v_mul_f32 v68, s46, v68
    v_mfma_f32_32x32x16_bf16 v[96:111], v[20:23], v[180:183], v[96:111]
    ds_read_b64_tr_b16 v[12:13], v11 offset:32768
    ds_read_b64_tr_b16 v[14:15], v11 offset:33792
    v_mul_f32 v69, s46, v69
    v_mul_f32 v70, s46, v70
    v_mul_f32 v71, s46, v71
    s_waitcnt lgkmcnt(10)
    v_mfma_f32_32x32x16_bf16 v[96:111], v[24:27], v[184:187], v[96:111]
    ds_read_b64_tr_b16 v[16:17], v11 offset:36864
    ds_read_b64_tr_b16 v[18:19], v11 offset:37888
    v_cvt_pk_bf16_f32 v68, v68, v69
    v_cvt_pk_bf16_f32 v69, v70, v71
    buffer_store_dwordx2 v[68:69], v5, s[28:31], s48 offen offset:2048 sc1
    v_mfma_f32_32x32x16_bf16 v[96:111], v[28:31], v[188:191], v[96:111]
    ds_read_b64_tr_b16 v[20:21], v11 offset:40960
    ds_read_b64_tr_b16 v[22:23], v11 offset:41984
    v_mul_f32 v72, s46, v72
    v_mul_f32 v73, s46, v73
    v_mul_f32 v74, s46, v74
    s_waitcnt lgkmcnt(10)
    v_mfma_f32_32x32x16_bf16 v[96:111], v[32:35], v[192:195], v[96:111]
    ds_read_b64_tr_b16 v[24:25], v11 offset:45056
    ds_read_b64_tr_b16 v[26:27], v11 offset:46080
    v_mul_f32 v75, s46, v75
    v_cvt_pk_bf16_f32 v72, v72, v73
    v_cvt_pk_bf16_f32 v73, v74, v75
    v_mfma_f32_32x32x16_bf16 v[96:111], v[36:39], v[196:199], v[96:111]
    ds_read_b64_tr_b16 v[28:29], v11 offset:49152
    ds_read_b64_tr_b16 v[30:31], v11 offset:50176
    buffer_store_dwordx2 v[72:73], v6, s[28:31], s48 offen offset:2048 sc1
    v_mul_f32 v76, s46, v76
    v_mul_f32 v77, s46, v77
    s_waitcnt lgkmcnt(10)
    v_mfma_f32_32x32x16_bf16 v[96:111], v[40:43], v[200:203], v[96:111]
    ds_read_b64_tr_b16 v[32:33], v11 offset:53248
    ds_read_b64_tr_b16 v[34:35], v11 offset:54272
    v_mul_f32 v78, s46, v78
    v_mul_f32 v79, s46, v79
    v_cvt_pk_bf16_f32 v76, v76, v77
    v_mfma_f32_32x32x16_bf16 v[96:111], v[44:47], v[204:207], v[96:111]
    ds_read_b64_tr_b16 v[36:37], v11 offset:57344
    ds_read_b64_tr_b16 v[38:39], v11 offset:58368
    v_cvt_pk_bf16_f32 v77, v78, v79
    buffer_store_dwordx2 v[76:77], v7, s[28:31], s48 offen offset:2048 sc1
    v_mul_f32 v80, s46, v80
    s_waitcnt lgkmcnt(10)
    v_mfma_f32_32x32x16_bf16 v[96:111], v[12:15], v[208:211], v[96:111]
    ds_read_b64_tr_b16 v[40:41], v11 offset:61440
    ds_read_b64_tr_b16 v[42:43], v11 offset:62464
    v_mul_f32 v81, s46, v81
    v_mul_f32 v82, s46, v82
    v_mul_f32 v83, s46, v83
    v_mfma_f32_32x32x16_bf16 v[96:111], v[16:19], v[212:215], v[96:111]
    v_add_u32 v11, 0x10000, v11
    ds_read_b64_tr_b16 v[44:45], v11 offset:0
    ds_read_b64_tr_b16 v[46:47], v11 offset:1024
    v_cvt_pk_bf16_f32 v80, v80, v81
    v_cvt_pk_bf16_f32 v81, v82, v83
    buffer_store_dwordx2 v[80:81], v4, s[28:31], s49 offen offset:0 sc1
    s_waitcnt lgkmcnt(10)
    v_mfma_f32_32x32x16_bf16 v[96:111], v[20:23], v[216:219], v[96:111]
    ds_read_b64_tr_b16 v[12:13], v11 offset:4096
    ds_read_b64_tr_b16 v[14:15], v11 offset:5120
    v_mul_f32 v84, s46, v84
    v_mul_f32 v85, s46, v85
    v_mul_f32 v86, s46, v86
    v_mfma_f32_32x32x16_bf16 v[96:111], v[24:27], v[220:223], v[96:111]
    ds_read_b64_tr_b16 v[16:17], v11 offset:8192
    ds_read_b64_tr_b16 v[18:19], v11 offset:9216
    v_mul_f32 v87, s46, v87
    v_cvt_pk_bf16_f32 v84, v84, v85
    v_cvt_pk_bf16_f32 v85, v86, v87
    s_waitcnt lgkmcnt(10)
    v_mfma_f32_32x32x16_bf16 v[96:111], v[28:31], v[224:227], v[96:111]
    ds_read_b64_tr_b16 v[20:21], v11 offset:12288
    ds_read_b64_tr_b16 v[22:23], v11 offset:13312
    buffer_store_dwordx2 v[84:85], v5, s[28:31], s49 offen offset:0 sc1
    v_mul_f32 v88, s46, v88
    v_mul_f32 v89, s46, v89
    v_mfma_f32_32x32x16_bf16 v[96:111], v[32:35], v[228:231], v[96:111]
    v_add_u32 v11, 0xfffe0000, v11
    ds_read_b64_tr_b16 v[24:25], v11 offset:0
    ds_read_b64_tr_b16 v[26:27], v11 offset:1024
    v_mul_f32 v90, s46, v90
    v_mul_f32 v91, s46, v91
    v_cvt_pk_bf16_f32 v88, v88, v89
    s_waitcnt lgkmcnt(10)
    v_mfma_f32_32x32x16_bf16 v[96:111], v[36:39], v[232:235], v[96:111]
    ds_read_b64_tr_b16 v[28:29], v11 offset:4096
    ds_read_b64_tr_b16 v[30:31], v11 offset:5120
    v_cvt_pk_bf16_f32 v89, v90, v91
    buffer_store_dwordx2 v[88:89], v6, s[28:31], s49 offen offset:0 sc1
    v_mul_f32 v92, s46, v92
    v_mfma_f32_32x32x16_bf16 v[96:111], v[40:43], v[236:239], v[96:111]
    ds_read_b64_tr_b16 v[32:33], v11 offset:8192
    ds_read_b64_tr_b16 v[34:35], v11 offset:9216
    v_mul_f32 v93, s46, v93
    v_mul_f32 v94, s46, v94
    v_mul_f32 v95, s46, v95
    s_waitcnt lgkmcnt(10)
    v_mfma_f32_32x32x16_bf16 v[96:111], v[44:47], v[240:243], v[96:111]
    ds_read_b64_tr_b16 v[36:37], v11 offset:12288
    ds_read_b64_tr_b16 v[38:39], v11 offset:13312
    v_cvt_pk_bf16_f32 v92, v92, v93
    v_cvt_pk_bf16_f32 v93, v94, v95
    buffer_store_dwordx2 v[92:93], v7, s[28:31], s49 offen offset:0 sc1
    v_mfma_f32_32x32x16_bf16 v[96:111], v[12:15], v[244:247], v[96:111]
    s_waitcnt lgkmcnt(8)
    v_mfma_f32_32x32x16_bf16 v[96:111], v[16:19], v[248:251], v[96:111]
    v_mfma_f32_32x32x16_bf16 v[96:111], v[20:23], v[252:255], v[96:111]
    s_waitcnt lgkmcnt(4)
    v_mfma_f32_32x32x16_bf16 v[96:111], v[24:27], v[112:115], v[96:111]
    v_mfma_f32_32x32x16_bf16 v[96:111], v[28:31], v[116:119], v[96:111]
    s_waitcnt lgkmcnt(0)
    v_mfma_f32_32x32x16_bf16 v[96:111], v[32:35], v[120:123], v[96:111]
    v_mfma_f32_32x32x16_bf16 v[96:111], v[36:39], v[124:127], v[96:111]
    s_nop 11
    v_pk_mul_f32 v[96:97], v[96:97], s[46:47]
    v_pk_mul_f32 v[98:99], v[98:99], s[46:47]
    v_cvt_pk_bf16_f32 v96, v96, v97
    v_cvt_pk_bf16_f32 v97, v98, v99
    buffer_store_dwordx2 v[96:97], v4, s[28:31], s49 offen offset:2048 sc1
    v_pk_mul_f32 v[100:101], v[100:101], s[46:47]
    v_pk_mul_f32 v[102:103], v[102:103], s[46:47]
    v_cvt_pk_bf16_f32 v100, v100, v101
    v_cvt_pk_bf16_f32 v101, v102, v103
    buffer_store_dwordx2 v[100:101], v5, s[28:31], s49 offen offset:2048 sc1
    v_pk_mul_f32 v[104:105], v[104:105], s[46:47]
    v_pk_mul_f32 v[106:107], v[106:107], s[46:47]
    v_cvt_pk_bf16_f32 v104, v104, v105
    v_cvt_pk_bf16_f32 v105, v106, v107
    buffer_store_dwordx2 v[104:105], v6, s[28:31], s49 offen offset:2048 sc1
    v_pk_mul_f32 v[108:109], v[108:109], s[46:47]
    v_pk_mul_f32 v[110:111], v[110:111], s[46:47]
    v_cvt_pk_bf16_f32 v108, v108, v109
    v_cvt_pk_bf16_f32 v109, v110, v111
    buffer_store_dwordx2 v[108:109], v7, s[28:31], s49 offen offset:2048 sc1
adaLN_cond__sliding_block__swiglu_ffn__prompt_kernel_p2_5:
hop_pad_8:
    s_cbranch_execz hop_back
    s_and_b32 s40, s2, 7
    s_lshr_b32 s41, s2, 3
    s_lshr_b32 s42, s40, 3
    s_lshl_b32 s42, s42, 4
    s_and_b32 s43, s41, 15
    s_add_u32 s60, s42, s43
    s_and_b32 s42, s40, 7
    s_lshl_b32 s42, s42, 1
    s_lshr_b32 s43, s41, 4
    s_add_u32 s61, s42, s43
    v_lshrrev_b32 v2, 5, v0
    v_and_b32 v1, 31, v0
    v_lshlrev_b32 v3, 4, v0
    v_mul_u32_u24 v4, 38400, v2
    v_add_u32 v4, v4, v3
    s_lshr_b32 s51, s3, 2
    s_lshl_b32 s52, s61, 1
    s_add_u32 s52, s52, s51
    s_mul_i32 s53, s52, 5
    s_lshl_b32 s54, s60, 2
    s_add_u32 s54, s54, s66
    s_mul_i32 s46, s66, 5136
    s_mul_i32 s47, s61, 2560
    s_sub_u32 s47, s46, s47
    v_lshl_add_u32 v150, v2, 1, s53
    v_and_b32 v151, 7, v150
    v_lshlrev_b32 v151, 2, v151
    v_xor_b32 v151, v151, v1
    v_lshlrev_b32 v151, 3, v151
    v_lshl_add_u32 v146, v150, 8, v151
    v_add_u32 v133, s47, v146
    v_lshl_add_u32 v150, v2, 1, s53
    v_add_u32 v150, 1, v150
    v_and_b32 v151, 7, v150
    v_lshlrev_b32 v151, 2, v151
    v_xor_b32 v151, v151, v1
    v_lshlrev_b32 v151, 3, v151
    v_lshl_add_u32 v147, v150, 8, v151
    v_add_u32 v134, s47, v147
    s_add_u32 s48, s53, 4
    v_mov_b32 v150, s48
    v_and_b32 v151, 7, v150
    v_lshlrev_b32 v151, 2, v151
    v_xor_b32 v151, v151, v1
    v_lshlrev_b32 v151, 3, v151
    v_lshl_add_u32 v148, v150, 8, v151
    v_add_u32 v135, s47, v148
    s_add_u32 s48, s46, 5128
    v_mov_b32 v150, s48
    v_cmp_eq_u32 vcc, 1, v2
    s_nop 1
    v_cndmask_b32 v135, v135, v150, vcc
    v_bfe_u32 v150, v0, 4, 1
    v_bfe_u32 v151, v0, 2, 2
    v_and_b32 v152, 3, v0
    v_lshl_add_u32 v153, v150, 2, v152
    v_add_u32 v154, s53, v153
    v_and_b32 v155, 7, v154
    v_lshlrev_b32 v155, 2, v155
    v_lshl_add_u32 v156, v2, 2, v151
    v_xor_b32 v155, v155, v156
    v_lshlrev_b32 v154, 8, v154
    s_add_u32 s48, s47, 2560
    v_add_u32 v154, s48, v154
    s_add_u32 s48, s46, 5120
    v_mov_b32 v157, s48
    v_cmp_lt_u32 vcc, 4, v153
    v_xor_b32 v156, 0, v155
    v_lshl_add_u32 v156, v156, 3, v154
    v_cndmask_b32 v136, v156, v157, vcc
    v_xor_b32 v156, 8, v155
    v_lshl_add_u32 v156, v156, 3, v154
    v_cndmask_b32 v137, v156, v157, vcc
    v_xor_b32 v156, 16, v155
    v_lshl_add_u32 v156, v156, 3, v154
    v_cndmask_b32 v138, v156, v157, vcc
    v_xor_b32 v156, 24, v155
    v_lshl_add_u32 v156, v156, 3, v154
    v_cndmask_b32 v139, v156, v157, vcc
    v_lshlrev_b32 v150, 2, v2
    v_sub_u32 v150, v1, v150
    v_mov_b32 v151, 0xff800000
    v_cmp_le_i32 s[48:49], 0, v150
    v_cmp_le_i32 vcc, 1, v150
    s_nop 0
    v_cndmask_b32 v176, v151, 0, s[48:49]
    v_cndmask_b32 v192, 0, v151, s[48:49]
    v_cndmask_b32 v177, v151, 0, vcc
    v_cndmask_b32 v193, 0, v151, vcc
    v_cmp_le_i32 s[48:49], 2, v150
    v_cmp_le_i32 vcc, 3, v150
    s_nop 0
    v_cndmask_b32 v178, v151, 0, s[48:49]
hop_pad_9:
    s_cbranch_execz hop_back
    v_cndmask_b32 v194, 0, v151, s[48:49]
    v_cndmask_b32 v179, v151, 0, vcc
    v_cndmask_b32 v195, 0, v151, vcc
    v_cmp_le_i32 s[48:49], 8, v150
    v_cmp_le_i32 vcc, 9, v150
    s_nop 0
    v_cndmask_b32 v180, v151, 0, s[48:49]
    v_cndmask_b32 v196, 0, v151, s[48:49]
    v_cndmask_b32 v181, v151, 0, vcc
    v_cndmask_b32 v197, 0, v151, vcc
    v_cmp_le_i32 s[48:49], 10, v150
    v_cmp_le_i32 vcc, 11, v150
    s_nop 0
    v_cndmask_b32 v182, v151, 0, s[48:49]
    v_cndmask_b32 v198, 0, v151, s[48:49]
    v_cndmask_b32 v183, v151, 0, vcc
    v_cndmask_b32 v199, 0, v151, vcc
    v_cmp_le_i32 s[48:49], 16, v150
    v_cmp_le_i32 vcc, 17, v150
    s_nop 0
    v_cndmask_b32 v184, v151, 0, s[48:49]
    v_cndmask_b32 v200, 0, v151, s[48:49]
    v_cndmask_b32 v185, v151, 0, vcc
    v_cndmask_b32 v201, 0, v151, vcc
    v_cmp_le_i32 s[48:49], 18, v150
    v_cmp_le_i32 vcc, 19, v150
    s_nop 0
    v_cndmask_b32 v186, v151, 0, s[48:49]
    v_cndmask_b32 v202, 0, v151, s[48:49]
    v_cndmask_b32 v187, v151, 0, vcc
    v_cndmask_b32 v203, 0, v151, vcc
    v_cmp_le_i32 s[48:49], 24, v150
    v_cmp_le_i32 vcc, 25, v150
    s_nop 0
    v_cndmask_b32 v188, v151, 0, s[48:49]
    v_cndmask_b32 v204, 0, v151, s[48:49]
    v_cndmask_b32 v189, v151, 0, vcc
    v_cndmask_b32 v205, 0, v151, vcc
    v_cmp_le_i32 s[48:49], 26, v150
    v_cmp_le_i32 vcc, 27, v150
    s_nop 0
    v_cndmask_b32 v190, v151, 0, s[48:49]
    v_cndmask_b32 v206, 0, v151, s[48:49]
    v_cndmask_b32 v191, v151, 0, vcc
    v_cndmask_b32 v207, 0, v151, vcc
    s_waitcnt vmcnt(0)
    v_mov_b32 v250, 162820
    v_mov_b32 v251, 1
    s_mov_b64 exec, 1
    ds_add_rtn_u32 v251, v250, v251
    s_mov_b64 exec, -1
    s_waitcnt lgkmcnt(0)
    v_readfirstlane_b32 s56, v251
    s_nop 0
    s_cmp_lg_u32 s56, 7
    s_cbranch_scc1 adaLN_cond__sliding_block__swiglu_ffn__prompt_kernel_sig_56
    s_lshl_b32 s57, s24, 7
    s_add_u32 s57, s57, 792576
    s_atomic_add_x2 s[10:11], s[26:27], s57
    s_add_u32 s57, s57, 128
    s_atomic_add_x2 s[10:11], s[26:27], s57
    s_add_u32 s57, s57, 128
    s_atomic_add_x2 s[10:11], s[26:27], s57
adaLN_cond__sliding_block__swiglu_ffn__prompt_kernel_sig_56:
    s_mov_b32 s24, s60
    s_cmp_lt_u32 s3, 4
    s_cbranch_scc1 adaLN_cond__sliding_block__swiglu_ffn__prompt_kernel_hl_57
    s_mov_b32 s101, 5
    s_mov_b64 exec, 0
    s_cmp_eq_u32 s66, 0
    s_cbranch_scc1 hop_pad_12
    s_cmp_eq_u32 s66, 1
    s_cbranch_scc1 hop_pad_13
    s_cmp_eq_u32 s66, 2
    s_cbranch_scc1 hop_pad_14
    s_cmp_eq_u32 s66, 3
    s_cbranch_scc1 hop_pad_15
hop_ret_5:
    s_mov_b64 exec, -1
    s_mov_b32 s101, 0
adaLN_cond__sliding_block__swiglu_ffn__prompt_kernel_hl_57:
    s_cmp_lg_u32 s3, 7
    s_cbranch_scc1 adaLN_cond__sliding_block__swiglu_ffn__prompt_kernel_gap_58
    v_mul_u32_u24 v8, 5136, v0
    v_mov_b32 v20, 0x3f803f80
    v_mov_b32 v21, 0x3f803f80
    v_mov_b32 v23, 0x3f803f80
    s_lshl_b32 s48, s60, 2
    v_add_u32 v9, s48, v0
    v_mov_b32 v10, 0x3f80f149
    v_mov_b32 v11, 0x3f800000
    v_cmp_gt_u32 vcc, 8, v9
    s_nop 1
    v_cndmask_b32 v22, v11, v10, vcc
    v_mov_b32 v250, 162820
    s_mov_b32 s58, 0
adaLN_cond__sliding_block__swiglu_ffn__prompt_kernel_spin_59:
    ds_read_b32 v251, v250
    s_waitcnt lgkmcnt(0)
    v_readfirstlane_b32 s56, v251
    s_nop 0
    s_cmp_ge_u32 s56, 8
    s_cbranch_scc1 adaLN_cond__sliding_block__swiglu_ffn__prompt_kernel_sdone_60
    s_add_u32 s58, s58, 1
    s_sleep 1
    s_cmp_lt_u32 s58, 0x40000
    s_cbranch_scc1 adaLN_cond__sliding_block__swiglu_ffn__prompt_kernel_spin_59
adaLN_cond__sliding_block__swiglu_ffn__prompt_kernel_sdone_60:
    s_mov_b64 exec, 0xfff
    ds_write_b128 v8, v[20:23] offset:5120
    s_mov_b64 exec, -1
    s_waitcnt lgkmcnt(0)
adaLN_cond__sliding_block__swiglu_ffn__prompt_kernel_gap_58:
    s_mul_i32 s44, s61, 2560
    s_add_u32 s44, s44, 10526720
    s_lshl_b32 s45, s60, 2
    s_add_u32 s45, s45, s3
    s_sub_u32 s45, s45, 8
    s_mul_i32 s40, s45, 122880
    s_add_u32 s40, s40, s44
    s_cmp_lt_i32 s45, 0
    s_cselect_b32 s40, 0x40000000, s40
    s_lshl_b32 s45, s60, 2
    s_add_u32 s45, s45, s3
    s_mul_i32 s41, s45, 122880
    s_add_u32 s41, s41, s44
    s_mul_i32 s42, s3, 5136
    s_mul_i32 s55, s54, 122880
    s_add_u32 s55, s55, 10485760
    s_cmp_lg_u32 s3, 0
    s_cbranch_scc1 adaLN_cond__sliding_block__swiglu_ffn__prompt_kernel_x1_55
    s_min_u32 s48, s60, 2
    s_add_u32 s48, s48, 1
    s_lshl_b32 s48, s48, 4
    s_mov_b32 s49, 0
    s_lshl_b32 s57, s60, 7
    s_add_u32 s57, s57, 792576
    s_waitcnt lgkmcnt(0)
    s_mov_b32 s56, 0
adaLN_cond__sliding_block__swiglu_ffn__prompt_kernel_poll_61:
    s_mov_b64 s[58:59], 0
    s_atomic_add_x2 s[58:59], s[26:27], s57 glc
    s_waitcnt lgkmcnt(0)
    s_sub_u32 s58, s58, s64
    s_subb_u32 s59, s59, s65
    s_cmp_eq_u64 s[58:59], s[48:49]
    s_cbranch_scc1 adaLN_cond__sliding_block__swiglu_ffn__prompt_kernel_pdone_62
    s_add_u32 s56, s56, 1
    s_sleep 1
    s_cmp_lt_u32 s56, 0x8000
    s_cbranch_scc1 adaLN_cond__sliding_block__swiglu_ffn__prompt_kernel_poll_61
adaLN_cond__sliding_block__swiglu_ffn__prompt_kernel_pdone_62:
    s_lshl_b32 s57, s61, 7
    s_add_u32 s57, s57, 796672
    s_atomic_add_x2 s[10:11], s[26:27], s57
adaLN_cond__sliding_block__swiglu_ffn__prompt_kernel_x1_55:
    s_barrier
    buffer_load_dwordx2 v[140:141], v146, s[28:31], s55 offen sc1
    buffer_load_dwordx2 v[142:143], v147, s[28:31], s55 offen sc1
    buffer_load_dwordx2 v[144:145], v148, s[28:31], s55 offen sc1
    s_add_u32 m0, s42, 0
    s_nop 0
    buffer_load_dwordx4 v3, s[28:31], s40 offen sc1 lds
    buffer_load_dwordx4 v3, s[28:31], s40 offen offset:1024 sc1 lds
    buffer_load_dwordx4 v4, s[28:31], s40 offen offset:2048 sc1 lds
    s_cmp_ge_u32 s3, 4
    s_cbranch_scc1 adaLN_cond__sliding_block__swiglu_ffn__prompt_kernel_l1_63
    s_add_u32 m0, s42, 41088
    s_nop 0
    buffer_load_dwordx4 v3, s[28:31], s41 offen sc1 lds
    buffer_load_dwordx4 v3, s[28:31], s41 offen offset:1024 sc1 lds
    buffer_load_dwordx4 v4, s[28:31], s41 offen offset:2048 sc1 lds
adaLN_cond__sliding_block__swiglu_ffn__prompt_kernel_l1_63:
    s_waitcnt vmcnt(0)
    s_add_u32 s47, s40, 41472
    s_add_u32 m0, s42, 3072
    s_nop 0
    buffer_load_dwordx4 v3, s[28:31], s47 offen sc1 lds
    buffer_load_dwordx4 v3, s[28:31], s47 offen offset:1024 sc1 lds
    s_cmp_ge_u32 s3, 4
    s_cbranch_scc1 adaLN_cond__sliding_block__swiglu_ffn__prompt_kernel_l2_64
    s_add_u32 s47, s41, 41472
    s_add_u32 m0, s42, 44160
    s_nop 0
    buffer_load_dwordx4 v3, s[28:31], s47 offen sc1 lds
    buffer_load_dwordx4 v3, s[28:31], s47 offen offset:1024 sc1 lds
adaLN_cond__sliding_block__swiglu_ffn__prompt_kernel_l2_64:
    v_mov_b32 v18, 0x3f80
    v_cmp_eq_u32 s[48:49], 1, v2
    s_nop 1
    v_cndmask_b32 v144, v144, v18, s[48:49]
    v_cndmask_b32 v145, v145, 0, s[48:49]
    s_barrier
    ds_read_b64 v[20:21], v133 offset:0
    ds_read_b64 v[22:23], v134 offset:0
    ds_read_b64 v[24:25], v135 offset:0
    ds_read_b64 v[26:27], v133 offset:5136
    ds_read_b64 v[28:29], v134 offset:5136
    ds_read_b64 v[30:31], v135 offset:5136
    ds_read_b64 v[32:33], v133 offset:10272
    ds_read_b64 v[34:35], v134 offset:10272
    ds_read_b64 v[36:37], v135 offset:10272
    ds_read_b64 v[38:39], v133 offset:15408
    ds_read_b64 v[40:41], v134 offset:15408
    ds_read_b64 v[42:43], v135 offset:15408
    s_cmp_lt_u32 s3, 4
    s_cbranch_scc1 adaLN_cond__sliding_block__swiglu_ffn__prompt_kernel_ds_65
    buffer_store_dwordx4 v[96:99], v3, s[28:31], s6 offen sc1
    buffer_store_dwordx4 v[100:103], v3, s[28:31], s7 offen sc1
    buffer_store_dwordx4 v[104:107], v3, s[28:31], s8 offen sc1
    buffer_store_dwordx4 v[108:111], v3, s[28:31], s9 offen sc1
    buffer_store_dwordx4 v[112:115], v3, s[28:31], s12 offen sc1
    buffer_store_dwordx4 v[116:119], v3, s[28:31], s13 offen sc1
    buffer_store_dwordx4 v[120:123], v3, s[28:31], s14 offen sc1
    buffer_store_dwordx4 v[124:127], v3, s[28:31], s15 offen sc1
adaLN_cond__sliding_block__swiglu_ffn__prompt_kernel_ds_65:
    s_and_b32 s40, s2, 7
    s_lshr_b32 s41, s2, 3
    s_lshr_b32 s42, s40, 1
    s_lshl_b32 s42, s42, 2
    s_and_b32 s43, s41, 3
    s_add_u32 s60, s42, s43
    s_and_b32 s42, s40, 1
    s_lshl_b32 s42, s42, 3
    s_lshr_b32 s43, s41, 2
    s_add_u32 s61, s42, s43
    s_and_b32 s42, s61, 1
    s_lshl_b32 s62, s60, 1
    s_add_u32 s62, s62, s42
    s_lshr_b32 s63, s61, 1
    s_cmp_lg_u32 s3, 7
    s_cbranch_scc1 adaLN_cond__sliding_block__swiglu_ffn__prompt_kernel_l4_66
    s_lshl_b32 s57, s60, 7
    s_add_u32 s57, s57, 796672
    s_mov_b64 s[46:47], 0
    s_atomic_add_x2 s[46:47], s[26:27], s57 glc
adaLN_cond__sliding_block__swiglu_ffn__prompt_kernel_l4_66:
    s_waitcnt lgkmcnt(9)
    v_mfma_f32_32x32x16_bf16 v[80:95], v[20:23], v[140:143], v[192:207]
    ds_read_b64 v[44:45], v133 offset:20544
    ds_read_b64 v[46:47], v134 offset:20544
    ds_read_b64 v[48:49], v135 offset:20544
    s_waitcnt lgkmcnt(9)
    v_mfma_f32_32x32x16_bf16 v[96:111], v[26:29], v[140:143], 0
    ds_read_b64 v[50:51], v133 offset:25680
    ds_read_b64 v[52:53], v134 offset:25680
    ds_read_b64 v[54:55], v135 offset:25680
    s_waitcnt lgkmcnt(9)
    v_mfma_f32_32x32x16_bf16 v[112:127], v[32:35], v[140:143], 0
    ds_read_b64 v[56:57], v133 offset:30816
    ds_read_b64 v[58:59], v134 offset:30816
    ds_read_b64 v[60:61], v135 offset:30816
    v_mfma_f32_32x32x8_bf16 v[80:95], v[24:25], v[144:145], v[80:95]
    s_nop 0
    v_mfma_f32_32x32x8_bf16 v[96:111], v[30:31], v[144:145], v[96:111]
    s_waitcnt lgkmcnt(9)
    v_mfma_f32_32x32x16_bf16 v[212:227], v[38:41], v[140:143], 0
    ds_read_b64 v[62:63], v133 offset:35952
    ds_read_b64 v[64:65], v134 offset:35952
    ds_read_b64 v[66:67], v135 offset:35952
    s_nop 4
    v_max_f32 v18, v80, v81
    v_max_f32 v19, v82, v83
    v_max3_f32 v18, v18, v84, v85
    v_max3_f32 v19, v19, v86, v87
    v_mfma_f32_32x32x8_bf16 v[112:127], v[36:37], v[144:145], v[112:127]
    v_max3_f32 v18, v18, v88, v89
    v_max3_f32 v19, v19, v90, v91
    v_max3_f32 v18, v18, v92, v93
    v_max3_f32 v19, v19, v94, v95
    s_waitcnt lgkmcnt(9)
    v_mfma_f32_32x32x16_bf16 v[80:95], v[44:47], v[140:143], 0
    ds_read_b64 v[68:69], v133 offset:41088
    ds_read_b64 v[70:71], v134 offset:41088
    ds_read_b64 v[72:73], v135 offset:41088
    v_max3_f32 v18, v18, v96, v97
    v_max3_f32 v19, v19, v98, v99
    v_max3_f32 v18, v18, v100, v101
    v_max3_f32 v19, v19, v102, v103
    v_mfma_f32_32x32x8_bf16 v[212:227], v[42:43], v[144:145], v[212:227]
    v_max3_f32 v18, v18, v104, v105
    v_max3_f32 v19, v19, v106, v107
    v_max3_f32 v18, v18, v108, v109
    v_max3_f32 v19, v19, v110, v111
    s_waitcnt lgkmcnt(9)
    v_mfma_f32_32x32x16_bf16 v[96:111], v[50:53], v[140:143], 0
    v_max3_f32 v18, v18, v112, v113
    v_max3_f32 v19, v19, v114, v115
    v_max3_f32 v18, v18, v116, v117
    v_max3_f32 v19, v19, v118, v119
    v_mfma_f32_32x32x8_bf16 v[80:95], v[48:49], v[144:145], v[80:95]
    v_max3_f32 v18, v18, v120, v121
    v_max3_f32 v19, v19, v122, v123
    v_max3_f32 v18, v18, v124, v125
    v_max3_f32 v19, v19, v126, v127
    s_waitcnt lgkmcnt(6)
    v_mfma_f32_32x32x16_bf16 v[112:127], v[56:59], v[140:143], 0
    v_max3_f32 v18, v18, v212, v213
    v_max3_f32 v19, v19, v214, v215
    v_max3_f32 v18, v18, v216, v217
    v_max3_f32 v19, v19, v218, v219
    v_mfma_f32_32x32x8_bf16 v[96:111], v[54:55], v[144:145], v[96:111]
    v_max3_f32 v18, v18, v220, v221
    v_max3_f32 v19, v19, v222, v223
    v_max3_f32 v18, v18, v224, v225
    v_max3_f32 v19, v19, v226, v227
    s_waitcnt lgkmcnt(3)
    v_mfma_f32_32x32x16_bf16 v[212:227], v[62:65], v[140:143], 0
    v_max3_f32 v18, v18, v80, v81
    v_max3_f32 v19, v19, v82, v83
    v_max3_f32 v18, v18, v84, v85
    v_max3_f32 v19, v19, v86, v87
    v_mfma_f32_32x32x8_bf16 v[112:127], v[60:61], v[144:145], v[112:127]
    v_max3_f32 v18, v18, v88, v89
    v_max3_f32 v19, v19, v90, v91
    v_max3_f32 v18, v18, v92, v93
    v_max3_f32 v19, v19, v94, v95
    s_waitcnt lgkmcnt(0)
    v_mfma_f32_32x32x16_bf16 v[80:95], v[68:71], v[140:143], v[176:191]
    v_max3_f32 v18, v18, v96, v97
    v_max3_f32 v19, v19, v98, v99
    v_max3_f32 v18, v18, v100, v101
    v_max3_f32 v19, v19, v102, v103
    v_mfma_f32_32x32x8_bf16 v[212:227], v[66:67], v[144:145], v[212:227]
    v_max3_f32 v18, v18, v104, v105
    v_max3_f32 v19, v19, v106, v107
    v_max3_f32 v18, v18, v108, v109
    v_max3_f32 v19, v19, v110, v111
    v_max3_f32 v18, v18, v112, v113
    v_max3_f32 v19, v19, v114, v115
    v_max3_f32 v18, v18, v116, v117
    v_max3_f32 v19, v19, v118, v119
    v_mfma_f32_32x32x8_bf16 v[80:95], v[72:73], v[144:145], v[80:95]
    v_max3_f32 v18, v18, v120, v121
    v_max3_f32 v19, v19, v122, v123
    v_max3_f32 v18, v18, v124, v125
    v_max3_f32 v19, v19, v126, v127
    v_max3_f32 v18, v18, v212, v213
    v_max3_f32 v19, v19, v214, v215
    v_max3_f32 v18, v18, v216, v217
    v_max3_f32 v19, v19, v218, v219
    v_max3_f32 v18, v18, v220, v221
    v_max3_f32 v19, v19, v222, v223
    v_max3_f32 v18, v18, v224, v225
    v_max3_f32 v19, v19, v226, v227
    v_max3_f32 v18, v18, v80, v81
    v_max3_f32 v19, v19, v82, v83
    v_max3_f32 v18, v18, v84, v85
    v_max3_f32 v19, v19, v86, v87
    v_max3_f32 v18, v18, v88, v89
    v_max3_f32 v19, v19, v90, v91
    v_max3_f32 v18, v18, v92, v93
    v_max3_f32 v19, v19, v94, v95
    s_waitcnt vmcnt(0)
    s_cmp_lg_u32 s3, 7
    s_cbranch_scc1 adaLN_cond__sliding_block__swiglu_ffn__prompt_kernel_l6_68
    s_waitcnt lgkmcnt(0)
    s_sub_u32 s46, s46, s64
    s_subb_u32 s47, s47, s65
    s_cmp_eq_u64 s[46:47], 16
    s_cbranch_scc1 adaLN_cond__sliding_block__swiglu_ffn__prompt_kernel_l7_69
    s_lshl_b32 s57, s60, 7
    s_add_u32 s57, s57, 796672
    s_waitcnt lgkmcnt(0)
    s_mov_b32 s56, 0
adaLN_cond__sliding_block__swiglu_ffn__prompt_kernel_poll_70:
    s_mov_b64 s[58:59], 0
    s_atomic_add_x2 s[58:59], s[26:27], s57 glc
    s_waitcnt lgkmcnt(0)
    s_sub_u32 s58, s58, s64
    s_subb_u32 s59, s59, s65
    s_cmp_eq_u64 s[58:59], 16
    s_cbranch_scc1 adaLN_cond__sliding_block__swiglu_ffn__prompt_kernel_pdone_71
    s_add_u32 s56, s56, 1
    s_sleep 1
    s_cmp_lt_u32 s56, 0x8000
    s_cbranch_scc1 adaLN_cond__sliding_block__swiglu_ffn__prompt_kernel_poll_70
adaLN_cond__sliding_block__swiglu_ffn__prompt_kernel_pdone_71:
adaLN_cond__sliding_block__swiglu_ffn__prompt_kernel_l7_69:
    s_cmp_lg_u32 s2, 0
    s_cbranch_scc1 adaLN_cond__sliding_block__swiglu_ffn__prompt_kernel_l6_68
    s_mov_b32 s57, 786432
    v_mov_b32 v10, s64
    v_mov_b32 v11, s65
    v_mov_b32 v12, 0
    buffer_store_dwordx2 v[10:11], v12, s[28:31], s57 offen sc1
adaLN_cond__sliding_block__swiglu_ffn__prompt_kernel_l6_68:
    s_barrier
    s_cmp_lg_u32 s3, 7
    s_cbranch_scc1 adaLN_cond__sliding_block__swiglu_ffn__prompt_kernel_r1_72
    s_lshl_b32 s57, s60, 7
    s_add_u32 s57, s57, 811008
    s_mov_b64 s[46:47], 1
    s_atomic_add_x2 s[46:47], s[26:27], s57 glc
    s_waitcnt lgkmcnt(0)
    s_sub_u32 s46, s46, s64
    s_subb_u32 s47, s47, s65
    s_cmp_eq_u64 s[46:47], 15
    s_cbranch_scc0 adaLN_cond__sliding_block__swiglu_ffn__prompt_kernel_r1_72
    s_mov_b32 s57, 813056
    s_atomic_add_x2 s[10:11], s[26:27], s57
    s_add_u32 s57, s57, 128
    s_atomic_add_x2 s[10:11], s[26:27], s57
    s_add_u32 s57, s57, 128
    s_atomic_add_x2 s[10:11], s[26:27], s57
    s_add_u32 s57, s57, 128
    s_atomic_add_x2 s[10:11], s[26:27], s57
    s_add_u32 s57, s57, 128
    s_atomic_add_x2 s[10:11], s[26:27], s57
    s_add_u32 s57, s57, 128
    s_atomic_add_x2 s[10:11], s[26:27], s57
    s_add_u32 s57, s57, 128
    s_atomic_add_x2 s[10:11], s[26:27], s57
    s_add_u32 s57, s57, 128
    s_atomic_add_x2 s[10:11], s[26:27], s57
    s_add_u32 s57, s57, 128
    s_atomic_add_x2 s[10:11], s[26:27], s57
    s_add_u32 s57, s57, 128
    s_atomic_add_x2 s[10:11], s[26:27], s57
    s_add_u32 s57, s57, 128
    s_atomic_add_x2 s[10:11], s[26:27], s57
    s_add_u32 s57, s57, 128
    s_atomic_add_x2 s[10:11], s[26:27], s57
    s_add_u32 s57, s57, 128
    s_atomic_add_x2 s[10:11], s[26:27], s57
    s_add_u32 s57, s57, 128
    s_atomic_add_x2 s[10:11], s[26:27], s57
    s_add_u32 s57, s57, 128
    s_atomic_add_x2 s[10:11], s[26:27], s57
    s_add_u32 s57, s57, 128
    s_atomic_add_x2 s[10:11], s[26:27], s57
    s_add_u32 s57, s57, 128
    s_waitcnt lgkmcnt(0)
adaLN_cond__sliding_block__swiglu_ffn__prompt_kernel_r1_72:
    s_mul_i32 s40, s66, 20480
    s_mul_i32 s41, s63, 102400
    s_add_u32 s41, s41, 1048576
    s_add_u32 s42, s41, s40
    s_add_u32 s40, s40, 78848
    ds_read_b64_tr_b16 v[228:229], v136 offset:0
    ds_read_b64_tr_b16 v[230:231], v137 offset:0
    ds_read_b64_tr_b16 v[232:233], v138 offset:0
    ds_read_b64_tr_b16 v[234:235], v139 offset:0
    v_mfma_f32_32x32x16_bf16 v[80:95], v[20:23], v[140:143], v[192:207]
    v_mfma_f32_32x32x16_bf16 v[96:111], v[26:29], v[140:143], 0
    v_max_f32 v18, v18, v19
    v_mov_b32 v19, v18
    s_nop 1
    v_permlane32_swap_b32 v18, v19
    v_max_f32 v18, v18, v19
    v_sub_f32 v18, 0, v18
    v_and_b32 v19, 0xffff0000, v18
    v_sub_f32 v18, v18, v19
    v_and_b32 v17, 0xffff0000, v18
    v_sub_f32 v18, v18, v17
    v_or_b32 v19, 0x3f80, v19
    v_cvt_pk_bf16_f32 v18, v17, v18
    v_cndmask_b32 v144, v144, v19, s[48:49]
    v_cndmask_b32 v145, v145, v18, s[48:49]
    s_nop 1
    v_mfma_f32_32x32x8_bf16 v[80:95], v[24:25], v[144:145], v[80:95]
    v_mfma_f32_32x32x8_bf16 v[96:111], v[30:31], v[144:145], v[96:111]
    s_nop 10
    v_exp_f32 v80, v80
    v_exp_f32 v81, v81
    v_exp_f32 v82, v82
    v_exp_f32 v83, v83
    ds_read_b64_tr_b16 v[236:237], v136 offset:5136
    ds_read_b64_tr_b16 v[238:239], v137 offset:5136
    ds_read_b64_tr_b16 v[240:241], v138 offset:5136
    ds_read_b64_tr_b16 v[242:243], v139 offset:5136
    v_cvt_pk_bf16_f32 v212, v80, v81
    v_cvt_pk_bf16_f32 v213, v82, v83
    v_exp_f32 v84, v84
    v_exp_f32 v85, v85
    v_exp_f32 v86, v86
    v_exp_f32 v87, v87
    v_mfma_f32_32x32x16_bf16 v[112:127], v[32:35], v[140:143], 0
    s_cmp_ge_u32 s3, 4
    s_cbranch_scc1 adaLN_cond__sliding_block__swiglu_ffn__prompt_kernel_sd_73
    s_add_u32 s43, s42, 0
    s_add_u32 m0, s40, 0
    s_nop 0
    buffer_load_dwordx4 v3, s[28:31], s43 offen sc1 lds
    buffer_load_dwordx4 v3, s[28:31], s43 offen offset:1024 sc1 lds
    buffer_load_dwordx4 v3, s[28:31], s43 offen offset:2048 sc1 lds
adaLN_cond__sliding_block__swiglu_ffn__prompt_kernel_sd_73:
    v_cvt_pk_bf16_f32 v214, v84, v85
    v_cvt_pk_bf16_f32 v215, v86, v87
    v_exp_f32 v88, v88
    v_exp_f32 v89, v89
    v_exp_f32 v90, v90
    v_exp_f32 v91, v91
    s_waitcnt lgkmcnt(4)
    v_mfma_f32_32x32x16_bf16 v[160:175], v[228:231], v[212:215], 0
    v_cvt_pk_bf16_f32 v216, v88, v89
    v_cvt_pk_bf16_f32 v217, v90, v91
    v_exp_f32 v92, v92
    v_exp_f32 v93, v93
    v_exp_f32 v94, v94
    v_exp_f32 v95, v95
    v_mfma_f32_32x32x8_bf16 v[112:127], v[36:37], v[144:145], v[112:127]
    v_cvt_pk_bf16_f32 v218, v92, v93
    v_cvt_pk_bf16_f32 v219, v94, v95
    v_exp_f32 v96, v96
    v_exp_f32 v97, v97
    v_exp_f32 v98, v98
    v_exp_f32 v99, v99
    v_mfma_f32_32x32x16_bf16 v[160:175], v[232:235], v[216:219], v[160:175]
    ds_read_b64_tr_b16 v[228:229], v136 offset:10272
    ds_read_b64_tr_b16 v[230:231], v137 offset:10272
    ds_read_b64_tr_b16 v[232:233], v138 offset:10272
    ds_read_b64_tr_b16 v[234:235], v139 offset:10272
    v_cvt_pk_bf16_f32 v220, v96, v97
    v_cvt_pk_bf16_f32 v221, v98, v99
    v_exp_f32 v100, v100
    v_exp_f32 v101, v101
    v_exp_f32 v102, v102
    v_exp_f32 v103, v103
    v_mfma_f32_32x32x16_bf16 v[80:95], v[38:41], v[140:143], 0
    s_cmp_ge_u32 s3, 4
    s_cbranch_scc1 adaLN_cond__sliding_block__swiglu_ffn__prompt_kernel_sd_74
    s_add_u32 s43, s42, 0
    s_add_u32 m0, s40, 0
    s_nop 0
    buffer_load_dwordx4 v3, s[28:31], s43 offen offset:3072 sc1 lds
    s_add_u32 s43, s42, 4096
    s_add_u32 m0, s40, 4096
    s_nop 0
    buffer_load_dwordx4 v3, s[28:31], s43 offen sc1 lds
    buffer_load_dwordx4 v3, s[28:31], s43 offen offset:1024 sc1 lds
adaLN_cond__sliding_block__swiglu_ffn__prompt_kernel_sd_74:
    v_cvt_pk_bf16_f32 v222, v100, v101
    v_cvt_pk_bf16_f32 v223, v102, v103
    v_exp_f32 v104, v104
    v_exp_f32 v105, v105
    v_exp_f32 v106, v106
    v_exp_f32 v107, v107
    s_waitcnt lgkmcnt(4)
    v_mfma_f32_32x32x16_bf16 v[160:175], v[236:239], v[220:223], v[160:175]
    v_cvt_pk_bf16_f32 v224, v104, v105
    v_cvt_pk_bf16_f32 v225, v106, v107
    v_exp_f32 v108, v108
    v_exp_f32 v109, v109
    v_exp_f32 v110, v110
    v_exp_f32 v111, v111
    v_mfma_f32_32x32x8_bf16 v[80:95], v[42:43], v[144:145], v[80:95]
    v_cvt_pk_bf16_f32 v226, v108, v109
    v_cvt_pk_bf16_f32 v227, v110, v111
    v_exp_f32 v112, v112
    v_exp_f32 v113, v113
    v_exp_f32 v114, v114
    v_exp_f32 v115, v115
    v_mfma_f32_32x32x16_bf16 v[160:175], v[240:243], v[224:227], v[160:175]
    ds_read_b64_tr_b16 v[236:237], v136 offset:15408
    ds_read_b64_tr_b16 v[238:239], v137 offset:15408
    ds_read_b64_tr_b16 v[240:241], v138 offset:15408
    ds_read_b64_tr_b16 v[242:243], v139 offset:15408
    v_cvt_pk_bf16_f32 v212, v112, v113
    v_cvt_pk_bf16_f32 v213, v114, v115
    v_exp_f32 v116, v116
    v_exp_f32 v117, v117
    v_exp_f32 v118, v118
    v_exp_f32 v119, v119
    v_mfma_f32_32x32x16_bf16 v[96:111], v[44:47], v[140:143], 0
    s_cmp_ge_u32 s3, 4
    s_cbranch_scc1 adaLN_cond__sliding_block__swiglu_ffn__prompt_kernel_sd_75
    s_add_u32 s43, s42, 4096
    s_add_u32 m0, s40, 4096
    s_nop 0
    buffer_load_dwordx4 v3, s[28:31], s43 offen offset:2048 sc1 lds
    buffer_load_dwordx4 v3, s[28:31], s43 offen offset:3072 sc1 lds
    s_add_u32 s43, s42, 8192
    s_add_u32 m0, s40, 8192
    s_nop 0
    buffer_load_dwordx4 v3, s[28:31], s43 offen sc1 lds
adaLN_cond__sliding_block__swiglu_ffn__prompt_kernel_sd_75:
    v_cvt_pk_bf16_f32 v214, v116, v117
    v_cvt_pk_bf16_f32 v215, v118, v119
    v_exp_f32 v120, v120
    v_exp_f32 v121, v121
    v_exp_f32 v122, v122
    v_exp_f32 v123, v123
    s_waitcnt lgkmcnt(4)
    v_mfma_f32_32x32x16_bf16 v[160:175], v[228:231], v[212:215], v[160:175]
    v_cvt_pk_bf16_f32 v216, v120, v121
    v_cvt_pk_bf16_f32 v217, v122, v123
    v_exp_f32 v124, v124
    v_exp_f32 v125, v125
    v_exp_f32 v126, v126
    v_exp_f32 v127, v127
    v_mfma_f32_32x32x8_bf16 v[96:111], v[48:49], v[144:145], v[96:111]
    v_cvt_pk_bf16_f32 v218, v124, v125
    v_cvt_pk_bf16_f32 v219, v126, v127
    v_exp_f32 v80, v80
    v_exp_f32 v81, v81
    v_exp_f32 v82, v82
    v_exp_f32 v83, v83
    v_mfma_f32_32x32x16_bf16 v[160:175], v[232:235], v[216:219], v[160:175]
    ds_read_b64_tr_b16 v[228:229], v136 offset:20544
    ds_read_b64_tr_b16 v[230:231], v137 offset:20544
    ds_read_b64_tr_b16 v[232:233], v138 offset:20544
    ds_read_b64_tr_b16 v[234:235], v139 offset:20544
    v_cvt_pk_bf16_f32 v220, v80, v81
    v_cvt_pk_bf16_f32 v221, v82, v83
    v_exp_f32 v84, v84
    v_exp_f32 v85, v85
    v_exp_f32 v86, v86
    v_exp_f32 v87, v87
    v_mfma_f32_32x32x16_bf16 v[112:127], v[50:53], v[140:143], 0
    s_cmp_ge_u32 s3, 4
    s_cbranch_scc1 adaLN_cond__sliding_block__swiglu_ffn__prompt_kernel_sd_76
    s_add_u32 s43, s42, 8192
    s_add_u32 m0, s40, 8192
    s_nop 0
    buffer_load_dwordx4 v3, s[28:31], s43 offen offset:1024 sc1 lds
    buffer_load_dwordx4 v3, s[28:31], s43 offen offset:2048 sc1 lds
    buffer_load_dwordx4 v3, s[28:31], s43 offen offset:3072 sc1 lds
adaLN_cond__sliding_block__swiglu_ffn__prompt_kernel_sd_76:
    v_cvt_pk_bf16_f32 v222, v84, v85
    v_cvt_pk_bf16_f32 v223, v86, v87
    v_exp_f32 v88, v88
    v_exp_f32 v89, v89
    v_exp_f32 v90, v90
    v_exp_f32 v91, v91
    s_waitcnt lgkmcnt(4)
    v_mfma_f32_32x32x16_bf16 v[160:175], v[236:239], v[220:223], v[160:175]
    v_cvt_pk_bf16_f32 v224, v88, v89
    v_cvt_pk_bf16_f32 v225, v90, v91
    v_exp_f32 v92, v92
    v_exp_f32 v93, v93
    v_exp_f32 v94, v94
    v_exp_f32 v95, v95
    v_mfma_f32_32x32x8_bf16 v[112:127], v[54:55], v[144:145], v[112:127]
    v_cvt_pk_bf16_f32 v226, v92, v93
    v_cvt_pk_bf16_f32 v227, v94, v95
    v_exp_f32 v96, v96
    v_exp_f32 v97, v97
    v_exp_f32 v98, v98
    v_exp_f32 v99, v99
    v_mfma_f32_32x32x16_bf16 v[160:175], v[240:243], v[224:227], v[160:175]
    ds_read_b64_tr_b16 v[236:237], v136 offset:25680
    ds_read_b64_tr_b16 v[238:239], v137 offset:25680
    ds_read_b64_tr_b16 v[240:241], v138 offset:25680
    ds_read_b64_tr_b16 v[242:243], v139 offset:25680
    v_cvt_pk_bf16_f32 v212, v96, v97
    v_cvt_pk_bf16_f32 v213, v98, v99
    v_exp_f32 v100, v100
    v_exp_f32 v101, v101
    v_exp_f32 v102, v102
    v_exp_f32 v103, v103
    v_mfma_f32_32x32x16_bf16 v[80:95], v[56:59], v[140:143], 0
    s_cmp_ge_u32 s3, 4
    s_cbranch_scc1 adaLN_cond__sliding_block__swiglu_ffn__prompt_kernel_sd_77
    s_add_u32 s43, s42, 12288
    s_add_u32 m0, s40, 12288
    s_nop 0
    buffer_load_dwordx4 v3, s[28:31], s43 offen sc1 lds
    buffer_load_dwordx4 v3, s[28:31], s43 offen offset:1024 sc1 lds
    buffer_load_dwordx4 v3, s[28:31], s43 offen offset:2048 sc1 lds
    s_mov_b32 s32, s4
    s_and_b32 s33, s5, 0xffff
    s_mov_b32 s34, 0x280000
    s_mov_b32 s35, 0x20000
    s_lshl_b32 s44, s62, 6
    s_lshl_b32 s45, s66, 4
    s_add_u32 s44, s44, s45
    s_mul_i32 s44, s44, 1280
    s_mul_i32 s45, s63, 160
    s_add_u32 s44, s44, s45
    s_mul_i32 s45, s66, 3072
    v_add_u32 v10, 0, v0
    v_min_u32 v10, 159, v10
    v_mul_u32_u24 v11, 0xcccd, v10
    v_lshrrev_b32 v11, 19, v11
    v_mul_u32_u24 v11, 1120, v11
    v_lshl_add_u32 v10, v10, 4, v11
    s_nop 0
hop_pad_10:
    s_cbranch_execz hop_back
    s_add_u32 m0, s45, 63488
    s_nop 0
    buffer_load_dwordx4 v10, s[32:35], s44 offen  lds
    v_add_u32 v10, 64, v0
    v_min_u32 v10, 159, v10
    v_mul_u32_u24 v11, 0xcccd, v10
    v_lshrrev_b32 v11, 19, v11
    v_mul_u32_u24 v11, 1120, v11
    v_lshl_add_u32 v10, v10, 4, v11
    s_add_u32 m0, s45, 64512
    s_nop 0
    buffer_load_dwordx4 v10, s[32:35], s44 offen  lds
    v_add_u32 v10, 128, v0
    v_min_u32 v10, 159, v10
    v_mul_u32_u24 v11, 0xcccd, v10
    v_lshrrev_b32 v11, 19, v11
    v_mul_u32_u24 v11, 1120, v11
    v_lshl_add_u32 v10, v10, 4, v11
    s_add_u32 m0, s45, 65536
    s_nop 0
    buffer_load_dwordx4 v10, s[32:35], s44 offen  lds
adaLN_cond__sliding_block__swiglu_ffn__prompt_kernel_sd_77:
    v_cvt_pk_bf16_f32 v214, v100, v101
    v_cvt_pk_bf16_f32 v215, v102, v103
    v_exp_f32 v104, v104
    v_exp_f32 v105, v105
    v_exp_f32 v106, v106
    v_exp_f32 v107, v107
    s_waitcnt lgkmcnt(4)
    v_mfma_f32_32x32x16_bf16 v[160:175], v[228:231], v[212:215], v[160:175]
    v_cvt_pk_bf16_f32 v216, v104, v105
    v_cvt_pk_bf16_f32 v217, v106, v107
    v_exp_f32 v108, v108
    v_exp_f32 v109, v109
    v_exp_f32 v110, v110
    v_exp_f32 v111, v111
    v_mfma_f32_32x32x8_bf16 v[80:95], v[60:61], v[144:145], v[80:95]
    v_cvt_pk_bf16_f32 v218, v108, v109
    v_cvt_pk_bf16_f32 v219, v110, v111
    v_exp_f32 v112, v112
    v_exp_f32 v113, v113
    v_exp_f32 v114, v114
    v_exp_f32 v115, v115
    v_mfma_f32_32x32x16_bf16 v[160:175], v[232:235], v[216:219], v[160:175]
    ds_read_b64_tr_b16 v[228:229], v136 offset:30816
    ds_read_b64_tr_b16 v[230:231], v137 offset:30816
    ds_read_b64_tr_b16 v[232:233], v138 offset:30816
    ds_read_b64_tr_b16 v[234:235], v139 offset:30816
    v_cvt_pk_bf16_f32 v220, v112, v113
    v_cvt_pk_bf16_f32 v221, v114, v115
    v_exp_f32 v116, v116
    v_exp_f32 v117, v117
    v_exp_f32 v118, v118
    v_exp_f32 v119, v119
    v_mfma_f32_32x32x16_bf16 v[96:111], v[62:65], v[140:143], 0
    s_cmp_ge_u32 s3, 4
    s_cbranch_scc1 adaLN_cond__sliding_block__swiglu_ffn__prompt_kernel_sd_78
    s_add_u32 s43, s42, 12288
    s_add_u32 m0, s40, 12288
    s_nop 0
    buffer_load_dwordx4 v3, s[28:31], s43 offen offset:3072 sc1 lds
    s_add_u32 s43, s42, 16384
    s_add_u32 m0, s40, 16384
    s_nop 0
    buffer_load_dwordx4 v3, s[28:31], s43 offen sc1 lds
    buffer_load_dwordx4 v3, s[28:31], s43 offen offset:1024 sc1 lds
adaLN_cond__sliding_block__swiglu_ffn__prompt_kernel_sd_78:
    v_cvt_pk_bf16_f32 v222, v116, v117
    v_cvt_pk_bf16_f32 v223, v118, v119
    v_exp_f32 v120, v120
    v_exp_f32 v121, v121
    v_exp_f32 v122, v122
    v_exp_f32 v123, v123
    s_waitcnt lgkmcnt(4)
    v_mfma_f32_32x32x16_bf16 v[160:175], v[236:239], v[220:223], v[160:175]
    v_cvt_pk_bf16_f32 v224, v120, v121
    v_cvt_pk_bf16_f32 v225, v122, v123
    v_exp_f32 v124, v124
    v_exp_f32 v125, v125
    v_exp_f32 v126, v126
    v_exp_f32 v127, v127
    v_mfma_f32_32x32x8_bf16 v[96:111], v[66:67], v[144:145], v[96:111]
    v_cvt_pk_bf16_f32 v226, v124, v125
    v_cvt_pk_bf16_f32 v227, v126, v127
    v_exp_f32 v80, v80
    v_exp_f32 v81, v81
    v_exp_f32 v82, v82
    v_exp_f32 v83, v83
    v_mfma_f32_32x32x16_bf16 v[160:175], v[240:243], v[224:227], v[160:175]
    ds_read_b64_tr_b16 v[236:237], v136 offset:35952
    ds_read_b64_tr_b16 v[238:239], v137 offset:35952
    ds_read_b64_tr_b16 v[240:241], v138 offset:35952
    ds_read_b64_tr_b16 v[242:243], v139 offset:35952
    v_cvt_pk_bf16_f32 v212, v80, v81
    v_cvt_pk_bf16_f32 v213, v82, v83
    v_exp_f32 v84, v84
    v_exp_f32 v85, v85
    v_exp_f32 v86, v86
    v_exp_f32 v87, v87
    v_mfma_f32_32x32x16_bf16 v[112:127], v[68:71], v[140:143], v[176:191]
    s_cmp_ge_u32 s3, 4
    s_cbranch_scc1 adaLN_cond__sliding_block__swiglu_ffn__prompt_kernel_sd_79
    s_add_u32 s43, s42, 16384
    s_add_u32 m0, s40, 16384
    s_nop 0
    buffer_load_dwordx4 v3, s[28:31], s43 offen offset:2048 sc1 lds
    buffer_load_dwordx4 v3, s[28:31], s43 offen offset:3072 sc1 lds
adaLN_cond__sliding_block__swiglu_ffn__prompt_kernel_sd_79:
    v_cvt_pk_bf16_f32 v214, v84, v85
    v_cvt_pk_bf16_f32 v215, v86, v87
    v_exp_f32 v88, v88
    v_exp_f32 v89, v89
    v_exp_f32 v90, v90
    v_exp_f32 v91, v91
    s_waitcnt lgkmcnt(4)
    v_mfma_f32_32x32x16_bf16 v[160:175], v[228:231], v[212:215], v[160:175]
    v_cvt_pk_bf16_f32 v216, v88, v89
    v_cvt_pk_bf16_f32 v217, v90, v91
    v_exp_f32 v92, v92
    v_exp_f32 v93, v93
    v_exp_f32 v94, v94
    v_exp_f32 v95, v95
    v_mfma_f32_32x32x8_bf16 v[112:127], v[72:73], v[144:145], v[112:127]
    v_cvt_pk_bf16_f32 v218, v92, v93
    v_cvt_pk_bf16_f32 v219, v94, v95
    s_cmp_lg_u32 s3, 4
    s_cbranch_scc1 adaLN_cond__sliding_block__swiglu_ffn__prompt_kernel_r2_80
    s_lshl_b32 s57, s60, 7
    s_add_u32 s57, s57, 813056
    s_mov_b64 s[68:69], 0
    s_atomic_add_x2 s[68:69], s[26:27], s57 glc
adaLN_cond__sliding_block__swiglu_ffn__prompt_kernel_r2_80:
    v_exp_f32 v96, v96
    v_exp_f32 v97, v97
    v_exp_f32 v98, v98
    v_exp_f32 v99, v99
    v_mfma_f32_32x32x16_bf16 v[160:175], v[232:235], v[216:219], v[160:175]
    ds_read_b64_tr_b16 v[228:229], v136 offset:41088
    ds_read_b64_tr_b16 v[230:231], v137 offset:41088
    ds_read_b64_tr_b16 v[232:233], v138 offset:41088
    ds_read_b64_tr_b16 v[234:235], v139 offset:41088
    v_cvt_pk_bf16_f32 v220, v96, v97
    v_cvt_pk_bf16_f32 v221, v98, v99
    v_exp_f32 v100, v100
    v_exp_f32 v101, v101
    v_exp_f32 v102, v102
    v_exp_f32 v103, v103
    v_cvt_pk_bf16_f32 v222, v100, v101
    v_cvt_pk_bf16_f32 v223, v102, v103
    v_exp_f32 v104, v104
    v_exp_f32 v105, v105
    v_exp_f32 v106, v106
    v_exp_f32 v107, v107
    s_waitcnt lgkmcnt(4)
    v_mfma_f32_32x32x16_bf16 v[160:175], v[236:239], v[220:223], v[160:175]
    v_cvt_pk_bf16_f32 v224, v104, v105
    v_cvt_pk_bf16_f32 v225, v106, v107
    v_exp_f32 v108, v108
    v_exp_f32 v109, v109
    v_exp_f32 v110, v110
    v_exp_f32 v111, v111
    v_cvt_pk_bf16_f32 v226, v108, v109
    v_cvt_pk_bf16_f32 v227, v110, v111
    v_exp_f32 v112, v112
    v_exp_f32 v113, v113
    v_exp_f32 v114, v114
    v_exp_f32 v115, v115
    v_mfma_f32_32x32x16_bf16 v[160:175], v[240:243], v[224:227], v[160:175]
    v_cvt_pk_bf16_f32 v212, v112, v113
    v_cvt_pk_bf16_f32 v213, v114, v115
    s_lshl_b32 s44, s66, 9
    s_add_u32 s44, s44, 160768
    v_lshlrev_b32 v6, 3, v0
    v_add_u32 v6, s44, v6
    s_lshl_b32 s44, s66, 2
    s_add_u32 s44, s44, 162880
    v_mov_b32 v7, s44
    ds_read_b32 v8, v7
    ds_read_b64 v[14:15], v6
    v_exp_f32 v116, v116
    v_exp_f32 v117, v117
    v_exp_f32 v118, v118
    v_exp_f32 v119, v119
    v_cvt_pk_bf16_f32 v214, v116, v117
    v_cvt_pk_bf16_f32 v215, v118, v119
    v_exp_f32 v120, v120
    v_exp_f32 v121, v121
    v_exp_f32 v122, v122
    v_exp_f32 v123, v123
    s_waitcnt lgkmcnt(0)
    v_mfma_f32_32x32x16_bf16 v[160:175], v[228:231], v[212:215], v[160:175]
    v_cvt_pk_bf16_f32 v216, v120, v121
    v_cvt_pk_bf16_f32 v217, v122, v123
    v_exp_f32 v124, v124
    v_exp_f32 v125, v125
    v_exp_f32 v126, v126
    v_exp_f32 v127, v127
    v_cvt_pk_bf16_f32 v218, v124, v125
    v_cvt_pk_bf16_f32 v219, v126, v127
    s_nop 1
    v_mfma_f32_32x32x16_bf16 v[160:175], v[232:235], v[216:219], v[160:175]
    s_mul_i32 s55, s54, 40960
    s_add_u32 s55, s55, 18874368
    s_lshr_b32 s45, s52, 1
    s_and_b32 s44, s52, 1
    s_lshl_b32 s44, s44, 4
    s_add_u32 s44, s44, s45
    s_lshl_b32 s44, s44, 10
    s_add_u32 s44, s44, s55
    s_lshl_b32 s45, s45, 9
    s_add_u32 s55, s55, s45
    s_add_u32 s55, s55, 30720
    s_nop 0
    v_rcp_f32 v28, v172
    s_nop 0
    v_mul_f32 v160, v160, v28
    v_mul_f32 v161, v161, v28
    v_mul_f32 v162, v162, v28
    v_mul_f32 v163, v163, v28
    v_mul_f32 v164, v164, v28
    v_mul_f32 v165, v165, v28
    v_mul_f32 v166, v166, v28
    v_mul_f32 v167, v167, v28
    v_mul_f32 v168, v168, v28
    v_mul_f32 v169, v169, v28
    v_mul_f32 v170, v170, v28
    v_mul_f32 v171, v171, v28
    v_cvt_pk_bf16_f32 v32, v160, v161
    v_cvt_pk_bf16_f32 v33, v162, v163
    v_cvt_pk_bf16_f32 v34, v164, v165
    v_cvt_pk_bf16_f32 v35, v166, v167
    v_cvt_pk_bf16_f32 v36, v168, v169
    v_cvt_pk_bf16_f32 v37, v170, v171
    buffer_store_dwordx4 v[32:35], v3, s[28:31], s44 offen sc1
    s_cmp_ge_u32 s3, 4
    s_cbranch_scc1 adaLN_cond__sliding_block__swiglu_ffn__prompt_kernel_la_81
    s_waitcnt vmcnt(1)
    ds_write_b64 v6, v[36:37]
    ds_write_b32 v7, v7
    s_waitcnt vmcnt(0)
    v_mov_b32 v250, 162832
    v_mov_b32 v251, 1
    s_mov_b64 exec, 1
    ds_add_rtn_u32 v251, v250, v251
    s_mov_b64 exec, -1
    s_waitcnt lgkmcnt(0)
    v_readfirstlane_b32 s56, v251
    s_nop 0
    s_cmp_lg_u32 s56, 3
    s_cbranch_scc1 adaLN_cond__sliding_block__swiglu_ffn__prompt_kernel_sig_84
    s_lshl_b32 s57, s24, 7
    s_add_u32 s57, s57, 815104
    s_atomic_add_x2 s[10:11], s[26:27], s57
adaLN_cond__sliding_block__swiglu_ffn__prompt_kernel_sig_84:
    s_branch adaLN_cond__sliding_block__swiglu_ffn__prompt_kernel_lb_82
adaLN_cond__sliding_block__swiglu_ffn__prompt_kernel_la_81:
    v_mov_b32 v10, v14
    v_mov_b32 v11, v15
    v_mov_b32 v12, v36
    v_mov_b32 v13, v37
    v_readfirstlane_b32 s44, v8
    s_mov_b32 s58, 0
adaLN_cond__sliding_block__swiglu_ffn__prompt_kernel_lp_85:
    s_cmp_lg_u32 s44, 0
    s_cbranch_scc1 adaLN_cond__sliding_block__swiglu_ffn__prompt_kernel_lc_83
    ds_read_b32 v8, v7
    ds_read_b64 v[10:11], v6
    s_waitcnt lgkmcnt(0)
    v_readfirstlane_b32 s44, v8
    s_add_u32 s58, s58, 1
    s_cmp_lt_u32 s58, 0x100000
    s_cbranch_scc1 adaLN_cond__sliding_block__swiglu_ffn__prompt_kernel_lp_85
adaLN_cond__sliding_block__swiglu_ffn__prompt_kernel_lc_83:
    s_mov_b32 exec_hi, 0
    buffer_store_dwordx4 v[10:13], v3, s[28:31], s55 offen offset:2048 sc1
    s_mov_b32 exec_hi, -1
adaLN_cond__sliding_block__swiglu_ffn__prompt_kernel_lb_82:
    s_cmp_ge_u32 s3, 4
    s_cbranch_scc1 adaLN_cond__sliding_block__swiglu_ffn__prompt_kernel_ld2_6
    s_lshr_b32 s42, s3, 1
    s_and_b32 s43, s3, 1
    v_and_b32 v1, 15, v0
    v_lshrrev_b32 v8, 4, v0
    v_lshlrev_b32 v10, 4, v0
    v_lshlrev_b32 v4, 3, v0
    s_lshl_b32 s44, s62, 6
    s_lshl_b32 s45, s3, 4
    s_add_u32 s44, s44, s45
    s_mul_i32 s47, s3, 2560
    v_add_u32 v4, s47, v4
    v_add_u32 v11, 57344, v10
    v_add_u32 v12, 114688, v10
    v_lshlrev_b32 v5, 4, v8
    s_mul_i32 s48, s63, 320
    s_add_u32 s49, s48, 98304
    buffer_load_dwordx4 v[208:211], v5, s[28:31], s49 offen offset:0 sc1
    buffer_load_dwordx4 v[212:215], v5, s[28:31], s49 offen offset:64 sc1
    buffer_load_dwordx4 v[216:219], v5, s[28:31], s49 offen offset:128 sc1
    buffer_load_dwordx4 v[220:223], v5, s[28:31], s49 offen offset:192 sc1
    buffer_load_dwordx4 v[224:227], v5, s[28:31], s49 offen offset:256 sc1
    s_add_u32 s49, s48, 103424
    buffer_load_dwordx4 v[228:231], v5, s[28:31], s49 offen offset:0 sc1
    buffer_load_dwordx4 v[232:235], v5, s[28:31], s49 offen offset:64 sc1
    buffer_load_dwordx4 v[236:239], v5, s[28:31], s49 offen offset:128 sc1
    buffer_load_dwordx4 v[240:243], v5, s[28:31], s49 offen offset:192 sc1
    buffer_load_dwordx4 v[244:247], v5, s[28:31], s49 offen offset:256 sc1
    v_lshrrev_b32 v6, 1, v8
    v_lshlrev_b32 v6, 9, v6
    v_lshl_add_u32 v6, v1, 4, v6
    v_and_b32 v7, 1, v8
    v_lshl_add_u32 v3, v7, 10, v6
    v_lshl_add_u32 v6, v7, 3, v6
    s_lshl_b32 s54, s62, 1
    s_add_u32 s54, s54, s42
    s_mul_i32 s54, s54, 40960
    s_add_u32 s52, s54, 18874368
    s_mul_i32 s55, s63, 5120
    s_add_u32 s54, s54, s55
    s_lshl_b32 s55, s43, 8
    s_add_u32 s54, s54, s55
    s_add_u32 s54, s54, 22020096
    s_add_u32 s55, s54, 4096
    s_lshl_b32 s53, s44, 7
    s_add_u32 s53, s53, 524288
    s_lshl_b32 s45, s63, 8
    s_add_u32 s53, s53, s45
    v_lshlrev_b32 v2, 4, v1
    v_lshl_add_u32 v2, v8, 9, v2
    s_lshl_b32 s45, s43, 8
    s_add_u32 s52, s52, s45
    v_mul_u32_u24 v9, 160, v1
    v_lshl_add_u32 v9, v8, 3, v9
    s_mul_i32 s45, s3, 3072
    s_add_u32 s45, s45, 63488
    v_add_u32 v9, s45, v9
    v_lshlrev_b32 v13, 2, v0
    s_lshl_b32 s45, s3, 4
    s_add_u32 s45, s45, s61
    s_lshl_b32 s45, s45, 8
    s_add_u32 s45, s45, 131072
    buffer_load_dword v251, v13, s[28:31], s45 offen sc1
    s_lshl_b32 s45, s3, 4
    s_add_u32 s45, s45, s61
    s_lshl_b32 s45, s45, 8
    s_add_u32 s45, s45, 147456
    buffer_load_dword v253, v13, s[28:31], s45 offen sc1
    s_lshl_b32 s45, s3, 10
    s_add_u32 s45, s45, 10240
    v_lshl_add_u32 v13, v0, 3, s45
    v_lshrrev_b32 v14, 5, v0
    v_lshl_add_u32 v13, v14, 8, v13
    s_waitcnt vmcnt(0)
    v_and_b32 v250, 0xffff0000, v251
    v_sub_f32 v251, v251, v250
    v_cvt_pk_bf16_f32 v250, v250, v250
    v_cvt_pk_bf16_f32 v251, v251, v251
    v_and_b32 v252, 0xffff0000, v253
    v_sub_f32 v253, v253, v252
    v_cvt_pk_bf16_f32 v252, v252, v252
    v_cvt_pk_bf16_f32 v253, v253, v253
    ds_read_b64 v[96:97], v9 offset:0
    ds_read_b64 v[98:99], v9 offset:32
    ds_read_b64 v[100:101], v9 offset:64
    ds_read_b64 v[102:103], v9 offset:96
    ds_read_b64 v[104:105], v9 offset:128
    s_waitcnt lgkmcnt(0)
    v_lshlrev_b32 v108, 16, v96
    v_and_b32 v109, 0xffff0000, v96
    v_lshlrev_b32 v110, 16, v97
    v_and_b32 v111, 0xffff0000, v97
    v_lshlrev_b32 v112, 16, v98
    v_and_b32 v113, 0xffff0000, v98
    v_lshlrev_b32 v114, 16, v99
    v_and_b32 v115, 0xffff0000, v99
    v_lshlrev_b32 v116, 16, v100
    v_and_b32 v117, 0xffff0000, v100
    v_lshlrev_b32 v118, 16, v101
    v_and_b32 v119, 0xffff0000, v101
    v_lshlrev_b32 v120, 16, v102
    v_and_b32 v121, 0xffff0000, v102
    v_lshlrev_b32 v122, 16, v103
    v_and_b32 v123, 0xffff0000, v103
    v_lshlrev_b32 v124, 16, v104
    v_and_b32 v125, 0xffff0000, v104
    v_lshlrev_b32 v126, 16, v105
    v_and_b32 v127, 0xffff0000, v105
    s_cmp_lg_u32 s3, 0
    s_cbranch_scc1 adaLN_cond__sliding_block__swiglu_ffn__prompt_kernel_np_86
    s_lshl_b32 s57, s60, 7
    s_add_u32 s57, s57, 815104
    s_waitcnt lgkmcnt(0)
    s_mov_b32 s56, 0
adaLN_cond__sliding_block__swiglu_ffn__prompt_kernel_poll_87:
    s_mov_b64 s[58:59], 0
    s_atomic_add_x2 s[58:59], s[26:27], s57 glc
    s_waitcnt lgkmcnt(0)
    s_sub_u32 s58, s58, s64
    s_subb_u32 s59, s59, s65
    s_cmp_eq_u64 s[58:59], 16
    s_cbranch_scc1 adaLN_cond__sliding_block__swiglu_ffn__prompt_kernel_pdone_88
    s_add_u32 s56, s56, 1
    s_sleep 1
    s_cmp_lt_u32 s56, 0x8000
    s_cbranch_scc1 adaLN_cond__sliding_block__swiglu_ffn__prompt_kernel_poll_87
adaLN_cond__sliding_block__swiglu_ffn__prompt_kernel_pdone_88:
adaLN_cond__sliding_block__swiglu_ffn__prompt_kernel_np_86:
    s_barrier
    ds_write_b64 v13, v[250:251]
    s_cmp_lt_u32 s3, 3
    s_cselect_b32 s45, 16, 1
    s_lshl_b32 s45, s45, 8
    v_add_u32 v13, s45, v13
    ds_write_b64 v13, v[252:253]
    buffer_load_dwordx4 v[128:131], v2, s[28:31], s52 offen offset:0 sc1
    buffer_load_dwordx4 v[132:135], v2, s[28:31], s52 offen offset:2048 sc1
    s_add_u32 s52, s52, 4096
    buffer_load_dwordx4 v[136:139], v2, s[28:31], s52 offen offset:0 sc1
    buffer_load_dwordx4 v[140:143], v2, s[28:31], s52 offen offset:2048 sc1
    s_add_u32 s52, s52, 4096
    buffer_load_dwordx4 v[144:147], v2, s[28:31], s52 offen offset:0 sc1
    buffer_load_dwordx4 v[148:151], v2, s[28:31], s52 offen offset:2048 sc1
    s_add_u32 s52, s52, 4096
    buffer_load_dwordx4 v[152:155], v2, s[28:31], s52 offen offset:0 sc1
    buffer_load_dwordx4 v[156:159], v2, s[28:31], s52 offen offset:2048 sc1
    ds_read_b128 v[36:39], v11 offset:21504
    ds_read_b128 v[40:43], v11 offset:22528
    ds_read_b128 v[44:47], v11 offset:23552
    ds_read_b128 v[48:51], v11 offset:24576
    ds_read_b128 v[52:55], v11 offset:25600
    ds_read_b128 v[56:59], v11 offset:26624
    ds_read_b128 v[60:63], v11 offset:27648
    ds_read_b128 v[64:67], v11 offset:28672
    ds_read_b128 v[68:71], v11 offset:29696
    ds_read_b128 v[72:75], v11 offset:30720
    s_waitcnt lgkmcnt(5)
    s_waitcnt vmcnt(7)
    v_mfma_f32_16x16x32_bf16 v[16:19], v[36:39], v[128:131], 0
    ds_read_b128 v[76:79], v11 offset:31744
    v_mfma_f32_16x16x32_bf16 v[20:23], v[40:43], v[128:131], 0
    ds_read_b128 v[80:83], v11 offset:32768
    v_mfma_f32_16x16x32_bf16 v[24:27], v[44:47], v[128:131], 0
    ds_read_b128 v[84:87], v11 offset:33792
    v_mfma_f32_16x16x32_bf16 v[28:31], v[48:51], v[128:131], 0
    ds_read_b128 v[88:91], v11 offset:34816
    v_mfma_f32_16x16x32_bf16 v[32:35], v[52:55], v[128:131], 0
    ds_read_b128 v[92:95], v11 offset:35840
    s_waitcnt lgkmcnt(5)
    s_waitcnt vmcnt(6)
    v_mfma_f32_16x16x32_bf16 v[16:19], v[56:59], v[132:135], v[16:19]
    ds_read_b128 v[36:39], v11 offset:36864
    v_mfma_f32_16x16x32_bf16 v[20:23], v[60:63], v[132:135], v[20:23]
    ds_read_b128 v[40:43], v11 offset:37888
    v_mfma_f32_16x16x32_bf16 v[24:27], v[64:67], v[132:135], v[24:27]
    ds_read_b128 v[44:47], v11 offset:38912
    v_mfma_f32_16x16x32_bf16 v[28:31], v[68:71], v[132:135], v[28:31]
    ds_read_b128 v[48:51], v11 offset:39936
    v_mfma_f32_16x16x32_bf16 v[32:35], v[72:75], v[132:135], v[32:35]
    ds_read_b128 v[52:55], v11 offset:40960
    s_waitcnt lgkmcnt(5)
    s_waitcnt vmcnt(5)
    v_mfma_f32_16x16x32_bf16 v[16:19], v[76:79], v[136:139], v[16:19]
    ds_read_b128 v[56:59], v11 offset:41984
    v_mfma_f32_16x16x32_bf16 v[20:23], v[80:83], v[136:139], v[20:23]
    ds_read_b128 v[60:63], v11 offset:43008
    v_mfma_f32_16x16x32_bf16 v[24:27], v[84:87], v[136:139], v[24:27]
    ds_read_b128 v[64:67], v11 offset:44032
    v_mfma_f32_16x16x32_bf16 v[28:31], v[88:91], v[136:139], v[28:31]
    ds_read_b128 v[68:71], v11 offset:45056
    v_mfma_f32_16x16x32_bf16 v[32:35], v[92:95], v[136:139], v[32:35]
    ds_read_b128 v[72:75], v11 offset:46080
    s_waitcnt lgkmcnt(5)
    s_waitcnt vmcnt(4)
    v_mfma_f32_16x16x32_bf16 v[16:19], v[36:39], v[140:143], v[16:19]
    ds_read_b128 v[76:79], v11 offset:47104
    v_mfma_f32_16x16x32_bf16 v[20:23], v[40:43], v[140:143], v[20:23]
    ds_read_b128 v[80:83], v11 offset:48128
    v_mfma_f32_16x16x32_bf16 v[24:27], v[44:47], v[140:143], v[24:27]
    ds_read_b128 v[84:87], v11 offset:49152
    v_mfma_f32_16x16x32_bf16 v[28:31], v[48:51], v[140:143], v[28:31]
    ds_read_b128 v[88:91], v11 offset:50176
    v_mfma_f32_16x16x32_bf16 v[32:35], v[52:55], v[140:143], v[32:35]
    ds_read_b128 v[92:95], v11 offset:51200
    s_waitcnt lgkmcnt(5)
    s_waitcnt vmcnt(3)
    v_mfma_f32_16x16x32_bf16 v[16:19], v[56:59], v[144:147], v[16:19]
    ds_read_b128 v[36:39], v11 offset:52224
    v_mfma_f32_16x16x32_bf16 v[20:23], v[60:63], v[144:147], v[20:23]
    ds_read_b128 v[40:43], v11 offset:53248
    v_mfma_f32_16x16x32_bf16 v[24:27], v[64:67], v[144:147], v[24:27]
    ds_read_b128 v[44:47], v11 offset:54272
    v_mfma_f32_16x16x32_bf16 v[28:31], v[68:71], v[144:147], v[28:31]
    ds_read_b128 v[48:51], v11 offset:55296
    v_mfma_f32_16x16x32_bf16 v[32:35], v[72:75], v[144:147], v[32:35]
    ds_read_b128 v[52:55], v11 offset:56320
    s_waitcnt lgkmcnt(5)
    s_waitcnt vmcnt(2)
    v_mfma_f32_16x16x32_bf16 v[16:19], v[76:79], v[148:151], v[16:19]
    ds_read_b128 v[56:59], v12 offset:0
    v_mfma_f32_16x16x32_bf16 v[20:23], v[80:83], v[148:151], v[20:23]
    ds_read_b128 v[60:63], v12 offset:1024
    v_mfma_f32_16x16x32_bf16 v[24:27], v[84:87], v[148:151], v[24:27]
    ds_read_b128 v[64:67], v12 offset:2048
    v_mfma_f32_16x16x32_bf16 v[28:31], v[88:91], v[148:151], v[28:31]
    ds_read_b128 v[68:71], v12 offset:3072
    v_mfma_f32_16x16x32_bf16 v[32:35], v[92:95], v[148:151], v[32:35]
    ds_read_b128 v[72:75], v12 offset:4096
    s_waitcnt lgkmcnt(5)
    s_waitcnt vmcnt(1)
    v_mfma_f32_16x16x32_bf16 v[16:19], v[36:39], v[152:155], v[16:19]
    ds_read_b128 v[76:79], v12 offset:5120
    v_mfma_f32_16x16x32_bf16 v[20:23], v[40:43], v[152:155], v[20:23]
    ds_read_b128 v[80:83], v12 offset:6144
    v_mfma_f32_16x16x32_bf16 v[24:27], v[44:47], v[152:155], v[24:27]
    ds_read_b128 v[84:87], v12 offset:7168
    v_mfma_f32_16x16x32_bf16 v[28:31], v[48:51], v[152:155], v[28:31]
    ds_read_b128 v[88:91], v12 offset:8192
    v_mfma_f32_16x16x32_bf16 v[32:35], v[52:55], v[152:155], v[32:35]
    ds_read_b128 v[92:95], v12 offset:9216
    s_waitcnt lgkmcnt(5)
    s_barrier
    s_add_u32 s52, s52, 4096
    buffer_load_dwordx4 v[160:163], v2, s[28:31], s52 offen offset:0 sc1
    buffer_load_dwordx4 v[164:167], v2, s[28:31], s52 offen offset:2048 sc1
    s_add_u32 s52, s52, 4096
    buffer_load_dwordx4 v[168:171], v2, s[28:31], s52 offen offset:0 sc1
    buffer_load_dwordx4 v[172:175], v2, s[28:31], s52 offen offset:2048 sc1
    s_add_u32 s52, s52, 4096
    buffer_load_dwordx4 v[176:179], v2, s[28:31], s52 offen offset:0 sc1
    buffer_load_dwordx4 v[180:183], v2, s[28:31], s52 offen offset:2048 sc1
    s_add_u32 s52, s52, 4096
    buffer_load_dwordx4 v[184:187], v2, s[28:31], s52 offen offset:0 sc1
    buffer_load_dwordx4 v[188:191], v2, s[28:31], s52 offen offset:2048 sc1
    s_waitcnt vmcnt(8)
    v_mfma_f32_16x16x32_bf16 v[16:19], v[56:59], v[156:159], v[16:19]
    ds_read_b128 v[36:39], v12 offset:10240
    v_mfma_f32_16x16x32_bf16 v[20:23], v[60:63], v[156:159], v[20:23]
    ds_read_b128 v[40:43], v12 offset:11264
    v_mfma_f32_16x16x32_bf16 v[24:27], v[64:67], v[156:159], v[24:27]
    ds_read_b128 v[44:47], v12 offset:12288
    v_mfma_f32_16x16x32_bf16 v[28:31], v[68:71], v[156:159], v[28:31]
    ds_read_b128 v[48:51], v12 offset:13312
    v_mfma_f32_16x16x32_bf16 v[32:35], v[72:75], v[156:159], v[32:35]
    ds_read_b128 v[52:55], v12 offset:14336
    s_waitcnt lgkmcnt(5)
    s_waitcnt vmcnt(7)
    v_mfma_f32_16x16x32_bf16 v[16:19], v[76:79], v[160:163], v[16:19]
    ds_read_b128 v[56:59], v12 offset:15360
    v_mfma_f32_16x16x32_bf16 v[20:23], v[80:83], v[160:163], v[20:23]
    ds_read_b128 v[60:63], v12 offset:16384
    s_add_u32 s52, s52, 4096
    buffer_load_dwordx4 v[192:195], v2, s[28:31], s52 offen offset:0 sc1
    v_mfma_f32_16x16x32_bf16 v[24:27], v[84:87], v[160:163], v[24:27]
    ds_read_b128 v[64:67], v12 offset:17408
    v_mfma_f32_16x16x32_bf16 v[28:31], v[88:91], v[160:163], v[28:31]
    ds_read_b128 v[68:71], v12 offset:18432
    v_mfma_f32_16x16x32_bf16 v[32:35], v[92:95], v[160:163], v[32:35]
    ds_read_b128 v[72:75], v12 offset:19456
    s_waitcnt lgkmcnt(5)
    s_waitcnt vmcnt(7)
    v_mfma_f32_16x16x32_bf16 v[16:19], v[36:39], v[164:167], v[16:19]
    ds_read_b128 v[76:79], v12 offset:20480
    v_mfma_f32_16x16x32_bf16 v[20:23], v[40:43], v[164:167], v[20:23]
    ds_read_b128 v[80:83], v12 offset:21504
    buffer_load_dwordx4 v[196:199], v2, s[28:31], s52 offen offset:2048 sc1
    v_mfma_f32_16x16x32_bf16 v[24:27], v[44:47], v[164:167], v[24:27]
    ds_read_b128 v[84:87], v12 offset:22528
    v_mfma_f32_16x16x32_bf16 v[28:31], v[48:51], v[164:167], v[28:31]
    ds_read_b128 v[88:91], v12 offset:23552
    v_mfma_f32_16x16x32_bf16 v[32:35], v[52:55], v[164:167], v[32:35]
    ds_read_b128 v[92:95], v12 offset:24576
    s_waitcnt lgkmcnt(5)
    s_waitcnt lgkmcnt(0)
    s_barrier
    s_waitcnt vmcnt(7)
    v_mfma_f32_16x16x32_bf16 v[16:19], v[56:59], v[168:171], v[16:19]
    ds_read_b128 v[36:39], v12 offset:25600
    v_mfma_f32_16x16x32_bf16 v[20:23], v[60:63], v[168:171], v[20:23]
    ds_read_b128 v[40:43], v12 offset:26624
    s_add_u32 s52, s52, 4096
    buffer_load_dwordx4 v[200:203], v2, s[28:31], s52 offen offset:0 sc1
    v_mfma_f32_16x16x32_bf16 v[24:27], v[64:67], v[168:171], v[24:27]
    ds_read_b128 v[44:47], v12 offset:27648
    v_mfma_f32_16x16x32_bf16 v[28:31], v[68:71], v[168:171], v[28:31]
    ds_read_b128 v[48:51], v12 offset:28672
    v_mfma_f32_16x16x32_bf16 v[32:35], v[72:75], v[168:171], v[32:35]
    ds_read_b128 v[52:55], v12 offset:29696
    s_waitcnt vmcnt(7)
    v_mfma_f32_16x16x32_bf16 v[16:19], v[76:79], v[172:175], v[16:19]
    ds_read_b128 v[56:59], v12 offset:30720
    v_mfma_f32_16x16x32_bf16 v[20:23], v[80:83], v[172:175], v[20:23]
    ds_read_b128 v[60:63], v12 offset:31744
    buffer_load_dwordx4 v[204:207], v2, s[28:31], s52 offen offset:2048 sc1
    v_mfma_f32_16x16x32_bf16 v[24:27], v[84:87], v[172:175], v[24:27]
    ds_read_b128 v[64:67], v12 offset:32768
    v_mfma_f32_16x16x32_bf16 v[28:31], v[88:91], v[172:175], v[28:31]
    ds_read_b128 v[68:71], v12 offset:33792
    v_mfma_f32_16x16x32_bf16 v[32:35], v[92:95], v[172:175], v[32:35]
    ds_read_b128 v[72:75], v12 offset:34816
    s_waitcnt lgkmcnt(5)
    s_waitcnt vmcnt(7)
    v_mfma_f32_16x16x32_bf16 v[16:19], v[36:39], v[176:179], v[16:19]
    ds_read_b128 v[76:79], v12 offset:35840
    v_mfma_f32_16x16x32_bf16 v[20:23], v[40:43], v[176:179], v[20:23]
    ds_read_b128 v[80:83], v12 offset:36864
    v_mfma_f32_16x16x32_bf16 v[24:27], v[44:47], v[176:179], v[24:27]
    ds_read_b128 v[84:87], v12 offset:37888
    v_mfma_f32_16x16x32_bf16 v[28:31], v[48:51], v[176:179], v[28:31]
    ds_read_b128 v[88:91], v12 offset:38912
    v_mfma_f32_16x16x32_bf16 v[32:35], v[52:55], v[176:179], v[32:35]
    ds_read_b128 v[92:95], v12 offset:39936
    s_waitcnt lgkmcnt(5)
    s_waitcnt vmcnt(6)
    v_mfma_f32_16x16x32_bf16 v[16:19], v[56:59], v[180:183], v[16:19]
    ds_read_b128 v[36:39], v12 offset:40960
    v_mfma_f32_16x16x32_bf16 v[20:23], v[60:63], v[180:183], v[20:23]
    ds_read_b128 v[40:43], v12 offset:41984
    v_mfma_f32_16x16x32_bf16 v[24:27], v[64:67], v[180:183], v[24:27]
    ds_read_b128 v[44:47], v12 offset:43008
    v_mfma_f32_16x16x32_bf16 v[28:31], v[68:71], v[180:183], v[28:31]
    ds_read_b128 v[48:51], v12 offset:44032
    v_mfma_f32_16x16x32_bf16 v[32:35], v[72:75], v[180:183], v[32:35]
    ds_read_b128 v[52:55], v12 offset:45056
    s_waitcnt lgkmcnt(5)
    s_waitcnt lgkmcnt(0)
    s_barrier
    s_waitcnt vmcnt(5)
    v_mfma_f32_16x16x32_bf16 v[16:19], v[76:79], v[184:187], v[16:19]
    ds_read_b128 v[56:59], v11 offset:1024
    v_mfma_f32_16x16x32_bf16 v[20:23], v[80:83], v[184:187], v[20:23]
    ds_read_b128 v[60:63], v11 offset:2048
    v_mfma_f32_16x16x32_bf16 v[24:27], v[84:87], v[184:187], v[24:27]
    ds_read_b128 v[64:67], v11 offset:3072
    v_mfma_f32_16x16x32_bf16 v[28:31], v[88:91], v[184:187], v[28:31]
    ds_read_b128 v[68:71], v11 offset:4096
    v_mfma_f32_16x16x32_bf16 v[32:35], v[92:95], v[184:187], v[32:35]
    ds_read_b128 v[72:75], v11 offset:5120
    s_waitcnt vmcnt(4)
    v_mfma_f32_16x16x32_bf16 v[16:19], v[36:39], v[188:191], v[16:19]
    ds_read_b128 v[76:79], v11 offset:6144
    v_mfma_f32_16x16x32_bf16 v[20:23], v[40:43], v[188:191], v[20:23]
    ds_read_b128 v[80:83], v11 offset:7168
    v_mfma_f32_16x16x32_bf16 v[24:27], v[44:47], v[188:191], v[24:27]
    ds_read_b128 v[84:87], v11 offset:8192
    v_mfma_f32_16x16x32_bf16 v[28:31], v[48:51], v[188:191], v[28:31]
    ds_read_b128 v[88:91], v11 offset:9216
    v_mfma_f32_16x16x32_bf16 v[32:35], v[52:55], v[188:191], v[32:35]
    ds_read_b128 v[92:95], v11 offset:10240
    s_waitcnt lgkmcnt(5)
    s_waitcnt vmcnt(3)
    v_mfma_f32_16x16x32_bf16 v[16:19], v[56:59], v[192:195], v[16:19]
    ds_read_b128 v[36:39], v11 offset:11264
    v_mfma_f32_16x16x32_bf16 v[20:23], v[60:63], v[192:195], v[20:23]
    s_nop 0
hop_pad_11:
    s_cbranch_execz hop_back
    ds_read_b128 v[40:43], v11 offset:12288
    v_mfma_f32_16x16x32_bf16 v[24:27], v[64:67], v[192:195], v[24:27]
    ds_read_b128 v[44:47], v11 offset:13312
    v_mfma_f32_16x16x32_bf16 v[28:31], v[68:71], v[192:195], v[28:31]
    ds_read_b128 v[48:51], v11 offset:14336
    v_mfma_f32_16x16x32_bf16 v[32:35], v[72:75], v[192:195], v[32:35]
    ds_read_b128 v[52:55], v11 offset:15360
    s_waitcnt lgkmcnt(5)
    s_waitcnt vmcnt(2)
    v_mfma_f32_16x16x32_bf16 v[16:19], v[76:79], v[196:199], v[16:19]
    ds_read_b128 v[56:59], v11 offset:16384
    v_mfma_f32_16x16x32_bf16 v[20:23], v[80:83], v[196:199], v[20:23]
    ds_read_b128 v[60:63], v11 offset:17408
    v_mfma_f32_16x16x32_bf16 v[24:27], v[84:87], v[196:199], v[24:27]
    ds_read_b128 v[64:67], v11 offset:18432
    v_mfma_f32_16x16x32_bf16 v[28:31], v[88:91], v[196:199], v[28:31]
    ds_read_b128 v[68:71], v11 offset:19456
    v_mfma_f32_16x16x32_bf16 v[32:35], v[92:95], v[196:199], v[32:35]
    ds_read_b128 v[72:75], v11 offset:20480
    s_waitcnt lgkmcnt(5)
    s_waitcnt vmcnt(1)
    v_mfma_f32_16x16x32_bf16 v[16:19], v[36:39], v[200:203], v[16:19]
    v_mfma_f32_16x16x32_bf16 v[20:23], v[40:43], v[200:203], v[20:23]
    v_mfma_f32_16x16x32_bf16 v[24:27], v[44:47], v[200:203], v[24:27]
    v_mfma_f32_16x16x32_bf16 v[28:31], v[48:51], v[200:203], v[28:31]
    v_mfma_f32_16x16x32_bf16 v[32:35], v[52:55], v[200:203], v[32:35]
    s_waitcnt lgkmcnt(0)
    s_barrier
    s_waitcnt vmcnt(0)
    v_mfma_f32_16x16x32_bf16 v[16:19], v[56:59], v[204:207], v[16:19]
    v_mfma_f32_16x16x32_bf16 v[20:23], v[60:63], v[204:207], v[20:23]
    v_mfma_f32_16x16x32_bf16 v[24:27], v[64:67], v[204:207], v[24:27]
    v_mfma_f32_16x16x32_bf16 v[28:31], v[68:71], v[204:207], v[28:31]
    v_mfma_f32_16x16x32_bf16 v[32:35], v[72:75], v[204:207], v[32:35]
    s_nop 3
    v_pk_fma_f32 v[108:109], v[16:17], v[208:209], v[108:109]
    v_pk_fma_f32 v[110:111], v[18:19], v[210:211], v[110:111]
    v_pk_mul_f32 v[16:17], v[108:109], v[228:229]
    v_pk_mul_f32 v[18:19], v[110:111], v[230:231]
    v_cvt_pk_bf16_f32 v36, v16, v17
    v_cvt_pk_bf16_f32 v37, v18, v19
    v_pk_fma_f32 v[112:113], v[20:21], v[212:213], v[112:113]
    v_pk_fma_f32 v[114:115], v[22:23], v[214:215], v[114:115]
    v_pk_mul_f32 v[20:21], v[112:113], v[232:233]
    v_pk_mul_f32 v[22:23], v[114:115], v[234:235]
    v_cvt_pk_bf16_f32 v38, v20, v21
    v_cvt_pk_bf16_f32 v39, v22, v23
    s_nop 0
    v_permlane16_swap_b32 v36, v38
    v_permlane16_swap_b32 v37, v39
    buffer_store_dwordx4 v[36:39], v3, s[28:31], s54 offen offset:0 sc1
    v_pk_fma_f32 v[116:117], v[24:25], v[216:217], v[116:117]
    v_pk_fma_f32 v[118:119], v[26:27], v[218:219], v[118:119]
    v_pk_mul_f32 v[24:25], v[116:117], v[236:237]
    v_pk_mul_f32 v[26:27], v[118:119], v[238:239]
    v_cvt_pk_bf16_f32 v40, v24, v25
    v_cvt_pk_bf16_f32 v41, v26, v27
    v_pk_fma_f32 v[120:121], v[28:29], v[220:221], v[120:121]
    v_pk_fma_f32 v[122:123], v[30:31], v[222:223], v[122:123]
    v_pk_mul_f32 v[28:29], v[120:121], v[240:241]
    v_pk_mul_f32 v[30:31], v[122:123], v[242:243]
    v_cvt_pk_bf16_f32 v42, v28, v29
    v_cvt_pk_bf16_f32 v43, v30, v31
    s_nop 0
    v_permlane16_swap_b32 v40, v42
    v_permlane16_swap_b32 v41, v43
    buffer_store_dwordx4 v[40:43], v3, s[28:31], s54 offen offset:2048 sc1
    v_pk_fma_f32 v[124:125], v[32:33], v[224:225], v[124:125]
    v_pk_fma_f32 v[126:127], v[34:35], v[226:227], v[126:127]
    v_pk_mul_f32 v[32:33], v[124:125], v[244:245]
    v_pk_mul_f32 v[34:35], v[126:127], v[246:247]
    v_cvt_pk_bf16_f32 v44, v32, v33
    v_cvt_pk_bf16_f32 v45, v34, v35
    buffer_store_dwordx2 v[44:45], v6, s[28:31], s55 offen offset:0 sc1
    v_pk_mul_f32 v[14:15], v[108:109], v[108:109]
    v_pk_add_f32 v[12:13], v[108:109], v[110:111]
    v_pk_fma_f32 v[14:15], v[110:111], v[110:111], v[14:15]
    v_pk_fma_f32 v[14:15], v[112:113], v[112:113], v[14:15]
    v_pk_add_f32 v[12:13], v[12:13], v[112:113]
    v_pk_fma_f32 v[14:15], v[114:115], v[114:115], v[14:15]
    v_pk_add_f32 v[12:13], v[12:13], v[114:115]
    v_pk_fma_f32 v[14:15], v[116:117], v[116:117], v[14:15]
    v_pk_add_f32 v[12:13], v[12:13], v[116:117]
    v_pk_fma_f32 v[14:15], v[118:119], v[118:119], v[14:15]
    v_pk_add_f32 v[12:13], v[12:13], v[118:119]
    v_pk_fma_f32 v[14:15], v[120:121], v[120:121], v[14:15]
    v_pk_add_f32 v[12:13], v[12:13], v[120:121]
    v_pk_fma_f32 v[14:15], v[122:123], v[122:123], v[14:15]
    v_pk_add_f32 v[12:13], v[12:13], v[122:123]
    v_pk_fma_f32 v[14:15], v[124:125], v[124:125], v[14:15]
    v_pk_add_f32 v[12:13], v[12:13], v[124:125]
    v_pk_fma_f32 v[14:15], v[126:127], v[126:127], v[14:15]
    v_pk_add_f32 v[12:13], v[12:13], v[126:127]
    v_add_f32 v12, v12, v13
    v_add_f32 v13, v14, v15
    v_mov_b32 v14, v12
    v_mov_b32 v15, v13
    s_nop 0
    v_permlane16_swap_b32 v12, v14
    v_permlane16_swap_b32 v13, v15
    v_add_f32 v12, v12, v14
    v_add_f32 v13, v13, v15
    v_mov_b32 v14, v12
    v_mov_b32 v15, v13
    s_nop 0
    v_permlane32_swap_b32 v12, v14
    v_permlane32_swap_b32 v13, v15
    v_add_f32 v12, v12, v14
    v_add_f32 v13, v13, v15
    s_mov_b64 exec, 0xffff
    buffer_store_dwordx4 v[12:15], v10, s[28:31], s53 offen sc1
    s_mov_b64 exec, -1
    s_barrier
    v_cvt_pk_bf16_f32 v96, v108, v109
    v_cvt_pk_bf16_f32 v97, v110, v111
    v_cvt_pk_bf16_f32 v98, v112, v113
    v_cvt_pk_bf16_f32 v99, v114, v115
    v_cvt_pk_bf16_f32 v100, v116, v117
    v_cvt_pk_bf16_f32 v101, v118, v119
    v_cvt_pk_bf16_f32 v102, v120, v121
    v_cvt_pk_bf16_f32 v103, v122, v123
    v_cvt_pk_bf16_f32 v104, v124, v125
    v_cvt_pk_bf16_f32 v105, v126, v127
    ds_write_b64 v4, v[96:97] offset:0
    ds_write_b64 v4, v[98:99] offset:512
    ds_write_b64 v4, v[100:101] offset:1024
    ds_write_b64 v4, v[102:103] offset:1536
    ds_write_b64 v4, v[104:105] offset:2048
    v_lshlrev_b32 v3, 4, v0
    s_lshl_b32 s44, s60, 2
    s_add_u32 s44, s44, s3
    s_mul_i32 s45, s44, 40960
    s_add_u32 s45, s45, 22020096
    s_mul_i32 s46, s44, 114688
    s_lshl_b32 s47, s61, 10
    s_add_u32 s46, s46, s47
    s_add_u32 s46, s46, 28311552
    v_add_u32 v7, 0x10000, v3
    v_add_u32 v1, 0x20000, v3
    s_mov_b32 s48, 0xbfb8aa3b
    s_mov_b32 s49, 160768
    v_and_b32 v2, 15, v0
    v_lshlrev_b32 v2, 4, v2
    v_lshrrev_b32 v6, 4, v0
    v_lshl_add_u32 v2, v6, 9, v2
    s_lshl_b32 s52, s62, 1
    s_lshr_b32 s53, s3, 1
    s_add_u32 s52, s52, s53
    s_mul_i32 s52, s52, 114688
    s_and_b32 s53, s3, 1
    s_lshl_b32 s53, s53, 8
    s_add_u32 s52, s52, s53
    s_add_u32 s52, s52, 28311552
    s_lshl_b32 s43, s44, 12
    s_add_u32 s43, s43, 524288
    v_cmp_eq_u32 s[50:51], 1, v6
    v_cmp_lt_u32 s[54:55], 1, v6
    v_and_b32 v6, 31, v0
    v_lshlrev_b32 v6, 3, v6
    v_add_u32 v6, 10240, v6
    v_mov_b32 v84, 0
    v_mov_b32 v85, 0
    s_waitcnt vmcnt(0)
    s_barrier
    s_cmp_lg_u32 s3, 0
    s_cbranch_scc1 adaLN_cond__sliding_block__swiglu_ffn__prompt_kernel_np_89
    s_lshl_b32 s57, s60, 7
    s_add_u32 s57, s57, 800768
    s_atomic_add_x2 s[10:11], s[26:27], s57
    s_lshl_b32 s57, s60, 7
    s_add_u32 s57, s57, 800768
    s_waitcnt lgkmcnt(0)
    s_mov_b32 s56, 0
adaLN_cond__sliding_block__swiglu_ffn__prompt_kernel_poll_90:
    s_mov_b64 s[58:59], 0
    s_atomic_add_x2 s[58:59], s[26:27], s57 glc
    s_waitcnt lgkmcnt(0)
    s_sub_u32 s58, s58, s64
    s_subb_u32 s59, s59, s65
    s_cmp_eq_u64 s[58:59], 16
    s_cbranch_scc1 adaLN_cond__sliding_block__swiglu_ffn__prompt_kernel_pdone_91
    s_add_u32 s56, s56, 1
    s_sleep 1
    s_cmp_lt_u32 s56, 0x8000
    s_cbranch_scc1 adaLN_cond__sliding_block__swiglu_ffn__prompt_kernel_poll_90
adaLN_cond__sliding_block__swiglu_ffn__prompt_kernel_pdone_91:
adaLN_cond__sliding_block__swiglu_ffn__prompt_kernel_np_89:
    s_waitcnt lgkmcnt(0)
    s_barrier
    buffer_load_dwordx4 v[96:99], v2, s[28:31], s45 offen offset:0 sc1
    buffer_load_dwordx4 v[100:103], v2, s[28:31], s45 offen offset:256 sc1
    buffer_load_dwordx4 v[104:107], v2, s[28:31], s45 offen offset:2048 sc1
    buffer_load_dwordx4 v[108:111], v2, s[28:31], s45 offen offset:2304 sc1
    s_add_u32 s45, s45, 4096
    buffer_load_dwordx4 v[112:115], v2, s[28:31], s45 offen offset:0 sc1
    buffer_load_dwordx4 v[116:119], v2, s[28:31], s45 offen offset:256 sc1
    buffer_load_dwordx4 v[120:123], v2, s[28:31], s45 offen offset:2048 sc1
    buffer_load_dwordx4 v[124:127], v2, s[28:31], s45 offen offset:2304 sc1
    s_add_u32 s45, s45, 4096
    buffer_load_dwordx4 v[128:131], v2, s[28:31], s45 offen offset:0 sc1
    buffer_load_dwordx4 v[132:135], v2, s[28:31], s45 offen offset:256 sc1
    buffer_load_dwordx2 v[64:65], v2, s[28:31], s43 offen offset:0 sc1
    buffer_load_dwordx2 v[66:67], v2, s[28:31], s43 offen offset:256 sc1
    buffer_load_dwordx2 v[68:69], v2, s[28:31], s43 offen offset:2048 sc1
    buffer_load_dwordx2 v[70:71], v2, s[28:31], s43 offen offset:2304 sc1
    ds_read_b128 v[8:11], v3 offset:17408
    ds_read_b128 v[12:15], v3 offset:18432
    ds_read_b128 v[16:19], v3 offset:37888
    ds_read_b128 v[20:23], v3 offset:38912
    ds_read_b128 v[24:27], v3 offset:19456
    ds_read_b128 v[28:31], v3 offset:20480
    s_waitcnt vmcnt(12)
    s_waitcnt lgkmcnt(3)
    v_mfma_f32_16x16x32_bf16 v[32:35], v[8:11], v[96:99], 0
    v_mfma_f32_16x16x32_bf16 v[36:39], v[8:11], v[100:103], 0
    ds_read_b128 v[92:95], v3 offset:39936
    v_mfma_f32_16x16x32_bf16 v[40:43], v[12:15], v[96:99], 0
    v_mfma_f32_16x16x32_bf16 v[44:47], v[12:15], v[100:103], 0
    ds_read_b128 v[8:11], v3 offset:40960
    buffer_load_dwordx4 v[136:139], v2, s[28:31], s45 offen offset:2048 sc1
    v_mfma_f32_16x16x32_bf16 v[48:51], v[16:19], v[96:99], 0
    v_mfma_f32_16x16x32_bf16 v[52:55], v[16:19], v[100:103], 0
    ds_read_b128 v[12:15], v3 offset:21504
    s_waitcnt lgkmcnt(3)
    v_mfma_f32_16x16x32_bf16 v[56:59], v[20:23], v[96:99], 0
    v_mfma_f32_16x16x32_bf16 v[60:63], v[20:23], v[100:103], 0
    ds_read_b128 v[16:19], v3 offset:22528
    buffer_load_dwordx4 v[140:143], v2, s[28:31], s45 offen offset:2304 sc1
    s_waitcnt vmcnt(12)
    v_mfma_f32_16x16x32_bf16 v[32:35], v[24:27], v[104:107], v[32:35]
    v_mfma_f32_16x16x32_bf16 v[36:39], v[24:27], v[108:111], v[36:39]
    ds_read_b128 v[20:23], v3 offset:41984
    v_mfma_f32_16x16x32_bf16 v[40:43], v[28:31], v[104:107], v[40:43]
    v_mfma_f32_16x16x32_bf16 v[44:47], v[28:31], v[108:111], v[44:47]
    ds_read_b128 v[24:27], v3 offset:43008
    s_add_u32 s45, s45, 4096
    buffer_load_dwordx4 v[144:147], v2, s[28:31], s45 offen offset:0 sc1
    s_waitcnt lgkmcnt(3)
    v_mfma_f32_16x16x32_bf16 v[48:51], v[92:95], v[104:107], v[48:51]
    v_mfma_f32_16x16x32_bf16 v[52:55], v[92:95], v[108:111], v[52:55]
    ds_read_b128 v[28:31], v3 offset:23552
    v_mfma_f32_16x16x32_bf16 v[56:59], v[8:11], v[104:107], v[56:59]
    v_mfma_f32_16x16x32_bf16 v[60:63], v[8:11], v[108:111], v[60:63]
    ds_read_b128 v[92:95], v3 offset:24576
    buffer_load_dwordx4 v[148:151], v2, s[28:31], s45 offen offset:256 sc1
    s_waitcnt vmcnt(12)
    v_mfma_f32_16x16x32_bf16 v[32:35], v[12:15], v[112:115], v[32:35]
    v_mfma_f32_16x16x32_bf16 v[36:39], v[12:15], v[116:119], v[36:39]
    ds_read_b128 v[8:11], v3 offset:44032
    s_waitcnt lgkmcnt(3)
    v_mfma_f32_16x16x32_bf16 v[40:43], v[16:19], v[112:115], v[40:43]
    v_mfma_f32_16x16x32_bf16 v[44:47], v[16:19], v[116:119], v[44:47]
    ds_read_b128 v[12:15], v3 offset:45056
    buffer_load_dwordx4 v[152:155], v2, s[28:31], s45 offen offset:2048 sc1
    v_mfma_f32_16x16x32_bf16 v[48:51], v[20:23], v[112:115], v[48:51]
    v_mfma_f32_16x16x32_bf16 v[52:55], v[20:23], v[116:119], v[52:55]
    ds_read_b128 v[16:19], v3 offset:25600
    v_mfma_f32_16x16x32_bf16 v[56:59], v[24:27], v[112:115], v[56:59]
    v_mfma_f32_16x16x32_bf16 v[60:63], v[24:27], v[116:119], v[60:63]
    ds_read_b128 v[20:23], v3 offset:26624
    buffer_load_dwordx4 v[156:159], v2, s[28:31], s45 offen offset:2304 sc1
    s_waitcnt vmcnt(12)
    s_waitcnt lgkmcnt(3)
    v_mfma_f32_16x16x32_bf16 v[32:35], v[28:31], v[120:123], v[32:35]
    v_mfma_f32_16x16x32_bf16 v[36:39], v[28:31], v[124:127], v[36:39]
    ds_read_b128 v[24:27], v3 offset:46080
    v_mfma_f32_16x16x32_bf16 v[40:43], v[92:95], v[120:123], v[40:43]
    v_mfma_f32_16x16x32_bf16 v[44:47], v[92:95], v[124:127], v[44:47]
    ds_read_b128 v[28:31], v3 offset:47104
    s_add_u32 s45, s45, 4096
    buffer_load_dwordx4 v[160:163], v2, s[28:31], s45 offen offset:0 sc1
    v_mfma_f32_16x16x32_bf16 v[48:51], v[8:11], v[120:123], v[48:51]
    s_waitcnt vmcnt(7)
    v_add_f32 v64, v64, v66
    v_mfma_f32_16x16x32_bf16 v[52:55], v[8:11], v[124:127], v[52:55]
    ds_read_b128 v[92:95], v3 offset:27648
    s_waitcnt lgkmcnt(3)
    v_mfma_f32_16x16x32_bf16 v[56:59], v[12:15], v[120:123], v[56:59]
    v_add_f32 v65, v65, v67
    v_mov_b32 v66, v64
    v_mfma_f32_16x16x32_bf16 v[60:63], v[12:15], v[124:127], v[60:63]
    ds_read_b128 v[8:11], v3 offset:28672
    buffer_load_dwordx4 v[164:167], v2, s[28:31], s45 offen offset:256 sc1
    v_mfma_f32_16x16x32_bf16 v[32:35], v[16:19], v[128:131], v[32:35]
    v_mov_b32 v67, v65
    v_permlane16_swap_b32 v64, v66
    v_mfma_f32_16x16x32_bf16 v[36:39], v[16:19], v[132:135], v[36:39]
    ds_read_b128 v[12:15], v3 offset:48128
    v_permlane16_swap_b32 v65, v67
    v_mfma_f32_16x16x32_bf16 v[40:43], v[20:23], v[128:131], v[40:43]
    v_add_f32 v64, v64, v66
    v_add_f32 v65, v65, v67
    v_mfma_f32_16x16x32_bf16 v[44:47], v[20:23], v[132:135], v[44:47]
    ds_read_b128 v[16:19], v3 offset:49152
    buffer_load_dwordx4 v[168:171], v2, s[28:31], s45 offen offset:2048 sc1
    s_waitcnt lgkmcnt(3)
    v_mfma_f32_16x16x32_bf16 v[48:51], v[24:27], v[128:131], v[48:51]
    v_mov_b32 v66, v64
    v_mov_b32 v67, v65
    v_mfma_f32_16x16x32_bf16 v[52:55], v[24:27], v[132:135], v[52:55]
    ds_read_b128 v[20:23], v3 offset:29696
    v_permlane32_swap_b32 v64, v66
    v_mfma_f32_16x16x32_bf16 v[56:59], v[28:31], v[128:131], v[56:59]
    v_permlane32_swap_b32 v65, v67
    v_add_f32 v64, v64, v66
    v_mfma_f32_16x16x32_bf16 v[60:63], v[28:31], v[132:135], v[60:63]
    ds_read_b128 v[24:27], v3 offset:30720
    buffer_load_dwordx4 v[172:175], v2, s[28:31], s45 offen offset:2304 sc1
    s_waitcnt vmcnt(8)
    v_mfma_f32_16x16x32_bf16 v[32:35], v[92:95], v[136:139], v[32:35]
    v_add_f32 v65, v65, v67
    v_mul_f32 v64, 0xbacccccd, v64
    v_mfma_f32_16x16x32_bf16 v[36:39], v[92:95], v[140:143], v[36:39]
    ds_read_b128 v[28:31], v3 offset:50176
    s_waitcnt lgkmcnt(3)
    v_mfma_f32_16x16x32_bf16 v[40:43], v[8:11], v[136:139], v[40:43]
    v_mul_f32 v5, 0x3acccccd, v65
    v_fma_f32 v5, -v64, v64, v5
    v_mfma_f32_16x16x32_bf16 v[44:47], v[8:11], v[140:143], v[44:47]
    ds_read_b128 v[92:95], v3 offset:51200
    s_add_u32 s45, s45, 4096
    buffer_load_dwordx4 v[176:179], v2, s[28:31], s45 offen offset:0 sc1
    v_mfma_f32_16x16x32_bf16 v[48:51], v[12:15], v[136:139], v[48:51]
    v_max_f32 v5, 0, v5
    v_add_f32 v5, 0x3727c5ac, v5
    v_mfma_f32_16x16x32_bf16 v[52:55], v[12:15], v[140:143], v[52:55]
    ds_read_b128 v[8:11], v3 offset:31744
    v_mfma_f32_16x16x32_bf16 v[56:59], v[16:19], v[136:139], v[56:59]
    v_rsq_f32 v4, v5
    v_mfma_f32_16x16x32_bf16 v[60:63], v[16:19], v[140:143], v[60:63]
    ds_read_b128 v[12:15], v3 offset:32768
    buffer_load_dwordx4 v[180:183], v2, s[28:31], s45 offen offset:256 sc1
    s_waitcnt vmcnt(8)
    s_waitcnt lgkmcnt(3)
    v_mfma_f32_16x16x32_bf16 v[32:35], v[20:23], v[144:147], v[32:35]
    v_mul_f32 v65, v5, v4
    v_mul_f32 v4, s48, v4
    v_mfma_f32_16x16x32_bf16 v[36:39], v[20:23], v[148:151], v[36:39]
    ds_read_b128 v[16:19], v3 offset:52224
    v_cndmask_b32 v64, v64, v65, s[50:51]
    v_mfma_f32_16x16x32_bf16 v[40:43], v[24:27], v[144:147], v[40:43]
    v_cndmask_b32 v64, v64, 0, s[54:55]
    v_and_b32 v65, 0xffff0000, v64
    v_mfma_f32_16x16x32_bf16 v[44:47], v[24:27], v[148:151], v[44:47]
    ds_read_b128 v[20:23], v3 offset:53248
    buffer_load_dwordx4 v[184:187], v2, s[28:31], s45 offen offset:2048 sc1
    v_mfma_f32_16x16x32_bf16 v[48:51], v[28:31], v[144:147], v[48:51]
    v_sub_f32 v64, v64, v65
    v_cvt_pk_bf16_f32 v82, v65, v64
    v_mfma_f32_16x16x32_bf16 v[52:55], v[28:31], v[148:151], v[52:55]
    ds_read_b128 v[24:27], v3 offset:33792
    s_waitcnt lgkmcnt(3)
    v_mfma_f32_16x16x32_bf16 v[56:59], v[92:95], v[144:147], v[56:59]
    v_mov_b32 v83, v82
    v_add_f32 v68, v68, v70
    v_mfma_f32_16x16x32_bf16 v[60:63], v[92:95], v[148:151], v[60:63]
    ds_read_b128 v[28:31], v3 offset:34816
    buffer_load_dwordx4 v[188:191], v2, s[28:31], s45 offen offset:2304 sc1
    s_waitcnt vmcnt(8)
    v_mfma_f32_16x16x32_bf16 v[32:35], v[8:11], v[152:155], v[32:35]
    v_add_f32 v69, v69, v71
    v_mov_b32 v70, v68
    v_mfma_f32_16x16x32_bf16 v[36:39], v[8:11], v[156:159], v[36:39]
    ds_read_b128 v[92:95], v3 offset:54272
    v_mov_b32 v71, v69
    v_mfma_f32_16x16x32_bf16 v[40:43], v[12:15], v[152:155], v[40:43]
    v_permlane16_swap_b32 v68, v70
    v_permlane16_swap_b32 v69, v71
    v_mfma_f32_16x16x32_bf16 v[44:47], v[12:15], v[156:159], v[44:47]
    ds_read_b128 v[8:11], v3 offset:55296
    s_add_u32 s45, s45, 4096
    buffer_load_dwordx4 v[192:195], v2, s[28:31], s45 offen offset:0 sc1
    s_waitcnt lgkmcnt(3)
    v_mfma_f32_16x16x32_bf16 v[48:51], v[16:19], v[152:155], v[48:51]
    v_add_f32 v68, v68, v70
    v_add_f32 v69, v69, v71
    v_mfma_f32_16x16x32_bf16 v[52:55], v[16:19], v[156:159], v[52:55]
    ds_read_b128 v[12:15], v3 offset:35840
    v_mov_b32 v70, v68
    v_mfma_f32_16x16x32_bf16 v[56:59], v[20:23], v[152:155], v[56:59]
    v_mov_b32 v71, v69
    v_permlane32_swap_b32 v68, v70
    v_mfma_f32_16x16x32_bf16 v[60:63], v[20:23], v[156:159], v[60:63]
    ds_read_b128 v[16:19], v3 offset:36864
    buffer_load_dwordx4 v[196:199], v2, s[28:31], s45 offen offset:256 sc1
    s_waitcnt vmcnt(8)
    v_mfma_f32_16x16x32_bf16 v[32:35], v[24:27], v[160:163], v[32:35]
    v_permlane32_swap_b32 v69, v71
    v_add_f32 v68, v68, v70
    v_mfma_f32_16x16x32_bf16 v[36:39], v[24:27], v[164:167], v[36:39]
    ds_read_b128 v[20:23], v3 offset:56320
    s_waitcnt lgkmcnt(3)
    v_mfma_f32_16x16x32_bf16 v[40:43], v[28:31], v[160:163], v[40:43]
    v_add_f32 v69, v69, v71
    v_mul_f32 v68, 0xbacccccd, v68
    v_mfma_f32_16x16x32_bf16 v[44:47], v[28:31], v[164:167], v[44:47]
    ds_read_b128 v[24:27], v3 offset:57344
    buffer_load_dwordx4 v[200:203], v2, s[28:31], s45 offen offset:2048 sc1
    v_mfma_f32_16x16x32_bf16 v[48:51], v[92:95], v[160:163], v[48:51]
    v_mul_f32 v81, 0x3acccccd, v69
    v_fma_f32 v81, -v68, v68, v81
    v_mfma_f32_16x16x32_bf16 v[52:55], v[92:95], v[164:167], v[52:55]
    s_barrier
    ds_read_b128 v[28:31], v7 offset:13312
    v_max_f32 v81, 0, v81
    v_mfma_f32_16x16x32_bf16 v[56:59], v[8:11], v[160:163], v[56:59]
    v_add_f32 v81, 0x3727c5ac, v81
    v_mfma_f32_16x16x32_bf16 v[60:63], v[8:11], v[164:167], v[60:63]
    ds_read_b128 v[92:95], v7 offset:14336
    buffer_load_dwordx4 v[204:207], v2, s[28:31], s45 offen offset:2304 sc1
    s_waitcnt vmcnt(8)
    s_waitcnt lgkmcnt(3)
    v_mfma_f32_16x16x32_bf16 v[32:35], v[12:15], v[168:171], v[32:35]
    v_rsq_f32 v80, v81
    v_mfma_f32_16x16x32_bf16 v[36:39], v[12:15], v[172:175], v[36:39]
    ds_read_b128 v[8:11], v7 offset:33792
    v_mul_f32 v69, v81, v80
    v_mfma_f32_16x16x32_bf16 v[40:43], v[16:19], v[168:171], v[40:43]
    v_mul_f32 v80, s48, v80
    v_cndmask_b32 v68, v68, v69, s[50:51]
    v_mfma_f32_16x16x32_bf16 v[44:47], v[16:19], v[172:175], v[44:47]
    ds_read_b128 v[12:15], v7 offset:34816
    s_add_u32 s45, s45, 4096
    buffer_load_dwordx4 v[208:211], v2, s[28:31], s45 offen offset:0 sc1
    v_mfma_f32_16x16x32_bf16 v[48:51], v[20:23], v[168:171], v[48:51]
    v_cndmask_b32 v68, v68, 0, s[54:55]
    v_and_b32 v69, 0xffff0000, v68
    v_mfma_f32_16x16x32_bf16 v[52:55], v[20:23], v[172:175], v[52:55]
    ds_read_b128 v[16:19], v7 offset:15360
    s_waitcnt lgkmcnt(3)
    v_mfma_f32_16x16x32_bf16 v[56:59], v[24:27], v[168:171], v[56:59]
    v_sub_f32 v68, v68, v69
    v_cvt_pk_bf16_f32 v86, v69, v68
    v_mfma_f32_16x16x32_bf16 v[60:63], v[24:27], v[172:175], v[60:63]
    ds_read_b128 v[20:23], v7 offset:16384
    buffer_load_dwordx4 v[212:215], v2, s[28:31], s45 offen offset:256 sc1
    s_waitcnt vmcnt(8)
    v_mfma_f32_16x16x32_bf16 v[32:35], v[28:31], v[176:179], v[32:35]
    v_mov_b32 v87, v86
    ds_read2st64_b64 v[88:91], v6 offset0:0 offset1:0
    v_mfma_f32_16x16x32_bf16 v[36:39], v[28:31], v[180:183], v[36:39]
    ds_read_b128 v[24:27], v7 offset:35840
    v_mfma_f32_16x16x32_bf16 v[40:43], v[92:95], v[176:179], v[40:43]
    v_mfma_f32_16x16x32_bf16 v[44:47], v[92:95], v[180:183], v[44:47]
    ds_read_b128 v[28:31], v7 offset:36864
    buffer_load_dwordx4 v[216:219], v2, s[28:31], s45 offen offset:2048 sc1
    s_waitcnt lgkmcnt(4)
    v_mfma_f32_16x16x32_bf16 v[48:51], v[8:11], v[176:179], v[48:51]
    v_mfma_f32_16x16x32_bf16 v[52:55], v[8:11], v[180:183], v[52:55]
    ds_read_b128 v[92:95], v7 offset:17408
    v_mfma_f32_16x16x32_bf16 v[56:59], v[12:15], v[176:179], v[56:59]
    v_mfma_f32_16x16x32_bf16 v[60:63], v[12:15], v[180:183], v[60:63]
    ds_read_b128 v[8:11], v7 offset:18432
    buffer_load_dwordx4 v[220:223], v2, s[28:31], s45 offen offset:2304 sc1
    s_waitcnt vmcnt(8)
    v_mfma_f32_16x16x32_bf16 v[32:35], v[16:19], v[184:187], v[32:35]
    v_mfma_f32_16x16x32_bf16 v[36:39], v[16:19], v[188:191], v[36:39]
    ds_read_b128 v[12:15], v7 offset:37888
    s_waitcnt lgkmcnt(3)
    v_mfma_f32_16x16x32_bf16 v[40:43], v[20:23], v[184:187], v[40:43]
    v_mfma_f32_16x16x32_bf16 v[32:35], v[88:91], v[82:85], v[32:35]
    v_mfma_f32_16x16x32_bf16 v[44:47], v[20:23], v[188:191], v[44:47]
    ds_read_b128 v[16:19], v7 offset:38912
    s_add_u32 s45, s45, 4096
    buffer_load_dwordx4 v[224:227], v2, s[28:31], s45 offen offset:0 sc1
    v_mfma_f32_16x16x32_bf16 v[48:51], v[24:27], v[184:187], v[48:51]
    v_mfma_f32_16x16x32_bf16 v[36:39], v[88:91], v[84:87], v[36:39]
    v_mfma_f32_16x16x32_bf16 v[52:55], v[24:27], v[188:191], v[52:55]
    ds_read_b128 v[20:23], v7 offset:19456
    ds_read2st64_b64 v[88:91], v6 offset0:1 offset1:1
    v_mfma_f32_16x16x32_bf16 v[56:59], v[28:31], v[184:187], v[56:59]
    v_mfma_f32_16x16x32_bf16 v[60:63], v[28:31], v[188:191], v[60:63]
    ds_read_b128 v[24:27], v7 offset:20480
    buffer_load_dwordx4 v[228:231], v2, s[28:31], s45 offen offset:256 sc1
    s_waitcnt vmcnt(8)
    s_waitcnt lgkmcnt(4)
    v_mfma_f32_16x16x32_bf16 v[32:35], v[92:95], v[192:195], v[32:35]
    v_mfma_f32_16x16x32_bf16 v[36:39], v[92:95], v[196:199], v[36:39]
    ds_read_b128 v[28:31], v7 offset:39936
    v_mfma_f32_16x16x32_bf16 v[40:43], v[8:11], v[192:195], v[40:43]
    v_mfma_f32_16x16x32_bf16 v[44:47], v[8:11], v[196:199], v[44:47]
    ds_read_b128 v[92:95], v7 offset:40960
    buffer_load_dwordx4 v[232:235], v2, s[28:31], s45 offen offset:2048 sc1
    v_mfma_f32_16x16x32_bf16 v[48:51], v[12:15], v[192:195], v[48:51]
    v_mfma_f32_16x16x32_bf16 v[52:55], v[12:15], v[196:199], v[52:55]
    ds_read_b128 v[8:11], v7 offset:21504
    s_waitcnt lgkmcnt(3)
    v_mfma_f32_16x16x32_bf16 v[56:59], v[16:19], v[192:195], v[56:59]
    v_mfma_f32_16x16x32_bf16 v[60:63], v[16:19], v[196:199], v[60:63]
    ds_read_b128 v[12:15], v7 offset:22528
    buffer_load_dwordx4 v[236:239], v2, s[28:31], s45 offen offset:2304 sc1
    s_waitcnt vmcnt(8)
    v_mfma_f32_16x16x32_bf16 v[32:35], v[20:23], v[200:203], v[32:35]
    v_mfma_f32_16x16x32_bf16 v[40:43], v[88:91], v[82:85], v[40:43]
    v_mfma_f32_16x16x32_bf16 v[36:39], v[20:23], v[204:207], v[36:39]
    ds_read_b128 v[16:19], v7 offset:41984
    v_mfma_f32_16x16x32_bf16 v[40:43], v[24:27], v[200:203], v[40:43]
    v_mfma_f32_16x16x32_bf16 v[44:47], v[88:91], v[84:87], v[44:47]
    v_mfma_f32_16x16x32_bf16 v[44:47], v[24:27], v[204:207], v[44:47]
    ds_read_b128 v[20:23], v7 offset:43008
    s_add_u32 s45, s45, 4096
    buffer_load_dwordx4 v[240:243], v2, s[28:31], s45 offen offset:0 sc1
    s_waitcnt lgkmcnt(3)
    v_mfma_f32_16x16x32_bf16 v[48:51], v[28:31], v[200:203], v[48:51]
    ds_read2st64_b64 v[88:91], v6 offset0:2 offset1:2
    v_mfma_f32_16x16x32_bf16 v[52:55], v[28:31], v[204:207], v[52:55]
    ds_read_b128 v[24:27], v7 offset:23552
    v_mfma_f32_16x16x32_bf16 v[56:59], v[92:95], v[200:203], v[56:59]
    v_mfma_f32_16x16x32_bf16 v[60:63], v[92:95], v[204:207], v[60:63]
    ds_read_b128 v[28:31], v7 offset:24576
    buffer_load_dwordx4 v[244:247], v2, s[28:31], s45 offen offset:256 sc1
    s_waitcnt vmcnt(8)
    v_mfma_f32_16x16x32_bf16 v[32:35], v[8:11], v[208:211], v[32:35]
    v_mfma_f32_16x16x32_bf16 v[36:39], v[8:11], v[212:215], v[36:39]
    ds_read_b128 v[92:95], v7 offset:44032
    s_waitcnt lgkmcnt(4)
    v_mfma_f32_16x16x32_bf16 v[40:43], v[12:15], v[208:211], v[40:43]
    v_mfma_f32_16x16x32_bf16 v[44:47], v[12:15], v[212:215], v[44:47]
    ds_read_b128 v[8:11], v7 offset:45056
    buffer_load_dwordx4 v[248:251], v2, s[28:31], s45 offen offset:2048 sc1
    v_mfma_f32_16x16x32_bf16 v[48:51], v[16:19], v[208:211], v[48:51]
    v_mfma_f32_16x16x32_bf16 v[52:55], v[16:19], v[212:215], v[52:55]
    ds_read_b128 v[12:15], v7 offset:25600
    v_mfma_f32_16x16x32_bf16 v[56:59], v[20:23], v[208:211], v[56:59]
    s_waitcnt lgkmcnt(5)
    v_mfma_f32_16x16x32_bf16 v[48:51], v[88:91], v[82:85], v[48:51]
    v_mfma_f32_16x16x32_bf16 v[60:63], v[20:23], v[212:215], v[60:63]
    ds_read_b128 v[16:19], v7 offset:26624
    buffer_load_dwordx4 v[252:255], v2, s[28:31], s45 offen offset:2304 sc1
    s_waitcnt vmcnt(8)
    s_waitcnt lgkmcnt(3)
    v_mfma_f32_16x16x32_bf16 v[32:35], v[24:27], v[216:219], v[32:35]
    v_mfma_f32_16x16x32_bf16 v[52:55], v[88:91], v[84:87], v[52:55]
    v_mfma_f32_16x16x32_bf16 v[36:39], v[24:27], v[220:223], v[36:39]
    ds_read_b128 v[20:23], v7 offset:46080
    ds_read2st64_b64 v[88:91], v6 offset0:3 offset1:3
    v_mfma_f32_16x16x32_bf16 v[40:43], v[28:31], v[216:219], v[40:43]
    v_mfma_f32_16x16x32_bf16 v[44:47], v[28:31], v[220:223], v[44:47]
    ds_read_b128 v[24:27], v7 offset:47104
    v_mfma_f32_16x16x32_bf16 v[48:51], v[92:95], v[216:219], v[48:51]
    v_mfma_f32_16x16x32_bf16 v[52:55], v[92:95], v[220:223], v[52:55]
    ds_read_b128 v[28:31], v7 offset:27648
    s_waitcnt lgkmcnt(4)
    v_mfma_f32_16x16x32_bf16 v[56:59], v[8:11], v[216:219], v[56:59]
    v_mfma_f32_16x16x32_bf16 v[60:63], v[8:11], v[220:223], v[60:63]
    ds_read_b128 v[92:95], v7 offset:28672
    s_waitcnt vmcnt(6)
    v_mfma_f32_16x16x32_bf16 v[32:35], v[12:15], v[224:227], v[32:35]
    v_mfma_f32_16x16x32_bf16 v[36:39], v[12:15], v[228:231], v[36:39]
    ds_read_b128 v[8:11], v7 offset:48128
    v_mfma_f32_16x16x32_bf16 v[40:43], v[16:19], v[224:227], v[40:43]
    s_waitcnt lgkmcnt(4)
    v_mfma_f32_16x16x32_bf16 v[56:59], v[88:91], v[82:85], v[56:59]
    v_mfma_f32_16x16x32_bf16 v[44:47], v[16:19], v[228:231], v[44:47]
    ds_read_b128 v[12:15], v7 offset:49152
    s_waitcnt lgkmcnt(3)
    v_mfma_f32_16x16x32_bf16 v[48:51], v[20:23], v[224:227], v[48:51]
    v_mfma_f32_16x16x32_bf16 v[60:63], v[88:91], v[84:87], v[60:63]
    v_mfma_f32_16x16x32_bf16 v[52:55], v[20:23], v[228:231], v[52:55]
    ds_read_b128 v[16:19], v7 offset:29696
    v_mfma_f32_16x16x32_bf16 v[56:59], v[24:27], v[224:227], v[56:59]
    v_mfma_f32_16x16x32_bf16 v[60:63], v[24:27], v[228:231], v[60:63]
    ds_read_b128 v[20:23], v7 offset:30720
    s_waitcnt vmcnt(4)
    v_mfma_f32_16x16x32_bf16 v[32:35], v[28:31], v[232:235], v[32:35]
    v_mfma_f32_16x16x32_bf16 v[36:39], v[28:31], v[236:239], v[36:39]
    ds_read_b128 v[24:27], v7 offset:50176
    s_waitcnt lgkmcnt(3)
    v_mfma_f32_16x16x32_bf16 v[40:43], v[92:95], v[232:235], v[40:43]
    v_mfma_f32_16x16x32_bf16 v[44:47], v[92:95], v[236:239], v[44:47]
    ds_read_b128 v[28:31], v7 offset:51200
    v_mfma_f32_16x16x32_bf16 v[48:51], v[8:11], v[232:235], v[48:51]
    v_mfma_f32_16x16x32_bf16 v[52:55], v[8:11], v[236:239], v[52:55]
    ds_read_b128 v[92:95], v7 offset:31744
    v_mfma_f32_16x16x32_bf16 v[56:59], v[12:15], v[232:235], v[56:59]
    v_mfma_f32_16x16x32_bf16 v[60:63], v[12:15], v[236:239], v[60:63]
    ds_read_b128 v[8:11], v7 offset:32768
    s_waitcnt vmcnt(2)
    s_waitcnt lgkmcnt(3)
    v_mfma_f32_16x16x32_bf16 v[32:35], v[16:19], v[240:243], v[32:35]
    v_mfma_f32_16x16x32_bf16 v[36:39], v[16:19], v[244:247], v[36:39]
    ds_read_b128 v[12:15], v7 offset:52224
    v_mfma_f32_16x16x32_bf16 v[40:43], v[20:23], v[240:243], v[40:43]
    v_mfma_f32_16x16x32_bf16 v[44:47], v[20:23], v[244:247], v[44:47]
    ds_read_b128 v[16:19], v7 offset:53248
    v_mfma_f32_16x16x32_bf16 v[48:51], v[24:27], v[240:243], v[48:51]
    v_mfma_f32_16x16x32_bf16 v[52:55], v[24:27], v[244:247], v[52:55]
    s_barrier
    ds_read_b128 v[20:23], v7 offset:54272
    s_waitcnt lgkmcnt(3)
    v_mfma_f32_16x16x32_bf16 v[56:59], v[28:31], v[240:243], v[56:59]
    v_mfma_f32_16x16x32_bf16 v[60:63], v[28:31], v[244:247], v[60:63]
    ds_read_b128 v[24:27], v7 offset:55296
    s_waitcnt vmcnt(0)
    s_nop 0
hop_pad_12:
    s_cbranch_execz hop_pad_16
    v_mfma_f32_16x16x32_bf16 v[32:35], v[92:95], v[248:251], v[32:35]
    v_mfma_f32_16x16x32_bf16 v[36:39], v[92:95], v[252:255], v[36:39]
    ds_read_b128 v[28:31], v7 offset:56320
    v_mfma_f32_16x16x32_bf16 v[40:43], v[8:11], v[248:251], v[40:43]
    v_mfma_f32_16x16x32_bf16 v[44:47], v[8:11], v[252:255], v[44:47]
    ds_read_b128 v[92:95], v7 offset:57344
    s_waitcnt lgkmcnt(3)
    v_mfma_f32_16x16x32_bf16 v[48:51], v[12:15], v[248:251], v[48:51]
    v_mfma_f32_16x16x32_bf16 v[52:55], v[12:15], v[252:255], v[52:55]
    ds_read_b128 v[8:11], v7 offset:58368
    v_mfma_f32_16x16x32_bf16 v[56:59], v[16:19], v[248:251], v[56:59]
    v_mfma_f32_16x16x32_bf16 v[60:63], v[16:19], v[252:255], v[60:63]
    ds_read_b128 v[12:15], v7 offset:59392
    v_mfma_f32_16x16x32_bf16 v[64:67], v[20:23], v[96:99], 0
    v_mfma_f32_16x16x32_bf16 v[68:71], v[20:23], v[100:103], 0
    ds_read_b128 v[16:19], v7 offset:60416
    s_waitcnt lgkmcnt(3)
    v_mfma_f32_16x16x32_bf16 v[72:75], v[24:27], v[96:99], 0
    v_mul_f32 v40, v32, v40
    v_mul_f32 v41, v33, v41
    v_mfma_f32_16x16x32_bf16 v[76:79], v[24:27], v[100:103], 0
    ds_read_b128 v[20:23], v7 offset:61440
    v_mul_f32 v42, v34, v42
    v_mfma_f32_16x16x32_bf16 v[64:67], v[28:31], v[104:107], v[64:67]
    v_mul_f32 v43, v35, v43
    v_mul_f32 v32, v4, v32
    v_mfma_f32_16x16x32_bf16 v[68:71], v[28:31], v[108:111], v[68:71]
    ds_read_b128 v[24:27], v7 offset:62464
    v_mul_f32 v33, v4, v33
    v_mfma_f32_16x16x32_bf16 v[72:75], v[92:95], v[104:107], v[72:75]
    v_exp_f32 v32, v32
    v_mfma_f32_16x16x32_bf16 v[76:79], v[92:95], v[108:111], v[76:79]
    ds_read_b128 v[28:31], v7 offset:63488
    s_waitcnt lgkmcnt(3)
    v_mfma_f32_16x16x32_bf16 v[64:67], v[8:11], v[112:115], v[64:67]
    ds_read2st64_b64 v[88:91], v6 offset0:4 offset1:4
    v_mul_f32 v34, v4, v34
    v_mfma_f32_16x16x32_bf16 v[68:71], v[8:11], v[116:119], v[68:71]
    ds_read_b128 v[92:95], v7 offset:64512
    v_mul_f32 v35, v4, v35
    v_mfma_f32_16x16x32_bf16 v[72:75], v[12:15], v[112:115], v[72:75]
    v_exp_f32 v33, v33
    v_mfma_f32_16x16x32_bf16 v[76:79], v[12:15], v[116:119], v[76:79]
    ds_read_b128 v[8:11], v1 offset:0
    v_fma_f32 v32, v32, v5, v5
    v_mfma_f32_16x16x32_bf16 v[64:67], v[16:19], v[120:123], v[64:67]
    v_exp_f32 v34, v34
    v_mfma_f32_16x16x32_bf16 v[68:71], v[16:19], v[124:127], v[68:71]
    ds_read_b128 v[12:15], v1 offset:1024
    s_waitcnt lgkmcnt(4)
    v_mfma_f32_16x16x32_bf16 v[72:75], v[20:23], v[120:123], v[72:75]
    v_exp_f32 v35, v35
    v_mfma_f32_16x16x32_bf16 v[76:79], v[20:23], v[124:127], v[76:79]
    ds_read_b128 v[16:19], v1 offset:2048
    v_fma_f32 v33, v33, v5, v5
    v_mfma_f32_16x16x32_bf16 v[64:67], v[24:27], v[128:131], v[64:67]
    v_rcp_f32 v32, v32
    v_mfma_f32_16x16x32_bf16 v[68:71], v[24:27], v[132:135], v[68:71]
    ds_read_b128 v[20:23], v1 offset:3072
    v_fma_f32 v34, v34, v5, v5
    v_mfma_f32_16x16x32_bf16 v[72:75], v[28:31], v[128:131], v[72:75]
    v_rcp_f32 v33, v33
    v_mfma_f32_16x16x32_bf16 v[76:79], v[28:31], v[132:135], v[76:79]
    ds_read_b128 v[24:27], v1 offset:4096
    s_waitcnt lgkmcnt(3)
    v_mfma_f32_16x16x32_bf16 v[64:67], v[92:95], v[136:139], v[64:67]
    v_rcp_f32 v34, v34
    v_mfma_f32_16x16x32_bf16 v[68:71], v[92:95], v[140:143], v[68:71]
    ds_read_b128 v[28:31], v1 offset:5120
    v_fma_f32 v35, v35, v5, v5
    v_mfma_f32_16x16x32_bf16 v[72:75], v[8:11], v[136:139], v[72:75]
    v_rcp_f32 v35, v35
    v_mfma_f32_16x16x32_bf16 v[76:79], v[8:11], v[140:143], v[76:79]
    ds_read_b128 v[92:95], v1 offset:6144
    v_mul_f32 v40, v40, v32
    v_mfma_f32_16x16x32_bf16 v[64:67], v[12:15], v[144:147], v[64:67]
    v_mul_f32 v41, v41, v33
    v_mul_f32 v42, v42, v34
    v_mfma_f32_16x16x32_bf16 v[68:71], v[12:15], v[148:151], v[68:71]
    ds_read_b128 v[8:11], v1 offset:7168
    s_waitcnt lgkmcnt(3)
    v_mfma_f32_16x16x32_bf16 v[72:75], v[16:19], v[144:147], v[72:75]
    v_mul_f32 v43, v43, v35
    v_cvt_pk_bf16_f32 v32, v40, v41
    v_mfma_f32_16x16x32_bf16 v[76:79], v[16:19], v[148:151], v[76:79]
    ds_read_b128 v[12:15], v1 offset:8192
    v_mul_f32 v44, v36, v44
    v_mfma_f32_16x16x32_bf16 v[64:67], v[20:23], v[152:155], v[64:67]
    v_mfma_f32_16x16x32_bf16 v[64:67], v[88:91], v[82:85], v[64:67]
    v_mfma_f32_16x16x32_bf16 v[68:71], v[20:23], v[156:159], v[68:71]
    s_barrier
    ds_read_b128 v[16:19], v1 offset:9216
    v_cvt_pk_bf16_f32 v33, v42, v43
    v_mfma_f32_16x16x32_bf16 v[72:75], v[24:27], v[152:155], v[72:75]
    v_mfma_f32_16x16x32_bf16 v[68:71], v[88:91], v[84:87], v[68:71]
    v_mfma_f32_16x16x32_bf16 v[76:79], v[24:27], v[156:159], v[76:79]
    ds_read_b128 v[20:23], v1 offset:10240
    s_waitcnt lgkmcnt(3)
    v_mfma_f32_16x16x32_bf16 v[64:67], v[28:31], v[160:163], v[64:67]
    ds_read2st64_b64 v[88:91], v6 offset0:5 offset1:5
    v_mul_f32 v45, v37, v45
    v_mfma_f32_16x16x32_bf16 v[68:71], v[28:31], v[164:167], v[68:71]
    ds_read_b128 v[24:27], v1 offset:11264
    v_mul_f32 v46, v38, v46
    v_mfma_f32_16x16x32_bf16 v[72:75], v[92:95], v[160:163], v[72:75]
    v_mul_f32 v47, v39, v47
    v_mul_f32 v36, v80, v36
    v_mfma_f32_16x16x32_bf16 v[76:79], v[92:95], v[164:167], v[76:79]
    ds_read_b128 v[28:31], v1 offset:12288
    v_mul_f32 v37, v80, v37
    v_mfma_f32_16x16x32_bf16 v[64:67], v[8:11], v[168:171], v[64:67]
    v_exp_f32 v36, v36
    v_mfma_f32_16x16x32_bf16 v[68:71], v[8:11], v[172:175], v[68:71]
    ds_read_b128 v[92:95], v1 offset:13312
    s_waitcnt lgkmcnt(4)
    v_mfma_f32_16x16x32_bf16 v[72:75], v[12:15], v[168:171], v[72:75]
    v_exp_f32 v37, v37
    v_mfma_f32_16x16x32_bf16 v[76:79], v[12:15], v[172:175], v[76:79]
    ds_read_b128 v[8:11], v1 offset:14336
    v_mul_f32 v38, v80, v38
    v_mfma_f32_16x16x32_bf16 v[64:67], v[16:19], v[176:179], v[64:67]
    v_exp_f32 v38, v38
    v_mfma_f32_16x16x32_bf16 v[68:71], v[16:19], v[180:183], v[68:71]
    ds_read_b128 v[12:15], v1 offset:15360
    v_mul_f32 v39, v80, v39
    v_mfma_f32_16x16x32_bf16 v[72:75], v[20:23], v[176:179], v[72:75]
    v_exp_f32 v39, v39
    v_mfma_f32_16x16x32_bf16 v[76:79], v[20:23], v[180:183], v[76:79]
    ds_read_b128 v[16:19], v1 offset:16384
    s_waitcnt lgkmcnt(3)
    v_mfma_f32_16x16x32_bf16 v[64:67], v[24:27], v[184:187], v[64:67]
    v_fma_f32 v36, v36, v81, v81
    v_fma_f32 v37, v37, v81, v81
    v_mfma_f32_16x16x32_bf16 v[68:71], v[24:27], v[188:191], v[68:71]
    ds_read_b128 v[20:23], v1 offset:17408
    v_fma_f32 v38, v38, v81, v81
    v_mfma_f32_16x16x32_bf16 v[72:75], v[28:31], v[184:187], v[72:75]
    v_rcp_f32 v36, v36
    v_mfma_f32_16x16x32_bf16 v[76:79], v[28:31], v[188:191], v[76:79]
    ds_read_b128 v[24:27], v1 offset:18432
    v_fma_f32 v39, v39, v81, v81
    v_mfma_f32_16x16x32_bf16 v[64:67], v[92:95], v[192:195], v[64:67]
    v_rcp_f32 v37, v37
    v_mfma_f32_16x16x32_bf16 v[68:71], v[92:95], v[196:199], v[68:71]
    ds_read_b128 v[28:31], v1 offset:19456
    s_waitcnt lgkmcnt(3)
    v_mfma_f32_16x16x32_bf16 v[72:75], v[8:11], v[192:195], v[72:75]
    v_rcp_f32 v38, v38
    v_mfma_f32_16x16x32_bf16 v[76:79], v[8:11], v[196:199], v[76:79]
    ds_read_b128 v[92:95], v1 offset:20480
    v_mul_f32 v44, v44, v36
    v_mfma_f32_16x16x32_bf16 v[64:67], v[12:15], v[200:203], v[64:67]
    v_mfma_f32_16x16x32_bf16 v[72:75], v[88:91], v[82:85], v[72:75]
    v_mfma_f32_16x16x32_bf16 v[68:71], v[12:15], v[204:207], v[68:71]
    ds_read_b128 v[8:11], v1 offset:21504
    v_mul_f32 v45, v45, v37
    v_mfma_f32_16x16x32_bf16 v[72:75], v[16:19], v[200:203], v[72:75]
    v_mfma_f32_16x16x32_bf16 v[76:79], v[88:91], v[84:87], v[76:79]
    v_mfma_f32_16x16x32_bf16 v[76:79], v[16:19], v[204:207], v[76:79]
    ds_read_b128 v[12:15], v1 offset:22528
    s_waitcnt lgkmcnt(3)
    v_mfma_f32_16x16x32_bf16 v[64:67], v[20:23], v[208:211], v[64:67]
    v_rcp_f32 v39, v39
    v_mfma_f32_16x16x32_bf16 v[68:71], v[20:23], v[212:215], v[68:71]
    ds_read_b128 v[16:19], v1 offset:23552
    v_mul_f32 v46, v46, v38
    v_mfma_f32_16x16x32_bf16 v[72:75], v[24:27], v[208:211], v[72:75]
    v_mul_f32 v47, v47, v39
    v_cvt_pk_bf16_f32 v34, v44, v45
    v_mfma_f32_16x16x32_bf16 v[76:79], v[24:27], v[212:215], v[76:79]
    ds_read_b128 v[20:23], v1 offset:24576
    v_mul_f32 v56, v48, v56
    v_mfma_f32_16x16x32_bf16 v[64:67], v[28:31], v[216:219], v[64:67]
    v_cvt_pk_bf16_f32 v35, v46, v47
    v_permlane16_swap_b32 v32, v34
    v_mfma_f32_16x16x32_bf16 v[68:71], v[28:31], v[220:223], v[68:71]
    ds_read_b128 v[24:27], v1 offset:25600
    s_waitcnt lgkmcnt(3)
    v_mfma_f32_16x16x32_bf16 v[72:75], v[92:95], v[216:219], v[72:75]
    v_permlane16_swap_b32 v33, v35
    v_mul_f32 v57, v49, v57
    v_mfma_f32_16x16x32_bf16 v[76:79], v[92:95], v[220:223], v[76:79]
    ds_read_b128 v[28:31], v1 offset:26624
    v_mul_f32 v58, v50, v58
    v_mfma_f32_16x16x32_bf16 v[64:67], v[8:11], v[224:227], v[64:67]
    buffer_store_dwordx4 v[32:35], v3, s[28:31], s46 offen sc1
    s_add_u32 s46, s46, 16384
    v_mul_f32 v59, v51, v59
    v_mfma_f32_16x16x32_bf16 v[68:71], v[8:11], v[228:231], v[68:71]
    ds_read_b128 v[92:95], v1 offset:27648
    v_mul_f32 v48, v4, v48
    v_mfma_f32_16x16x32_bf16 v[72:75], v[12:15], v[224:227], v[72:75]
    v_exp_f32 v48, v48
    v_mfma_f32_16x16x32_bf16 v[76:79], v[12:15], v[228:231], v[76:79]
    ds_read_b128 v[8:11], v1 offset:28672
    s_waitcnt lgkmcnt(3)
    v_mfma_f32_16x16x32_bf16 v[64:67], v[16:19], v[232:235], v[64:67]
    v_mul_f32 v49, v4, v49
    v_mul_f32 v50, v4, v50
    v_mfma_f32_16x16x32_bf16 v[68:71], v[16:19], v[236:239], v[68:71]
    s_barrier
    ds_read_b128 v[12:15], v3 offset:58368
    v_mul_f32 v51, v4, v51
    v_mfma_f32_16x16x32_bf16 v[72:75], v[20:23], v[232:235], v[72:75]
    v_exp_f32 v49, v49
    v_mfma_f32_16x16x32_bf16 v[76:79], v[20:23], v[236:239], v[76:79]
    ds_read_b128 v[16:19], v3 offset:59392
    v_fma_f32 v48, v48, v5, v5
    v_mfma_f32_16x16x32_bf16 v[64:67], v[24:27], v[240:243], v[64:67]
    v_exp_f32 v50, v50
    v_mfma_f32_16x16x32_bf16 v[68:71], v[24:27], v[244:247], v[68:71]
    ds_read_b128 v[20:23], v3 offset:60416
    s_waitcnt lgkmcnt(3)
    v_mfma_f32_16x16x32_bf16 v[72:75], v[28:31], v[240:243], v[72:75]
    v_exp_f32 v51, v51
    v_mfma_f32_16x16x32_bf16 v[76:79], v[28:31], v[244:247], v[76:79]
    ds_read_b128 v[24:27], v3 offset:61440
    v_fma_f32 v49, v49, v5, v5
    v_mfma_f32_16x16x32_bf16 v[64:67], v[92:95], v[248:251], v[64:67]
    v_rcp_f32 v48, v48
    v_mfma_f32_16x16x32_bf16 v[68:71], v[92:95], v[252:255], v[68:71]
    ds_read_b128 v[28:31], v3 offset:62464
    v_fma_f32 v50, v50, v5, v5
    v_mfma_f32_16x16x32_bf16 v[72:75], v[8:11], v[248:251], v[72:75]
    v_rcp_f32 v49, v49
    v_mfma_f32_16x16x32_bf16 v[76:79], v[8:11], v[252:255], v[76:79]
    ds_read_b128 v[92:95], v3 offset:63488
    s_waitcnt lgkmcnt(3)
    v_mfma_f32_16x16x32_bf16 v[32:35], v[12:15], v[96:99], 0
    v_rcp_f32 v50, v50
    v_mfma_f32_16x16x32_bf16 v[36:39], v[12:15], v[100:103], 0
    ds_read_b128 v[8:11], v3 offset:64512
    v_fma_f32 v51, v51, v5, v5
    v_mfma_f32_16x16x32_bf16 v[40:43], v[16:19], v[96:99], 0
    v_rcp_f32 v51, v51
    v_mfma_f32_16x16x32_bf16 v[44:47], v[16:19], v[100:103], 0
    ds_read_b128 v[12:15], v7 offset:0
    v_mul_f32 v56, v56, v48
    v_mfma_f32_16x16x32_bf16 v[32:35], v[20:23], v[104:107], v[32:35]
    v_mul_f32 v57, v57, v49
    v_mul_f32 v58, v58, v50
    v_mfma_f32_16x16x32_bf16 v[36:39], v[20:23], v[108:111], v[36:39]
    ds_read_b128 v[16:19], v7 offset:1024
    s_waitcnt lgkmcnt(3)
    v_mfma_f32_16x16x32_bf16 v[40:43], v[24:27], v[104:107], v[40:43]
    v_mul_f32 v59, v59, v51
    v_cvt_pk_bf16_f32 v48, v56, v57
    v_mfma_f32_16x16x32_bf16 v[44:47], v[24:27], v[108:111], v[44:47]
    ds_read_b128 v[20:23], v7 offset:2048
    v_mul_f32 v60, v52, v60
    v_mfma_f32_16x16x32_bf16 v[32:35], v[28:31], v[112:115], v[32:35]
    ds_read2st64_b64 v[88:91], v6 offset0:6 offset1:6
    v_cvt_pk_bf16_f32 v49, v58, v59
    v_mfma_f32_16x16x32_bf16 v[36:39], v[28:31], v[116:119], v[36:39]
    ds_read_b128 v[24:27], v7 offset:3072
    v_mul_f32 v61, v53, v61
    v_mfma_f32_16x16x32_bf16 v[40:43], v[92:95], v[112:115], v[40:43]
    v_mul_f32 v62, v54, v62
    v_mul_f32 v63, v55, v63
    v_mfma_f32_16x16x32_bf16 v[44:47], v[92:95], v[116:119], v[44:47]
    ds_read_b128 v[28:31], v7 offset:4096
    s_waitcnt lgkmcnt(4)
    v_mfma_f32_16x16x32_bf16 v[32:35], v[8:11], v[120:123], v[32:35]
    v_mul_f32 v52, v80, v52
    v_mul_f32 v53, v80, v53
    v_mfma_f32_16x16x32_bf16 v[36:39], v[8:11], v[124:127], v[36:39]
    ds_read_b128 v[92:95], v7 offset:5120
    v_mul_f32 v54, v80, v54
    v_mfma_f32_16x16x32_bf16 v[40:43], v[12:15], v[120:123], v[40:43]
    v_exp_f32 v52, v52
    v_mfma_f32_16x16x32_bf16 v[44:47], v[12:15], v[124:127], v[44:47]
    ds_read_b128 v[8:11], v7 offset:6144
    v_mul_f32 v55, v80, v55
    v_mfma_f32_16x16x32_bf16 v[32:35], v[16:19], v[128:131], v[32:35]
    v_exp_f32 v53, v53
    v_mfma_f32_16x16x32_bf16 v[36:39], v[16:19], v[132:135], v[36:39]
    ds_read_b128 v[12:15], v7 offset:7168
    s_waitcnt lgkmcnt(3)
    v_mfma_f32_16x16x32_bf16 v[40:43], v[20:23], v[128:131], v[40:43]
    v_exp_f32 v54, v54
    v_mfma_f32_16x16x32_bf16 v[44:47], v[20:23], v[132:135], v[44:47]
    ds_read_b128 v[16:19], v7 offset:8192
    v_fma_f32 v52, v52, v81, v81
    v_mfma_f32_16x16x32_bf16 v[32:35], v[24:27], v[136:139], v[32:35]
    v_exp_f32 v55, v55
    v_mfma_f32_16x16x32_bf16 v[36:39], v[24:27], v[140:143], v[36:39]
    ds_read_b128 v[20:23], v7 offset:9216
    v_fma_f32 v53, v53, v81, v81
    v_mfma_f32_16x16x32_bf16 v[40:43], v[28:31], v[136:139], v[40:43]
    v_rcp_f32 v52, v52
    v_mfma_f32_16x16x32_bf16 v[44:47], v[28:31], v[140:143], v[44:47]
    ds_read_b128 v[24:27], v7 offset:10240
    s_waitcnt lgkmcnt(3)
    v_mfma_f32_16x16x32_bf16 v[32:35], v[92:95], v[144:147], v[32:35]
    v_rcp_f32 v53, v53
    v_mfma_f32_16x16x32_bf16 v[36:39], v[92:95], v[148:151], v[36:39]
    ds_read_b128 v[28:31], v7 offset:11264
    v_fma_f32 v54, v54, v81, v81
    v_mfma_f32_16x16x32_bf16 v[40:43], v[8:11], v[144:147], v[40:43]
    v_rcp_f32 v54, v54
    v_mfma_f32_16x16x32_bf16 v[44:47], v[8:11], v[148:151], v[44:47]
    ds_read_b128 v[92:95], v7 offset:12288
    v_fma_f32 v55, v55, v81, v81
    v_mfma_f32_16x16x32_bf16 v[32:35], v[12:15], v[152:155], v[32:35]
    v_mfma_f32_16x16x32_bf16 v[32:35], v[88:91], v[82:85], v[32:35]
    v_mfma_f32_16x16x32_bf16 v[36:39], v[12:15], v[156:159], v[36:39]
    s_barrier
    ds_read_b128 v[8:11], v3 offset:17408
    s_waitcnt lgkmcnt(3)
    v_mfma_f32_16x16x32_bf16 v[40:43], v[16:19], v[152:155], v[40:43]
    v_mfma_f32_16x16x32_bf16 v[36:39], v[88:91], v[84:87], v[36:39]
    v_mfma_f32_16x16x32_bf16 v[44:47], v[16:19], v[156:159], v[44:47]
    ds_read_b128 v[12:15], v3 offset:18432
    v_mul_f32 v60, v60, v52
    v_mfma_f32_16x16x32_bf16 v[32:35], v[20:23], v[160:163], v[32:35]
    ds_read2st64_b64 v[88:91], v6 offset0:7 offset1:7
    v_mul_f32 v61, v61, v53
    v_mfma_f32_16x16x32_bf16 v[36:39], v[20:23], v[164:167], v[36:39]
    ds_read_b128 v[16:19], v3 offset:19456
    v_mul_f32 v62, v62, v54
    v_mfma_f32_16x16x32_bf16 v[40:43], v[24:27], v[160:163], v[40:43]
    v_rcp_f32 v55, v55
    v_mfma_f32_16x16x32_bf16 v[44:47], v[24:27], v[164:167], v[44:47]
    ds_read_b128 v[20:23], v3 offset:20480
    s_waitcnt lgkmcnt(4)
    v_mfma_f32_16x16x32_bf16 v[32:35], v[28:31], v[168:171], v[32:35]
    v_mul_f32 v63, v63, v55
    v_cvt_pk_bf16_f32 v50, v60, v61
    v_mfma_f32_16x16x32_bf16 v[36:39], v[28:31], v[172:175], v[36:39]
    ds_read_b128 v[24:27], v3 offset:21504
    v_mul_f32 v72, v64, v72
    v_mfma_f32_16x16x32_bf16 v[40:43], v[92:95], v[168:171], v[40:43]
    v_cvt_pk_bf16_f32 v51, v62, v63
    v_permlane16_swap_b32 v48, v50
    v_mfma_f32_16x16x32_bf16 v[44:47], v[92:95], v[172:175], v[44:47]
    ds_read_b128 v[28:31], v3 offset:22528
    v_mul_f32 v73, v65, v73
    v_mfma_f32_16x16x32_bf16 v[32:35], v[8:11], v[176:179], v[32:35]
    v_permlane16_swap_b32 v49, v51
    v_mul_f32 v74, v66, v74
    v_mfma_f32_16x16x32_bf16 v[36:39], v[8:11], v[180:183], v[36:39]
    ds_read_b128 v[92:95], v3 offset:23552
    s_waitcnt lgkmcnt(3)
    v_mfma_f32_16x16x32_bf16 v[40:43], v[12:15], v[176:179], v[40:43]
    buffer_store_dwordx4 v[48:51], v3, s[28:31], s46 offen sc1
    s_add_u32 s46, s46, 16384
    v_mul_f32 v75, v67, v75
    v_mfma_f32_16x16x32_bf16 v[44:47], v[12:15], v[180:183], v[44:47]
    ds_read_b128 v[8:11], v3 offset:24576
    v_mul_f32 v64, v4, v64
    v_mfma_f32_16x16x32_bf16 v[32:35], v[16:19], v[184:187], v[32:35]
    v_exp_f32 v64, v64
    v_mfma_f32_16x16x32_bf16 v[36:39], v[16:19], v[188:191], v[36:39]
    ds_read_b128 v[12:15], v3 offset:25600
    v_mul_f32 v65, v4, v65
    v_mfma_f32_16x16x32_bf16 v[40:43], v[20:23], v[184:187], v[40:43]
    v_exp_f32 v65, v65
    v_mfma_f32_16x16x32_bf16 v[44:47], v[20:23], v[188:191], v[44:47]
    ds_read_b128 v[16:19], v3 offset:26624
    s_waitcnt lgkmcnt(3)
    v_mfma_f32_16x16x32_bf16 v[32:35], v[24:27], v[192:195], v[32:35]
    v_mul_f32 v66, v4, v66
    v_mul_f32 v67, v4, v67
    v_mfma_f32_16x16x32_bf16 v[36:39], v[24:27], v[196:199], v[36:39]
    ds_read_b128 v[20:23], v3 offset:27648
    v_fma_f32 v64, v64, v5, v5
    v_mfma_f32_16x16x32_bf16 v[40:43], v[28:31], v[192:195], v[40:43]
    v_exp_f32 v66, v66
    v_mfma_f32_16x16x32_bf16 v[44:47], v[28:31], v[196:199], v[44:47]
    ds_read_b128 v[24:27], v3 offset:28672
    v_fma_f32 v65, v65, v5, v5
    v_mfma_f32_16x16x32_bf16 v[32:35], v[92:95], v[200:203], v[32:35]
    v_mfma_f32_16x16x32_bf16 v[40:43], v[88:91], v[82:85], v[40:43]
    v_mfma_f32_16x16x32_bf16 v[36:39], v[92:95], v[204:207], v[36:39]
    ds_read_b128 v[28:31], v3 offset:29696
    s_waitcnt lgkmcnt(3)
    v_mfma_f32_16x16x32_bf16 v[40:43], v[8:11], v[200:203], v[40:43]
    v_mfma_f32_16x16x32_bf16 v[44:47], v[88:91], v[84:87], v[44:47]
    v_mfma_f32_16x16x32_bf16 v[44:47], v[8:11], v[204:207], v[44:47]
    ds_read_b128 v[92:95], v3 offset:30720
    v_fma_f32 v66, v66, v5, v5
    v_mfma_f32_16x16x32_bf16 v[32:35], v[12:15], v[208:211], v[32:35]
    v_exp_f32 v67, v67
    v_mfma_f32_16x16x32_bf16 v[36:39], v[12:15], v[212:215], v[36:39]
    ds_read_b128 v[8:11], v3 offset:31744
    v_mul_f32 v76, v68, v76
    v_mfma_f32_16x16x32_bf16 v[40:43], v[16:19], v[208:211], v[40:43]
    v_rcp_f32 v64, v64
    v_mfma_f32_16x16x32_bf16 v[44:47], v[16:19], v[212:215], v[44:47]
    ds_read_b128 v[12:15], v3 offset:32768
    s_waitcnt lgkmcnt(3)
    v_mfma_f32_16x16x32_bf16 v[32:35], v[20:23], v[216:219], v[32:35]
    v_rcp_f32 v65, v65
    v_mfma_f32_16x16x32_bf16 v[36:39], v[20:23], v[220:223], v[36:39]
    ds_read_b128 v[16:19], v3 offset:33792
    v_fma_f32 v67, v67, v5, v5
    v_mfma_f32_16x16x32_bf16 v[40:43], v[24:27], v[216:219], v[40:43]
    v_rcp_f32 v66, v66
    v_mfma_f32_16x16x32_bf16 v[44:47], v[24:27], v[220:223], v[44:47]
    ds_read_b128 v[20:23], v3 offset:34816
    v_mul_f32 v72, v72, v64
    v_mfma_f32_16x16x32_bf16 v[32:35], v[28:31], v[224:227], v[32:35]
    v_rcp_f32 v67, v67
    v_mfma_f32_16x16x32_bf16 v[36:39], v[28:31], v[228:231], v[36:39]
    ds_read_b128 v[24:27], v3 offset:35840
    s_waitcnt lgkmcnt(3)
    v_mfma_f32_16x16x32_bf16 v[40:43], v[92:95], v[224:227], v[40:43]
    v_mul_f32 v73, v73, v65
    v_mul_f32 v74, v74, v66
    v_mfma_f32_16x16x32_bf16 v[44:47], v[92:95], v[228:231], v[44:47]
    ds_read_b128 v[28:31], v3 offset:36864
    v_mul_f32 v75, v75, v67
    v_mfma_f32_16x16x32_bf16 v[32:35], v[8:11], v[232:235], v[32:35]
    v_cvt_pk_bf16_f32 v64, v72, v73
    v_cvt_pk_bf16_f32 v65, v74, v75
    v_mfma_f32_16x16x32_bf16 v[36:39], v[8:11], v[236:239], v[36:39]
    s_barrier
    ds_read_b128 v[92:95], v3 offset:37888
    v_mul_f32 v77, v69, v77
    v_mfma_f32_16x16x32_bf16 v[40:43], v[12:15], v[232:235], v[40:43]
    v_mul_f32 v78, v70, v78
    v_mul_f32 v79, v71, v79
    v_mfma_f32_16x16x32_bf16 v[44:47], v[12:15], v[236:239], v[44:47]
    ds_read_b128 v[8:11], v3 offset:38912
    s_waitcnt lgkmcnt(3)
    v_mfma_f32_16x16x32_bf16 v[32:35], v[16:19], v[240:243], v[32:35]
    v_mul_f32 v68, v80, v68
    v_mul_f32 v69, v80, v69
    v_mfma_f32_16x16x32_bf16 v[36:39], v[16:19], v[244:247], v[36:39]
    ds_read_b128 v[12:15], v3 offset:39936
    v_mul_f32 v70, v80, v70
    v_mfma_f32_16x16x32_bf16 v[40:43], v[20:23], v[240:243], v[40:43]
    v_exp_f32 v68, v68
    v_mfma_f32_16x16x32_bf16 v[44:47], v[20:23], v[244:247], v[44:47]
    ds_read_b128 v[16:19], v3 offset:40960
    v_mul_f32 v71, v80, v71
    v_mfma_f32_16x16x32_bf16 v[32:35], v[24:27], v[248:251], v[32:35]
    v_exp_f32 v69, v69
    v_mfma_f32_16x16x32_bf16 v[36:39], v[24:27], v[252:255], v[36:39]
    ds_read_b128 v[20:23], v3 offset:41984
    s_waitcnt lgkmcnt(3)
    v_mfma_f32_16x16x32_bf16 v[40:43], v[28:31], v[248:251], v[40:43]
    v_exp_f32 v70, v70
    v_mfma_f32_16x16x32_bf16 v[44:47], v[28:31], v[252:255], v[44:47]
    ds_read_b128 v[24:27], v3 offset:43008
    v_fma_f32 v68, v68, v81, v81
    v_mfma_f32_16x16x32_bf16 v[48:51], v[92:95], v[96:99], 0
    v_exp_f32 v71, v71
    v_mfma_f32_16x16x32_bf16 v[52:55], v[92:95], v[100:103], 0
    ds_read_b128 v[28:31], v3 offset:44032
    v_fma_f32 v69, v69, v81, v81
    v_mfma_f32_16x16x32_bf16 v[56:59], v[8:11], v[96:99], 0
    v_rcp_f32 v68, v68
    v_mfma_f32_16x16x32_bf16 v[60:63], v[8:11], v[100:103], 0
    ds_read_b128 v[92:95], v3 offset:45056
    s_waitcnt lgkmcnt(3)
    v_mfma_f32_16x16x32_bf16 v[48:51], v[12:15], v[104:107], v[48:51]
    v_rcp_f32 v69, v69
    v_mfma_f32_16x16x32_bf16 v[52:55], v[12:15], v[108:111], v[52:55]
    ds_read_b128 v[8:11], v3 offset:46080
    v_fma_f32 v70, v70, v81, v81
    v_mfma_f32_16x16x32_bf16 v[56:59], v[16:19], v[104:107], v[56:59]
    v_rcp_f32 v70, v70
    v_mfma_f32_16x16x32_bf16 v[60:63], v[16:19], v[108:111], v[60:63]
    ds_read_b128 v[12:15], v3 offset:47104
    v_fma_f32 v71, v71, v81, v81
    v_mfma_f32_16x16x32_bf16 v[48:51], v[20:23], v[112:115], v[48:51]
    ds_read2st64_b64 v[88:91], v6 offset0:8 offset1:8
    v_mul_f32 v76, v76, v68
    v_mfma_f32_16x16x32_bf16 v[52:55], v[20:23], v[116:119], v[52:55]
    ds_read_b128 v[16:19], v3 offset:48128
    s_waitcnt lgkmcnt(4)
    v_mfma_f32_16x16x32_bf16 v[56:59], v[24:27], v[112:115], v[56:59]
    v_rcp_f32 v71, v71
    v_mfma_f32_16x16x32_bf16 v[60:63], v[24:27], v[116:119], v[60:63]
    ds_read_b128 v[20:23], v3 offset:49152
    v_mul_f32 v77, v77, v69
    v_mfma_f32_16x16x32_bf16 v[48:51], v[28:31], v[120:123], v[48:51]
    v_mul_f32 v78, v78, v70
    v_mul_f32 v79, v79, v71
    v_mfma_f32_16x16x32_bf16 v[52:55], v[28:31], v[124:127], v[52:55]
    ds_read_b128 v[24:27], v3 offset:50176
    v_cvt_pk_bf16_f32 v66, v76, v77
    v_mfma_f32_16x16x32_bf16 v[56:59], v[92:95], v[120:123], v[56:59]
    v_cvt_pk_bf16_f32 v67, v78, v79
    v_permlane16_swap_b32 v64, v66
    v_mfma_f32_16x16x32_bf16 v[60:63], v[92:95], v[124:127], v[60:63]
    ds_read_b128 v[28:31], v3 offset:51200
    s_waitcnt lgkmcnt(3)
    v_mfma_f32_16x16x32_bf16 v[48:51], v[8:11], v[128:131], v[48:51]
    v_permlane16_swap_b32 v65, v67
    v_mul_f32 v40, v32, v40
    v_mfma_f32_16x16x32_bf16 v[52:55], v[8:11], v[132:135], v[52:55]
    ds_read_b128 v[92:95], v3 offset:52224
    v_mul_f32 v41, v33, v41
    v_mfma_f32_16x16x32_bf16 v[56:59], v[12:15], v[128:131], v[56:59]
    buffer_store_dwordx4 v[64:67], v3, s[28:31], s46 offen sc1
    s_add_u32 s46, s46, 16384
    v_mul_f32 v42, v34, v42
    v_mfma_f32_16x16x32_bf16 v[60:63], v[12:15], v[132:135], v[60:63]
    ds_read_b128 v[8:11], v3 offset:53248
    v_mul_f32 v43, v35, v43
    v_mfma_f32_16x16x32_bf16 v[48:51], v[16:19], v[136:139], v[48:51]
    v_mul_f32 v32, v4, v32
    v_mul_f32 v33, v4, v33
    v_mfma_f32_16x16x32_bf16 v[52:55], v[16:19], v[140:143], v[52:55]
    ds_read_b128 v[12:15], v3 offset:54272
    s_waitcnt lgkmcnt(3)
    v_mfma_f32_16x16x32_bf16 v[56:59], v[20:23], v[136:139], v[56:59]
    v_exp_f32 v32, v32
    v_mfma_f32_16x16x32_bf16 v[60:63], v[20:23], v[140:143], v[60:63]
    ds_read_b128 v[16:19], v3 offset:55296
    v_mul_f32 v34, v4, v34
    v_mfma_f32_16x16x32_bf16 v[48:51], v[24:27], v[144:147], v[48:51]
    v_exp_f32 v33, v33
    v_mfma_f32_16x16x32_bf16 v[52:55], v[24:27], v[148:151], v[52:55]
    ds_read_b128 v[20:23], v3 offset:56320
    v_mul_f32 v35, v4, v35
    v_mfma_f32_16x16x32_bf16 v[56:59], v[28:31], v[144:147], v[56:59]
    v_exp_f32 v34, v34
    v_mfma_f32_16x16x32_bf16 v[60:63], v[28:31], v[148:151], v[60:63]
    ds_read_b128 v[24:27], v3 offset:57344
    s_waitcnt lgkmcnt(3)
    v_mfma_f32_16x16x32_bf16 v[48:51], v[92:95], v[152:155], v[48:51]
    v_mfma_f32_16x16x32_bf16 v[48:51], v[88:91], v[82:85], v[48:51]
    v_mfma_f32_16x16x32_bf16 v[52:55], v[92:95], v[156:159], v[52:55]
    s_waitcnt vmcnt(1)
    s_barrier
    ds_read_b128 v[28:31], v7 offset:13312
    v_fma_f32 v32, v32, v5, v5
    v_mfma_f32_16x16x32_bf16 v[56:59], v[8:11], v[152:155], v[56:59]
    v_mfma_f32_16x16x32_bf16 v[52:55], v[88:91], v[84:87], v[52:55]
    v_mfma_f32_16x16x32_bf16 v[60:63], v[8:11], v[156:159], v[60:63]
    ds_read_b128 v[92:95], v7 offset:14336
    v_fma_f32 v33, v33, v5, v5
    v_mfma_f32_16x16x32_bf16 v[48:51], v[12:15], v[160:163], v[48:51]
    ds_read2st64_b64 v[88:91], v6 offset0:9 offset1:9
    v_fma_f32 v34, v34, v5, v5
    v_mfma_f32_16x16x32_bf16 v[52:55], v[12:15], v[164:167], v[52:55]
    ds_read_b128 v[8:11], v7 offset:15360
    s_waitcnt lgkmcnt(4)
    v_mfma_f32_16x16x32_bf16 v[56:59], v[16:19], v[160:163], v[56:59]
    v_exp_f32 v35, v35
    v_mfma_f32_16x16x32_bf16 v[60:63], v[16:19], v[164:167], v[60:63]
    ds_read_b128 v[12:15], v7 offset:16384
    v_mul_f32 v44, v36, v44
    v_mfma_f32_16x16x32_bf16 v[48:51], v[20:23], v[168:171], v[48:51]
    v_rcp_f32 v32, v32
    v_mfma_f32_16x16x32_bf16 v[52:55], v[20:23], v[172:175], v[52:55]
    ds_read_b128 v[16:19], v7 offset:17408
    v_fma_f32 v35, v35, v5, v5
    v_mfma_f32_16x16x32_bf16 v[56:59], v[24:27], v[168:171], v[56:59]
    v_rcp_f32 v33, v33
    v_mfma_f32_16x16x32_bf16 v[60:63], v[24:27], v[172:175], v[60:63]
    ds_read_b128 v[20:23], v7 offset:18432
    s_waitcnt lgkmcnt(3)
    v_mfma_f32_16x16x32_bf16 v[48:51], v[28:31], v[176:179], v[48:51]
    v_rcp_f32 v34, v34
    v_mfma_f32_16x16x32_bf16 v[52:55], v[28:31], v[180:183], v[52:55]
    ds_read_b128 v[24:27], v7 offset:19456
    v_mul_f32 v40, v40, v32
    v_mfma_f32_16x16x32_bf16 v[56:59], v[92:95], v[176:179], v[56:59]
    v_rcp_f32 v35, v35
    v_mfma_f32_16x16x32_bf16 v[60:63], v[92:95], v[180:183], v[60:63]
    ds_read_b128 v[28:31], v7 offset:20480
    v_mul_f32 v41, v41, v33
    v_mfma_f32_16x16x32_bf16 v[48:51], v[8:11], v[184:187], v[48:51]
    v_mul_f32 v42, v42, v34
    v_mul_f32 v43, v43, v35
    v_mfma_f32_16x16x32_bf16 v[52:55], v[8:11], v[188:191], v[52:55]
    ds_read_b128 v[92:95], v7 offset:21504
    s_waitcnt lgkmcnt(3)
    v_mfma_f32_16x16x32_bf16 v[56:59], v[12:15], v[184:187], v[56:59]
    v_cvt_pk_bf16_f32 v32, v40, v41
    v_cvt_pk_bf16_f32 v33, v42, v43
    v_mfma_f32_16x16x32_bf16 v[60:63], v[12:15], v[188:191], v[60:63]
    ds_read_b128 v[8:11], v7 offset:22528
    v_mul_f32 v45, v37, v45
    v_mfma_f32_16x16x32_bf16 v[48:51], v[16:19], v[192:195], v[48:51]
    v_mul_f32 v46, v38, v46
    v_mul_f32 v47, v39, v47
    v_mfma_f32_16x16x32_bf16 v[52:55], v[16:19], v[196:199], v[52:55]
    ds_read_b128 v[12:15], v7 offset:23552
    v_mul_f32 v36, v80, v36
    v_mfma_f32_16x16x32_bf16 v[56:59], v[20:23], v[192:195], v[56:59]
    v_exp_f32 v36, v36
    v_mfma_f32_16x16x32_bf16 v[60:63], v[20:23], v[196:199], v[60:63]
    ds_read_b128 v[16:19], v7 offset:24576
    s_waitcnt lgkmcnt(3)
    v_mfma_f32_16x16x32_bf16 v[48:51], v[24:27], v[200:203], v[48:51]
    v_mfma_f32_16x16x32_bf16 v[56:59], v[88:91], v[82:85], v[56:59]
    v_mfma_f32_16x16x32_bf16 v[52:55], v[24:27], v[204:207], v[52:55]
    ds_read_b128 v[20:23], v7 offset:25600
    v_mul_f32 v37, v80, v37
    v_mfma_f32_16x16x32_bf16 v[56:59], v[28:31], v[200:203], v[56:59]
    v_mfma_f32_16x16x32_bf16 v[60:63], v[88:91], v[84:87], v[60:63]
    v_mfma_f32_16x16x32_bf16 v[60:63], v[28:31], v[204:207], v[60:63]
    ds_read_b128 v[24:27], v7 offset:26624
    v_mul_f32 v38, v80, v38
    v_mfma_f32_16x16x32_bf16 v[48:51], v[92:95], v[208:211], v[48:51]
    v_exp_f32 v37, v37
    v_mfma_f32_16x16x32_bf16 v[52:55], v[92:95], v[212:215], v[52:55]
    ds_read_b128 v[28:31], v7 offset:27648
    s_waitcnt lgkmcnt(3)
    v_mfma_f32_16x16x32_bf16 v[56:59], v[8:11], v[208:211], v[56:59]
    v_exp_f32 v38, v38
    v_mfma_f32_16x16x32_bf16 v[60:63], v[8:11], v[212:215], v[60:63]
    ds_read_b128 v[92:95], v7 offset:28672
    v_mul_f32 v39, v80, v39
    v_mfma_f32_16x16x32_bf16 v[48:51], v[12:15], v[216:219], v[48:51]
    v_exp_f32 v39, v39
    v_mfma_f32_16x16x32_bf16 v[52:55], v[12:15], v[220:223], v[52:55]
    s_nop 0
hop_pad_13:
    s_cbranch_execz hop_pad_17
    ds_read_b128 v[8:11], v7 offset:29696
    v_fma_f32 v36, v36, v81, v81
    v_mfma_f32_16x16x32_bf16 v[56:59], v[16:19], v[216:219], v[56:59]
    v_rcp_f32 v36, v36
    v_mfma_f32_16x16x32_bf16 v[60:63], v[16:19], v[220:223], v[60:63]
    ds_read_b128 v[12:15], v7 offset:30720
    s_waitcnt lgkmcnt(3)
    v_mfma_f32_16x16x32_bf16 v[48:51], v[20:23], v[224:227], v[48:51]
    v_fma_f32 v37, v37, v81, v81
    v_fma_f32 v38, v38, v81, v81
    v_mfma_f32_16x16x32_bf16 v[52:55], v[20:23], v[228:231], v[52:55]
    ds_read_b128 v[16:19], v7 offset:31744
    v_fma_f32 v39, v39, v81, v81
    v_mfma_f32_16x16x32_bf16 v[56:59], v[24:27], v[224:227], v[56:59]
    v_rcp_f32 v37, v37
    v_mfma_f32_16x16x32_bf16 v[60:63], v[24:27], v[228:231], v[60:63]
    ds_read_b128 v[20:23], v7 offset:32768
    v_mul_f32 v44, v44, v36
    v_mfma_f32_16x16x32_bf16 v[48:51], v[28:31], v[232:235], v[48:51]
    v_rcp_f32 v38, v38
    v_mfma_f32_16x16x32_bf16 v[52:55], v[28:31], v[236:239], v[52:55]
    s_barrier
    ds_read_b128 v[24:27], v7 offset:33792
    s_waitcnt lgkmcnt(3)
    v_mfma_f32_16x16x32_bf16 v[56:59], v[92:95], v[232:235], v[56:59]
    v_rcp_f32 v39, v39
    v_mfma_f32_16x16x32_bf16 v[60:63], v[92:95], v[236:239], v[60:63]
    ds_read_b128 v[28:31], v7 offset:34816
    v_mul_f32 v45, v45, v37
    v_mfma_f32_16x16x32_bf16 v[48:51], v[8:11], v[240:243], v[48:51]
    v_mul_f32 v46, v46, v38
    v_mul_f32 v47, v47, v39
    v_mfma_f32_16x16x32_bf16 v[52:55], v[8:11], v[244:247], v[52:55]
    ds_read_b128 v[92:95], v7 offset:35840
    v_cvt_pk_bf16_f32 v34, v44, v45
    v_mfma_f32_16x16x32_bf16 v[56:59], v[12:15], v[240:243], v[56:59]
    v_cvt_pk_bf16_f32 v35, v46, v47
    v_permlane16_swap_b32 v32, v34
    v_mfma_f32_16x16x32_bf16 v[60:63], v[12:15], v[244:247], v[60:63]
    ds_read_b128 v[8:11], v7 offset:36864
    s_waitcnt lgkmcnt(3)
    v_mfma_f32_16x16x32_bf16 v[48:51], v[16:19], v[248:251], v[48:51]
    v_permlane16_swap_b32 v33, v35
    v_mfma_f32_16x16x32_bf16 v[52:55], v[16:19], v[252:255], v[52:55]
    ds_read_b128 v[12:15], v7 offset:37888
    v_mfma_f32_16x16x32_bf16 v[56:59], v[20:23], v[248:251], v[56:59]
    buffer_store_dwordx4 v[32:35], v3, s[28:31], s46 offen sc1
    s_add_u32 s46, s46, 16384
    v_mfma_f32_16x16x32_bf16 v[60:63], v[20:23], v[252:255], v[60:63]
    ds_read_b128 v[16:19], v7 offset:38912
    v_mfma_f32_16x16x32_bf16 v[64:67], v[24:27], v[96:99], 0
    v_mfma_f32_16x16x32_bf16 v[68:71], v[24:27], v[100:103], 0
    ds_read_b128 v[20:23], v7 offset:39936
    s_waitcnt lgkmcnt(3)
    v_mfma_f32_16x16x32_bf16 v[72:75], v[28:31], v[96:99], 0
    v_mul_f32 v56, v48, v56
    v_mul_f32 v57, v49, v57
    v_mfma_f32_16x16x32_bf16 v[76:79], v[28:31], v[100:103], 0
    ds_read_b128 v[24:27], v7 offset:40960
    v_mul_f32 v58, v50, v58
    v_mfma_f32_16x16x32_bf16 v[64:67], v[92:95], v[104:107], v[64:67]
    v_mul_f32 v59, v51, v59
    v_mul_f32 v48, v4, v48
    v_mfma_f32_16x16x32_bf16 v[68:71], v[92:95], v[108:111], v[68:71]
    ds_read_b128 v[28:31], v7 offset:41984
    v_mul_f32 v49, v4, v49
    v_mfma_f32_16x16x32_bf16 v[72:75], v[8:11], v[104:107], v[72:75]
    v_exp_f32 v48, v48
    v_mfma_f32_16x16x32_bf16 v[76:79], v[8:11], v[108:111], v[76:79]
    ds_read_b128 v[92:95], v7 offset:43008
    s_waitcnt lgkmcnt(3)
    v_mfma_f32_16x16x32_bf16 v[64:67], v[12:15], v[112:115], v[64:67]
    ds_read2st64_b64 v[88:91], v6 offset0:10 offset1:10
    v_mul_f32 v50, v4, v50
    v_mfma_f32_16x16x32_bf16 v[68:71], v[12:15], v[116:119], v[68:71]
    ds_read_b128 v[8:11], v7 offset:44032
    v_mul_f32 v51, v4, v51
    v_mfma_f32_16x16x32_bf16 v[72:75], v[16:19], v[112:115], v[72:75]
    v_exp_f32 v49, v49
    v_mfma_f32_16x16x32_bf16 v[76:79], v[16:19], v[116:119], v[76:79]
    ds_read_b128 v[12:15], v7 offset:45056
    v_fma_f32 v48, v48, v5, v5
    v_mfma_f32_16x16x32_bf16 v[64:67], v[20:23], v[120:123], v[64:67]
    v_exp_f32 v50, v50
    v_mfma_f32_16x16x32_bf16 v[68:71], v[20:23], v[124:127], v[68:71]
    ds_read_b128 v[16:19], v7 offset:46080
    s_waitcnt lgkmcnt(4)
    v_mfma_f32_16x16x32_bf16 v[72:75], v[24:27], v[120:123], v[72:75]
    v_exp_f32 v51, v51
    v_mfma_f32_16x16x32_bf16 v[76:79], v[24:27], v[124:127], v[76:79]
    ds_read_b128 v[20:23], v7 offset:47104
    v_fma_f32 v49, v49, v5, v5
    v_mfma_f32_16x16x32_bf16 v[64:67], v[28:31], v[128:131], v[64:67]
    v_rcp_f32 v48, v48
    v_mfma_f32_16x16x32_bf16 v[68:71], v[28:31], v[132:135], v[68:71]
    ds_read_b128 v[24:27], v7 offset:48128
    v_fma_f32 v50, v50, v5, v5
    v_mfma_f32_16x16x32_bf16 v[72:75], v[92:95], v[128:131], v[72:75]
    v_rcp_f32 v49, v49
    v_mfma_f32_16x16x32_bf16 v[76:79], v[92:95], v[132:135], v[76:79]
    ds_read_b128 v[28:31], v7 offset:49152
    s_waitcnt lgkmcnt(3)
    v_mfma_f32_16x16x32_bf16 v[64:67], v[8:11], v[136:139], v[64:67]
    v_rcp_f32 v50, v50
    v_mfma_f32_16x16x32_bf16 v[68:71], v[8:11], v[140:143], v[68:71]
    ds_read_b128 v[92:95], v7 offset:50176
    v_fma_f32 v51, v51, v5, v5
    v_mfma_f32_16x16x32_bf16 v[72:75], v[12:15], v[136:139], v[72:75]
    v_rcp_f32 v51, v51
    v_mfma_f32_16x16x32_bf16 v[76:79], v[12:15], v[140:143], v[76:79]
    ds_read_b128 v[8:11], v7 offset:51200
    v_mul_f32 v56, v56, v48
    v_mfma_f32_16x16x32_bf16 v[64:67], v[16:19], v[144:147], v[64:67]
    v_mul_f32 v57, v57, v49
    v_mul_f32 v58, v58, v50
    v_mfma_f32_16x16x32_bf16 v[68:71], v[16:19], v[148:151], v[68:71]
    ds_read_b128 v[12:15], v7 offset:52224
    s_waitcnt lgkmcnt(3)
    v_mfma_f32_16x16x32_bf16 v[72:75], v[20:23], v[144:147], v[72:75]
    v_mul_f32 v59, v59, v51
    v_cvt_pk_bf16_f32 v48, v56, v57
    v_mfma_f32_16x16x32_bf16 v[76:79], v[20:23], v[148:151], v[76:79]
    ds_read_b128 v[16:19], v7 offset:53248
    v_mul_f32 v60, v52, v60
    v_mfma_f32_16x16x32_bf16 v[64:67], v[24:27], v[152:155], v[64:67]
    v_mfma_f32_16x16x32_bf16 v[64:67], v[88:91], v[82:85], v[64:67]
    v_mfma_f32_16x16x32_bf16 v[68:71], v[24:27], v[156:159], v[68:71]
    s_barrier
    ds_read_b128 v[20:23], v7 offset:54272
    v_cvt_pk_bf16_f32 v49, v58, v59
    v_mfma_f32_16x16x32_bf16 v[72:75], v[28:31], v[152:155], v[72:75]
    v_mfma_f32_16x16x32_bf16 v[68:71], v[88:91], v[84:87], v[68:71]
    v_mfma_f32_16x16x32_bf16 v[76:79], v[28:31], v[156:159], v[76:79]
    ds_read_b128 v[24:27], v7 offset:55296
    s_waitcnt lgkmcnt(3)
    v_mfma_f32_16x16x32_bf16 v[64:67], v[92:95], v[160:163], v[64:67]
    ds_read2st64_b64 v[88:91], v6 offset0:11 offset1:11
    v_mul_f32 v61, v53, v61
    v_mfma_f32_16x16x32_bf16 v[68:71], v[92:95], v[164:167], v[68:71]
    ds_read_b128 v[28:31], v7 offset:56320
    v_mul_f32 v62, v54, v62
    v_mfma_f32_16x16x32_bf16 v[72:75], v[8:11], v[160:163], v[72:75]
    v_mul_f32 v63, v55, v63
    v_mul_f32 v52, v80, v52
    v_mfma_f32_16x16x32_bf16 v[76:79], v[8:11], v[164:167], v[76:79]
    ds_read_b128 v[92:95], v7 offset:57344
    v_mul_f32 v53, v80, v53
    v_mfma_f32_16x16x32_bf16 v[64:67], v[12:15], v[168:171], v[64:67]
    v_exp_f32 v52, v52
    v_mfma_f32_16x16x32_bf16 v[68:71], v[12:15], v[172:175], v[68:71]
    ds_read_b128 v[8:11], v7 offset:58368
    s_waitcnt lgkmcnt(4)
    v_mfma_f32_16x16x32_bf16 v[72:75], v[16:19], v[168:171], v[72:75]
    v_exp_f32 v53, v53
    v_mfma_f32_16x16x32_bf16 v[76:79], v[16:19], v[172:175], v[76:79]
    ds_read_b128 v[12:15], v7 offset:59392
    v_mul_f32 v54, v80, v54
    v_mfma_f32_16x16x32_bf16 v[64:67], v[20:23], v[176:179], v[64:67]
    v_exp_f32 v54, v54
    v_mfma_f32_16x16x32_bf16 v[68:71], v[20:23], v[180:183], v[68:71]
    ds_read_b128 v[16:19], v7 offset:60416
    v_mul_f32 v55, v80, v55
    v_mfma_f32_16x16x32_bf16 v[72:75], v[24:27], v[176:179], v[72:75]
    v_exp_f32 v55, v55
    v_mfma_f32_16x16x32_bf16 v[76:79], v[24:27], v[180:183], v[76:79]
    ds_read_b128 v[20:23], v7 offset:61440
    s_waitcnt lgkmcnt(3)
    v_mfma_f32_16x16x32_bf16 v[64:67], v[28:31], v[184:187], v[64:67]
    v_fma_f32 v52, v52, v81, v81
    v_fma_f32 v53, v53, v81, v81
    v_mfma_f32_16x16x32_bf16 v[68:71], v[28:31], v[188:191], v[68:71]
    ds_read_b128 v[24:27], v7 offset:62464
    v_fma_f32 v54, v54, v81, v81
    v_mfma_f32_16x16x32_bf16 v[72:75], v[92:95], v[184:187], v[72:75]
    v_rcp_f32 v52, v52
    v_mfma_f32_16x16x32_bf16 v[76:79], v[92:95], v[188:191], v[76:79]
    ds_read_b128 v[28:31], v7 offset:63488
    v_fma_f32 v55, v55, v81, v81
    v_mfma_f32_16x16x32_bf16 v[64:67], v[8:11], v[192:195], v[64:67]
    v_rcp_f32 v53, v53
    v_mfma_f32_16x16x32_bf16 v[68:71], v[8:11], v[196:199], v[68:71]
    ds_read_b128 v[92:95], v7 offset:64512
    s_waitcnt lgkmcnt(3)
    v_mfma_f32_16x16x32_bf16 v[72:75], v[12:15], v[192:195], v[72:75]
    v_rcp_f32 v54, v54
    v_mfma_f32_16x16x32_bf16 v[76:79], v[12:15], v[196:199], v[76:79]
    ds_read_b128 v[8:11], v1 offset:0
    v_mul_f32 v60, v60, v52
    v_mfma_f32_16x16x32_bf16 v[64:67], v[16:19], v[200:203], v[64:67]
    v_mfma_f32_16x16x32_bf16 v[72:75], v[88:91], v[82:85], v[72:75]
    v_mfma_f32_16x16x32_bf16 v[68:71], v[16:19], v[204:207], v[68:71]
    ds_read_b128 v[12:15], v1 offset:1024
    v_mul_f32 v61, v61, v53
    v_mfma_f32_16x16x32_bf16 v[72:75], v[20:23], v[200:203], v[72:75]
    v_mfma_f32_16x16x32_bf16 v[76:79], v[88:91], v[84:87], v[76:79]
    v_mfma_f32_16x16x32_bf16 v[76:79], v[20:23], v[204:207], v[76:79]
    ds_read_b128 v[16:19], v1 offset:2048
    s_waitcnt lgkmcnt(3)
    v_mfma_f32_16x16x32_bf16 v[64:67], v[24:27], v[208:211], v[64:67]
    v_rcp_f32 v55, v55
    v_mfma_f32_16x16x32_bf16 v[68:71], v[24:27], v[212:215], v[68:71]
    ds_read_b128 v[20:23], v1 offset:3072
    v_mul_f32 v62, v62, v54
    v_mfma_f32_16x16x32_bf16 v[72:75], v[28:31], v[208:211], v[72:75]
    v_mul_f32 v63, v63, v55
    v_cvt_pk_bf16_f32 v50, v60, v61
    v_mfma_f32_16x16x32_bf16 v[76:79], v[28:31], v[212:215], v[76:79]
    ds_read_b128 v[24:27], v1 offset:4096
    v_mfma_f32_16x16x32_bf16 v[64:67], v[92:95], v[216:219], v[64:67]
    v_cvt_pk_bf16_f32 v51, v62, v63
    v_permlane16_swap_b32 v48, v50
    v_mfma_f32_16x16x32_bf16 v[68:71], v[92:95], v[220:223], v[68:71]
    ds_read_b128 v[28:31], v1 offset:5120
    s_waitcnt lgkmcnt(3)
    v_mfma_f32_16x16x32_bf16 v[72:75], v[8:11], v[216:219], v[72:75]
    v_permlane16_swap_b32 v49, v51
    v_mfma_f32_16x16x32_bf16 v[76:79], v[8:11], v[220:223], v[76:79]
    ds_read_b128 v[92:95], v1 offset:6144
    v_mfma_f32_16x16x32_bf16 v[64:67], v[12:15], v[224:227], v[64:67]
    buffer_store_dwordx4 v[48:51], v3, s[28:31], s46 offen sc1
    s_add_u32 s46, s46, 16384
    v_mfma_f32_16x16x32_bf16 v[68:71], v[12:15], v[228:231], v[68:71]
    ds_read_b128 v[8:11], v1 offset:7168
    v_mfma_f32_16x16x32_bf16 v[72:75], v[16:19], v[224:227], v[72:75]
    v_mfma_f32_16x16x32_bf16 v[76:79], v[16:19], v[228:231], v[76:79]
    ds_read_b128 v[12:15], v1 offset:8192
    s_waitcnt lgkmcnt(3)
    v_mfma_f32_16x16x32_bf16 v[64:67], v[20:23], v[232:235], v[64:67]
    v_mfma_f32_16x16x32_bf16 v[68:71], v[20:23], v[236:239], v[68:71]
    s_waitcnt vmcnt(1)
    s_barrier
    ds_read_b128 v[16:19], v1 offset:9216
    v_mfma_f32_16x16x32_bf16 v[72:75], v[24:27], v[232:235], v[72:75]
    v_mfma_f32_16x16x32_bf16 v[76:79], v[24:27], v[236:239], v[76:79]
    ds_read_b128 v[20:23], v1 offset:10240
    v_mfma_f32_16x16x32_bf16 v[64:67], v[28:31], v[240:243], v[64:67]
    v_mfma_f32_16x16x32_bf16 v[68:71], v[28:31], v[244:247], v[68:71]
    ds_read_b128 v[24:27], v1 offset:11264
    s_waitcnt lgkmcnt(3)
    v_mfma_f32_16x16x32_bf16 v[72:75], v[92:95], v[240:243], v[72:75]
    v_mfma_f32_16x16x32_bf16 v[76:79], v[92:95], v[244:247], v[76:79]
    ds_read_b128 v[28:31], v1 offset:12288
    v_mfma_f32_16x16x32_bf16 v[64:67], v[8:11], v[248:251], v[64:67]
    v_mfma_f32_16x16x32_bf16 v[68:71], v[8:11], v[252:255], v[68:71]
    ds_read_b128 v[92:95], v1 offset:13312
    v_mfma_f32_16x16x32_bf16 v[72:75], v[12:15], v[248:251], v[72:75]
    v_mfma_f32_16x16x32_bf16 v[76:79], v[12:15], v[252:255], v[76:79]
    ds_read_b128 v[8:11], v1 offset:14336
    s_waitcnt lgkmcnt(3)
    v_mfma_f32_16x16x32_bf16 v[32:35], v[16:19], v[96:99], 0
    v_mfma_f32_16x16x32_bf16 v[36:39], v[16:19], v[100:103], 0
    ds_read_b128 v[12:15], v1 offset:15360
    v_mfma_f32_16x16x32_bf16 v[40:43], v[20:23], v[96:99], 0
    s_nop 0
    v_mul_f32 v72, v64, v72
    v_mul_f32 v73, v65, v73
    v_mfma_f32_16x16x32_bf16 v[44:47], v[20:23], v[100:103], 0
    ds_read_b128 v[16:19], v1 offset:16384
    v_mul_f32 v74, v66, v74
    v_mfma_f32_16x16x32_bf16 v[32:35], v[24:27], v[104:107], v[32:35]
    v_mul_f32 v75, v67, v75
    v_mul_f32 v64, v4, v64
    v_mfma_f32_16x16x32_bf16 v[36:39], v[24:27], v[108:111], v[36:39]
    ds_read_b128 v[20:23], v1 offset:17408
    s_waitcnt lgkmcnt(3)
    v_mfma_f32_16x16x32_bf16 v[40:43], v[28:31], v[104:107], v[40:43]
    v_exp_f32 v64, v64
    v_mfma_f32_16x16x32_bf16 v[44:47], v[28:31], v[108:111], v[44:47]
    ds_read_b128 v[24:27], v1 offset:18432
    v_mul_f32 v65, v4, v65
    v_mfma_f32_16x16x32_bf16 v[32:35], v[92:95], v[112:115], v[32:35]
    ds_read2st64_b64 v[88:91], v6 offset0:12 offset1:12
    v_mul_f32 v66, v4, v66
    v_mfma_f32_16x16x32_bf16 v[36:39], v[92:95], v[116:119], v[36:39]
    ds_read_b128 v[28:31], v1 offset:19456
    v_mul_f32 v67, v4, v67
    v_mfma_f32_16x16x32_bf16 v[40:43], v[8:11], v[112:115], v[40:43]
    v_exp_f32 v65, v65
    v_mfma_f32_16x16x32_bf16 v[44:47], v[8:11], v[116:119], v[44:47]
    ds_read_b128 v[92:95], v1 offset:20480
    s_waitcnt lgkmcnt(4)
    v_mfma_f32_16x16x32_bf16 v[32:35], v[12:15], v[120:123], v[32:35]
    v_exp_f32 v66, v66
    v_mfma_f32_16x16x32_bf16 v[36:39], v[12:15], v[124:127], v[36:39]
    ds_read_b128 v[8:11], v1 offset:21504
    v_fma_f32 v64, v64, v5, v5
    v_mfma_f32_16x16x32_bf16 v[40:43], v[16:19], v[120:123], v[40:43]
    v_exp_f32 v67, v67
    v_mfma_f32_16x16x32_bf16 v[44:47], v[16:19], v[124:127], v[44:47]
    ds_read_b128 v[12:15], v1 offset:22528
    v_fma_f32 v65, v65, v5, v5
    v_mfma_f32_16x16x32_bf16 v[32:35], v[20:23], v[128:131], v[32:35]
    v_rcp_f32 v64, v64
    v_mfma_f32_16x16x32_bf16 v[36:39], v[20:23], v[132:135], v[36:39]
    ds_read_b128 v[16:19], v1 offset:23552
    s_waitcnt lgkmcnt(3)
    v_mfma_f32_16x16x32_bf16 v[40:43], v[24:27], v[128:131], v[40:43]
    v_rcp_f32 v65, v65
    v_mfma_f32_16x16x32_bf16 v[44:47], v[24:27], v[132:135], v[44:47]
    ds_read_b128 v[20:23], v1 offset:24576
    v_fma_f32 v66, v66, v5, v5
    v_mfma_f32_16x16x32_bf16 v[32:35], v[28:31], v[136:139], v[32:35]
    v_rcp_f32 v66, v66
    v_mfma_f32_16x16x32_bf16 v[36:39], v[28:31], v[140:143], v[36:39]
    ds_read_b128 v[24:27], v1 offset:25600
    buffer_load_dwordx4 v[128:131], v2, s[28:31], s52 offen offset:0 sc1
    v_mfma_f32_16x16x32_bf16 v[40:43], v[92:95], v[136:139], v[40:43]
    v_fma_f32 v67, v67, v5, v5
    v_mul_f32 v72, v72, v64
    v_mfma_f32_16x16x32_bf16 v[44:47], v[92:95], v[140:143], v[44:47]
    ds_read_b128 v[28:31], v1 offset:26624
    s_waitcnt lgkmcnt(3)
    v_mfma_f32_16x16x32_bf16 v[32:35], v[8:11], v[144:147], v[32:35]
    v_rcp_f32 v67, v67
    v_mfma_f32_16x16x32_bf16 v[36:39], v[8:11], v[148:151], v[36:39]
    ds_read_b128 v[92:95], v1 offset:27648
    buffer_load_dwordx4 v[132:135], v2, s[28:31], s52 offen offset:2048 sc1
    v_mfma_f32_16x16x32_bf16 v[40:43], v[12:15], v[144:147], v[40:43]
    v_mul_f32 v73, v73, v65
    v_mul_f32 v74, v74, v66
    v_mfma_f32_16x16x32_bf16 v[44:47], v[12:15], v[148:151], v[44:47]
    ds_read_b128 v[8:11], v1 offset:28672
    v_mul_f32 v75, v75, v67
    v_mfma_f32_16x16x32_bf16 v[32:35], v[16:19], v[152:155], v[32:35]
    v_mfma_f32_16x16x32_bf16 v[32:35], v[88:91], v[82:85], v[32:35]
    v_mfma_f32_16x16x32_bf16 v[36:39], v[16:19], v[156:159], v[36:39]
    s_barrier
    ds_read_b128 v[12:15], v3 offset:58368
    s_add_u32 s52, s52, 4096
    buffer_load_dwordx4 v[136:139], v2, s[28:31], s52 offen offset:0 sc1
    s_waitcnt lgkmcnt(3)
    v_mfma_f32_16x16x32_bf16 v[40:43], v[20:23], v[152:155], v[40:43]
    v_mfma_f32_16x16x32_bf16 v[36:39], v[88:91], v[84:87], v[36:39]
    v_mfma_f32_16x16x32_bf16 v[44:47], v[20:23], v[156:159], v[44:47]
    ds_read_b128 v[16:19], v3 offset:59392
    v_cvt_pk_bf16_f32 v64, v72, v73
    v_mfma_f32_16x16x32_bf16 v[32:35], v[24:27], v[160:163], v[32:35]
    ds_read2st64_b64 v[88:91], v6 offset0:13 offset1:13
    v_cvt_pk_bf16_f32 v65, v74, v75
    v_mfma_f32_16x16x32_bf16 v[36:39], v[24:27], v[164:167], v[36:39]
    ds_read_b128 v[20:23], v3 offset:60416
    buffer_load_dwordx4 v[140:143], v2, s[28:31], s52 offen offset:2048 sc1
    v_mfma_f32_16x16x32_bf16 v[40:43], v[28:31], v[160:163], v[40:43]
    v_mul_f32 v76, v68, v76
    v_mul_f32 v77, v69, v77
    v_mfma_f32_16x16x32_bf16 v[44:47], v[28:31], v[164:167], v[44:47]
    ds_read_b128 v[24:27], v3 offset:61440
    s_waitcnt lgkmcnt(4)
    v_mfma_f32_16x16x32_bf16 v[32:35], v[92:95], v[168:171], v[32:35]
    v_mul_f32 v78, v70, v78
    v_mul_f32 v79, v71, v79
    v_mfma_f32_16x16x32_bf16 v[36:39], v[92:95], v[172:175], v[36:39]
    ds_read_b128 v[28:31], v3 offset:62464
    s_add_u32 s52, s52, 4096
    buffer_load_dwordx4 v[144:147], v2, s[28:31], s52 offen offset:0 sc1
    v_mfma_f32_16x16x32_bf16 v[40:43], v[8:11], v[168:171], v[40:43]
    v_mul_f32 v68, v80, v68
    v_mul_f32 v69, v80, v69
    v_mfma_f32_16x16x32_bf16 v[44:47], v[8:11], v[172:175], v[44:47]
    ds_read_b128 v[92:95], v3 offset:63488
    v_mul_f32 v70, v80, v70
    v_mfma_f32_16x16x32_bf16 v[32:35], v[12:15], v[176:179], v[32:35]
    v_exp_f32 v68, v68
    v_mfma_f32_16x16x32_bf16 v[36:39], v[12:15], v[180:183], v[36:39]
    ds_read_b128 v[8:11], v3 offset:64512
    buffer_load_dwordx4 v[148:151], v2, s[28:31], s52 offen offset:2048 sc1
    s_waitcnt lgkmcnt(3)
    v_mfma_f32_16x16x32_bf16 v[40:43], v[16:19], v[176:179], v[40:43]
    v_exp_f32 v69, v69
    v_mfma_f32_16x16x32_bf16 v[44:47], v[16:19], v[180:183], v[44:47]
    ds_read_b128 v[12:15], v7 offset:0
    v_mul_f32 v71, v80, v71
    v_mfma_f32_16x16x32_bf16 v[32:35], v[20:23], v[184:187], v[32:35]
    v_exp_f32 v70, v70
    v_mfma_f32_16x16x32_bf16 v[36:39], v[20:23], v[188:191], v[36:39]
    ds_read_b128 v[16:19], v7 offset:1024
    s_add_u32 s52, s52, 4096
    buffer_load_dwordx4 v[152:155], v2, s[28:31], s52 offen offset:0 sc1
    v_mfma_f32_16x16x32_bf16 v[40:43], v[24:27], v[184:187], v[40:43]
    v_exp_f32 v71, v71
    v_mfma_f32_16x16x32_bf16 v[44:47], v[24:27], v[188:191], v[44:47]
    ds_read_b128 v[20:23], v7 offset:2048
    s_waitcnt lgkmcnt(3)
    v_mfma_f32_16x16x32_bf16 v[32:35], v[28:31], v[192:195], v[32:35]
    v_fma_f32 v68, v68, v81, v81
    v_fma_f32 v69, v69, v81, v81
    v_mfma_f32_16x16x32_bf16 v[36:39], v[28:31], v[196:199], v[36:39]
    ds_read_b128 v[24:27], v7 offset:3072
    buffer_load_dwordx4 v[156:159], v2, s[28:31], s52 offen offset:2048 sc1
    v_mfma_f32_16x16x32_bf16 v[40:43], v[92:95], v[192:195], v[40:43]
    v_rcp_f32 v68, v68
    v_mfma_f32_16x16x32_bf16 v[44:47], v[92:95], v[196:199], v[44:47]
    ds_read_b128 v[28:31], v7 offset:4096
    v_fma_f32 v70, v70, v81, v81
    v_mfma_f32_16x16x32_bf16 v[32:35], v[8:11], v[200:203], v[32:35]
    v_mfma_f32_16x16x32_bf16 v[40:43], v[88:91], v[82:85], v[40:43]
    v_mfma_f32_16x16x32_bf16 v[36:39], v[8:11], v[204:207], v[36:39]
    ds_read_b128 v[92:95], v7 offset:5120
    s_add_u32 s52, s52, 4096
    buffer_load_dwordx4 v[160:163], v2, s[28:31], s52 offen offset:0 sc1
    s_waitcnt lgkmcnt(3)
    v_mfma_f32_16x16x32_bf16 v[40:43], v[12:15], v[200:203], v[40:43]
    v_mfma_f32_16x16x32_bf16 v[44:47], v[88:91], v[84:87], v[44:47]
    v_mfma_f32_16x16x32_bf16 v[44:47], v[12:15], v[204:207], v[44:47]
    ds_read_b128 v[8:11], v7 offset:6144
    v_fma_f32 v71, v71, v81, v81
    v_mfma_f32_16x16x32_bf16 v[32:35], v[16:19], v[208:211], v[32:35]
    v_rcp_f32 v69, v69
    v_mfma_f32_16x16x32_bf16 v[36:39], v[16:19], v[212:215], v[36:39]
    ds_read_b128 v[12:15], v7 offset:7168
    buffer_load_dwordx4 v[164:167], v2, s[28:31], s52 offen offset:2048 sc1
    v_mfma_f32_16x16x32_bf16 v[40:43], v[20:23], v[208:211], v[40:43]
    v_rcp_f32 v70, v70
    v_mfma_f32_16x16x32_bf16 v[44:47], v[20:23], v[212:215], v[44:47]
    ds_read_b128 v[16:19], v7 offset:8192
    s_waitcnt lgkmcnt(3)
    v_mfma_f32_16x16x32_bf16 v[32:35], v[24:27], v[216:219], v[32:35]
    v_rcp_f32 v71, v71
    v_mfma_f32_16x16x32_bf16 v[36:39], v[24:27], v[220:223], v[36:39]
    ds_read_b128 v[20:23], v7 offset:9216
    s_add_u32 s52, s52, 4096
    buffer_load_dwordx4 v[168:171], v2, s[28:31], s52 offen offset:0 sc1
    v_mfma_f32_16x16x32_bf16 v[40:43], v[28:31], v[216:219], v[40:43]
    v_mul_f32 v76, v76, v68
    v_mul_f32 v77, v77, v69
    v_mfma_f32_16x16x32_bf16 v[44:47], v[28:31], v[220:223], v[44:47]
    ds_read_b128 v[24:27], v7 offset:10240
    v_mul_f32 v78, v78, v70
    v_mfma_f32_16x16x32_bf16 v[32:35], v[92:95], v[224:227], v[32:35]
    v_mul_f32 v79, v79, v71
    v_cvt_pk_bf16_f32 v66, v76, v77
    v_mfma_f32_16x16x32_bf16 v[36:39], v[92:95], v[228:231], v[36:39]
    ds_read_b128 v[28:31], v7 offset:11264
    buffer_load_dwordx4 v[172:175], v2, s[28:31], s52 offen offset:2048 sc1
    s_waitcnt lgkmcnt(3)
    v_mfma_f32_16x16x32_bf16 v[40:43], v[8:11], v[224:227], v[40:43]
    v_cvt_pk_bf16_f32 v67, v78, v79
    v_permlane16_swap_b32 v64, v66
    v_mfma_f32_16x16x32_bf16 v[44:47], v[8:11], v[228:231], v[44:47]
    ds_read_b128 v[92:95], v7 offset:12288
    v_mfma_f32_16x16x32_bf16 v[32:35], v[12:15], v[232:235], v[32:35]
    v_permlane16_swap_b32 v65, v67
    v_mfma_f32_16x16x32_bf16 v[36:39], v[12:15], v[236:239], v[36:39]
    s_add_u32 s52, s52, 4096
    buffer_load_dwordx4 v[176:179], v2, s[28:31], s52 offen offset:0 sc1
    v_mfma_f32_16x16x32_bf16 v[40:43], v[16:19], v[232:235], v[40:43]
    buffer_store_dwordx4 v[64:67], v3, s[28:31], s46 offen sc1
    s_add_u32 s46, s46, 16384
    v_mfma_f32_16x16x32_bf16 v[44:47], v[16:19], v[236:239], v[44:47]
    s_waitcnt lgkmcnt(1)
    v_mfma_f32_16x16x32_bf16 v[32:35], v[20:23], v[240:243], v[32:35]
    v_mfma_f32_16x16x32_bf16 v[36:39], v[20:23], v[244:247], v[36:39]
    buffer_load_dwordx4 v[180:183], v2, s[28:31], s52 offen offset:2048 sc1
    v_mfma_f32_16x16x32_bf16 v[40:43], v[24:27], v[240:243], v[40:43]
    v_mfma_f32_16x16x32_bf16 v[44:47], v[24:27], v[244:247], v[44:47]
    v_mfma_f32_16x16x32_bf16 v[32:35], v[28:31], v[248:251], v[32:35]
    v_mfma_f32_16x16x32_bf16 v[36:39], v[28:31], v[252:255], v[36:39]
    s_add_u32 s52, s52, 4096
    buffer_load_dwordx4 v[184:187], v2, s[28:31], s52 offen offset:0 sc1
    s_waitcnt lgkmcnt(0)
    v_mfma_f32_16x16x32_bf16 v[40:43], v[92:95], v[248:251], v[40:43]
    v_mfma_f32_16x16x32_bf16 v[44:47], v[92:95], v[252:255], v[44:47]
    s_barrier
    s_nop 5
    v_mul_f32 v40, v32, v40
    v_mul_f32 v41, v33, v41
    v_mul_f32 v42, v34, v42
    v_mul_f32 v43, v35, v43
    v_mul_f32 v32, v4, v32
    v_mul_f32 v33, v4, v33
    v_mul_f32 v34, v4, v34
    v_mul_f32 v35, v4, v35
    buffer_load_dwordx4 v[188:191], v2, s[28:31], s52 offen offset:2048 sc1
    v_exp_f32 v32, v32
    v_exp_f32 v33, v33
    v_exp_f32 v34, v34
    v_exp_f32 v35, v35
    v_fma_f32 v32, v32, v5, v5
    v_fma_f32 v33, v33, v5, v5
    v_fma_f32 v34, v34, v5, v5
    v_fma_f32 v35, v35, v5, v5
    v_rcp_f32 v32, v32
    v_rcp_f32 v33, v33
    v_rcp_f32 v34, v34
    v_rcp_f32 v35, v35
    v_mul_f32 v40, v40, v32
    v_mul_f32 v41, v41, v33
    v_mul_f32 v42, v42, v34
    v_mul_f32 v43, v43, v35
    v_cvt_pk_bf16_f32 v32, v40, v41
    v_cvt_pk_bf16_f32 v33, v42, v43
    v_mul_f32 v44, v36, v44
    v_mul_f32 v45, v37, v45
    v_mul_f32 v46, v38, v46
    v_mul_f32 v47, v39, v47
    v_mul_f32 v36, v80, v36
    v_mul_f32 v37, v80, v37
    v_mul_f32 v38, v80, v38
    v_mul_f32 v39, v80, v39
    v_exp_f32 v36, v36
    v_exp_f32 v37, v37
    v_exp_f32 v38, v38
    v_exp_f32 v39, v39
    v_fma_f32 v36, v36, v81, v81
    v_fma_f32 v37, v37, v81, v81
    v_fma_f32 v38, v38, v81, v81
    v_fma_f32 v39, v39, v81, v81
    v_rcp_f32 v36, v36
    v_rcp_f32 v37, v37
    v_rcp_f32 v38, v38
    v_rcp_f32 v39, v39
    v_mul_f32 v44, v44, v36
    v_mul_f32 v45, v45, v37
    v_mul_f32 v46, v46, v38
    v_mul_f32 v47, v47, v39
    v_cvt_pk_bf16_f32 v34, v44, v45
    v_cvt_pk_bf16_f32 v35, v46, v47
    s_nop 0
    v_permlane16_swap_b32 v32, v34
    v_permlane16_swap_b32 v33, v35
    buffer_store_dwordx4 v[32:35], v3, s[28:31], s46 offen sc1
    s_add_u32 s46, s46, 16384
    ds_read_b128 v[48:51], v3 offset:17408
    ds_read_b128 v[52:55], v3 offset:18432
    ds_read_b128 v[56:59], v3 offset:19456
    ds_read_b128 v[60:63], v3 offset:20480
    ds_read_b128 v[64:67], v3 offset:21504
    ds_read_b128 v[68:71], v3 offset:22528
    ds_read_b128 v[72:75], v3 offset:23552
    ds_read_b128 v[76:79], v3 offset:24576
    ds_read_b128 v[80:83], v3 offset:25600
    ds_read_b128 v[84:87], v3 offset:26624
    s_waitcnt lgkmcnt(5)
    s_waitcnt vmcnt(17)
    v_mfma_f32_16x16x32_bf16 v[8:11], v[48:51], v[128:131], 0
    ds_read_b128 v[88:91], v3 offset:27648
    v_mfma_f32_16x16x32_bf16 v[12:15], v[52:55], v[128:131], 0
    ds_read_b128 v[92:95], v3 offset:28672
    v_mfma_f32_16x16x32_bf16 v[16:19], v[56:59], v[128:131], 0
    ds_read_b128 v[96:99], v3 offset:29696
    v_mfma_f32_16x16x32_bf16 v[20:23], v[60:63], v[128:131], 0
    ds_read_b128 v[100:103], v3 offset:30720
    v_mfma_f32_16x16x32_bf16 v[24:27], v[64:67], v[128:131], 0
    ds_read_b128 v[104:107], v3 offset:31744
    s_waitcnt lgkmcnt(5)
    s_waitcnt vmcnt(16)
    v_mfma_f32_16x16x32_bf16 v[8:11], v[68:71], v[132:135], v[8:11]
    ds_read_b128 v[48:51], v3 offset:32768
    v_mfma_f32_16x16x32_bf16 v[12:15], v[72:75], v[132:135], v[12:15]
    ds_read_b128 v[52:55], v3 offset:33792
    v_mfma_f32_16x16x32_bf16 v[16:19], v[76:79], v[132:135], v[16:19]
    ds_read_b128 v[56:59], v3 offset:34816
    v_mfma_f32_16x16x32_bf16 v[20:23], v[80:83], v[132:135], v[20:23]
    ds_read_b128 v[60:63], v3 offset:35840
    v_mfma_f32_16x16x32_bf16 v[24:27], v[84:87], v[132:135], v[24:27]
    ds_read_b128 v[64:67], v3 offset:36864
    s_waitcnt lgkmcnt(5)
    s_waitcnt lgkmcnt(0)
    s_barrier
    s_waitcnt vmcnt(15)
    v_mfma_f32_16x16x32_bf16 v[8:11], v[88:91], v[136:139], v[8:11]
    ds_read_b128 v[68:71], v3 offset:37888
    v_mfma_f32_16x16x32_bf16 v[12:15], v[92:95], v[136:139], v[12:15]
    ds_read_b128 v[72:75], v3 offset:38912
    s_add_u32 s52, s52, 4096
    buffer_load_dwordx4 v[192:195], v2, s[28:31], s52 offen offset:0 sc1
    v_mfma_f32_16x16x32_bf16 v[16:19], v[96:99], v[136:139], v[16:19]
    ds_read_b128 v[76:79], v3 offset:39936
    v_mfma_f32_16x16x32_bf16 v[20:23], v[100:103], v[136:139], v[20:23]
    ds_read_b128 v[80:83], v3 offset:40960
    buffer_load_dwordx4 v[196:199], v2, s[28:31], s52 offen offset:2048 sc1
    v_mfma_f32_16x16x32_bf16 v[24:27], v[104:107], v[136:139], v[24:27]
    ds_read_b128 v[84:87], v3 offset:41984
    s_waitcnt vmcnt(16)
    v_mfma_f32_16x16x32_bf16 v[8:11], v[48:51], v[140:143], v[8:11]
    ds_read_b128 v[88:91], v3 offset:43008
    v_mfma_f32_16x16x32_bf16 v[12:15], v[52:55], v[140:143], v[12:15]
    ds_read_b128 v[92:95], v3 offset:44032
    s_add_u32 s52, s52, 4096
    buffer_load_dwordx4 v[200:203], v2, s[28:31], s52 offen offset:0 sc1
    v_mfma_f32_16x16x32_bf16 v[16:19], v[56:59], v[140:143], v[16:19]
    ds_read_b128 v[96:99], v3 offset:45056
    v_mfma_f32_16x16x32_bf16 v[20:23], v[60:63], v[140:143], v[20:23]
    ds_read_b128 v[100:103], v3 offset:46080
    buffer_load_dwordx4 v[204:207], v2, s[28:31], s52 offen offset:2048 sc1
    v_mfma_f32_16x16x32_bf16 v[24:27], v[64:67], v[140:143], v[24:27]
    ds_read_b128 v[104:107], v3 offset:47104
    s_waitcnt lgkmcnt(5)
    s_waitcnt vmcnt(17)
    v_mfma_f32_16x16x32_bf16 v[8:11], v[68:71], v[144:147], v[8:11]
    ds_read_b128 v[48:51], v3 offset:48128
    v_mfma_f32_16x16x32_bf16 v[12:15], v[72:75], v[144:147], v[12:15]
    ds_read_b128 v[52:55], v3 offset:49152
    v_mfma_f32_16x16x32_bf16 v[16:19], v[76:79], v[144:147], v[16:19]
    ds_read_b128 v[56:59], v3 offset:50176
    v_mfma_f32_16x16x32_bf16 v[20:23], v[80:83], v[144:147], v[20:23]
    ds_read_b128 v[60:63], v3 offset:51200
    v_mfma_f32_16x16x32_bf16 v[24:27], v[84:87], v[144:147], v[24:27]
    ds_read_b128 v[64:67], v3 offset:52224
    s_waitcnt lgkmcnt(5)
    s_waitcnt vmcnt(16)
    v_mfma_f32_16x16x32_bf16 v[8:11], v[88:91], v[148:151], v[8:11]
    ds_read_b128 v[68:71], v3 offset:53248
    v_mfma_f32_16x16x32_bf16 v[12:15], v[92:95], v[148:151], v[12:15]
    ds_read_b128 v[72:75], v3 offset:54272
    s_nop 0
hop_pad_14:
    s_cbranch_execz hop_back
    s_add_u32 s52, s52, 4096
    buffer_load_dwordx4 v[208:211], v2, s[28:31], s52 offen offset:0 sc1
    v_mfma_f32_16x16x32_bf16 v[16:19], v[96:99], v[148:151], v[16:19]
    ds_read_b128 v[76:79], v3 offset:55296
    v_mfma_f32_16x16x32_bf16 v[20:23], v[100:103], v[148:151], v[20:23]
    ds_read_b128 v[80:83], v3 offset:56320
    v_mfma_f32_16x16x32_bf16 v[24:27], v[104:107], v[148:151], v[24:27]
    ds_read_b128 v[84:87], v3 offset:57344
    s_waitcnt lgkmcnt(5)
    s_waitcnt lgkmcnt(0)
    s_waitcnt vmcnt(5)
    s_barrier
    v_mfma_f32_16x16x32_bf16 v[8:11], v[48:51], v[152:155], v[8:11]
    ds_read_b128 v[88:91], v7 offset:13312
    v_mfma_f32_16x16x32_bf16 v[12:15], v[52:55], v[152:155], v[12:15]
    ds_read_b128 v[92:95], v7 offset:14336
    buffer_load_dwordx4 v[212:215], v2, s[28:31], s52 offen offset:2048 sc1
    v_mfma_f32_16x16x32_bf16 v[16:19], v[56:59], v[152:155], v[16:19]
    ds_read_b128 v[96:99], v7 offset:15360
    v_mfma_f32_16x16x32_bf16 v[20:23], v[60:63], v[152:155], v[20:23]
    ds_read_b128 v[100:103], v7 offset:16384
    v_mfma_f32_16x16x32_bf16 v[24:27], v[64:67], v[152:155], v[24:27]
    ds_read_b128 v[104:107], v7 offset:17408
    v_mfma_f32_16x16x32_bf16 v[8:11], v[68:71], v[156:159], v[8:11]
    ds_read_b128 v[48:51], v7 offset:18432
    v_mfma_f32_16x16x32_bf16 v[12:15], v[72:75], v[156:159], v[12:15]
    ds_read_b128 v[52:55], v7 offset:19456
    s_add_u32 s52, s52, 4096
    buffer_load_dwordx4 v[216:219], v2, s[28:31], s52 offen offset:0 sc1
    v_mfma_f32_16x16x32_bf16 v[16:19], v[76:79], v[156:159], v[16:19]
    ds_read_b128 v[56:59], v7 offset:20480
    v_mfma_f32_16x16x32_bf16 v[20:23], v[80:83], v[156:159], v[20:23]
    ds_read_b128 v[60:63], v7 offset:21504
    v_mfma_f32_16x16x32_bf16 v[24:27], v[84:87], v[156:159], v[24:27]
    ds_read_b128 v[64:67], v7 offset:22528
    s_waitcnt lgkmcnt(5)
    v_mfma_f32_16x16x32_bf16 v[8:11], v[88:91], v[160:163], v[8:11]
    ds_read_b128 v[68:71], v7 offset:23552
    v_mfma_f32_16x16x32_bf16 v[12:15], v[92:95], v[160:163], v[12:15]
    ds_read_b128 v[72:75], v7 offset:24576
    buffer_load_dwordx4 v[220:223], v2, s[28:31], s52 offen offset:2048 sc1
    v_mfma_f32_16x16x32_bf16 v[16:19], v[96:99], v[160:163], v[16:19]
    ds_read_b128 v[76:79], v7 offset:25600
    v_mfma_f32_16x16x32_bf16 v[20:23], v[100:103], v[160:163], v[20:23]
    ds_read_b128 v[80:83], v7 offset:26624
    v_mfma_f32_16x16x32_bf16 v[24:27], v[104:107], v[160:163], v[24:27]
    ds_read_b128 v[84:87], v7 offset:27648
    s_waitcnt lgkmcnt(5)
    s_mov_b32 s32, s22
    s_and_b32 s33, s23, 0xffff
    s_mov_b32 s34, 0x280000
    s_mov_b32 s35, 0x20000
    v_and_b32 v4, 15, v0
    v_lshrrev_b32 v5, 4, v0
    v_mul_u32_u24 v4, 1280, v4
    v_and_b32 v40, 1, v5
    v_lshl_add_u32 v40, v40, 5, v4
    v_lshrrev_b32 v41, 1, v5
    v_lshl_add_u32 v40, v41, 4, v40
    v_lshl_add_u32 v4, v5, 3, v4
    v_lshlrev_b32 v5, 4, v5
    s_lshl_b32 s44, s62, 6
    s_lshl_b32 s45, s3, 4
    s_add_u32 s44, s44, s45
    s_mul_i32 s46, s44, 1280
    s_mul_i32 s45, s63, 160
    s_add_u32 s46, s46, s45
    s_mul_i32 s47, s3, 2560
    v_lshlrev_b32 v6, 3, v0
    v_add_u32 v6, s47, v6
    s_mul_i32 s48, s63, 320
    s_add_u32 s48, s48, 105984
    ds_read_b64 v[28:29], v6 offset:0
    ds_read_b64 v[30:31], v6 offset:512
    ds_read_b64 v[32:33], v6 offset:1024
    ds_read_b64 v[34:35], v6 offset:1536
    ds_read_b64 v[36:37], v6 offset:2048
    v_mfma_f32_16x16x32_bf16 v[8:11], v[48:51], v[164:167], v[8:11]
    ds_read_b128 v[88:91], v7 offset:28672
    v_mfma_f32_16x16x32_bf16 v[12:15], v[52:55], v[164:167], v[12:15]
    ds_read_b128 v[92:95], v7 offset:29696
    v_mfma_f32_16x16x32_bf16 v[16:19], v[56:59], v[164:167], v[16:19]
    ds_read_b128 v[96:99], v7 offset:30720
    v_mfma_f32_16x16x32_bf16 v[20:23], v[60:63], v[164:167], v[20:23]
    ds_read_b128 v[100:103], v7 offset:31744
    v_mfma_f32_16x16x32_bf16 v[24:27], v[64:67], v[164:167], v[24:27]
    ds_read_b128 v[104:107], v7 offset:32768
    s_waitcnt lgkmcnt(10)
    s_waitcnt lgkmcnt(0)
    s_barrier
    v_mfma_f32_16x16x32_bf16 v[8:11], v[68:71], v[168:171], v[8:11]
    ds_read_b128 v[48:51], v7 offset:33792
    v_mfma_f32_16x16x32_bf16 v[12:15], v[72:75], v[168:171], v[12:15]
    ds_read_b128 v[52:55], v7 offset:34816
    s_add_u32 s52, s52, 4096
    buffer_load_dwordx4 v[224:227], v2, s[28:31], s52 offen offset:0 sc1
    v_mfma_f32_16x16x32_bf16 v[16:19], v[76:79], v[168:171], v[16:19]
    ds_read_b128 v[56:59], v7 offset:35840
    v_mfma_f32_16x16x32_bf16 v[20:23], v[80:83], v[168:171], v[20:23]
    ds_read_b128 v[60:63], v7 offset:36864
    v_mfma_f32_16x16x32_bf16 v[24:27], v[84:87], v[168:171], v[24:27]
    ds_read_b128 v[64:67], v7 offset:37888
    v_mfma_f32_16x16x32_bf16 v[8:11], v[88:91], v[172:175], v[8:11]
    ds_read_b128 v[68:71], v7 offset:38912
    v_mfma_f32_16x16x32_bf16 v[12:15], v[92:95], v[172:175], v[12:15]
    ds_read_b128 v[72:75], v7 offset:39936
    buffer_load_dwordx4 v[228:231], v2, s[28:31], s52 offen offset:2048 sc1
    v_mfma_f32_16x16x32_bf16 v[16:19], v[96:99], v[172:175], v[16:19]
    ds_read_b128 v[76:79], v7 offset:40960
    v_mfma_f32_16x16x32_bf16 v[20:23], v[100:103], v[172:175], v[20:23]
    ds_read_b128 v[80:83], v7 offset:41984
    v_mfma_f32_16x16x32_bf16 v[24:27], v[104:107], v[172:175], v[24:27]
    ds_read_b128 v[84:87], v7 offset:43008
    s_waitcnt lgkmcnt(5)
    buffer_load_dwordx4 v[108:111], v5, s[28:31], s48 offen offset:0 sc1
    buffer_load_dwordx4 v[112:115], v5, s[28:31], s48 offen offset:64 sc1
    buffer_load_dwordx4 v[116:119], v5, s[28:31], s48 offen offset:128 sc1
    buffer_load_dwordx4 v[120:123], v5, s[28:31], s48 offen offset:192 sc1
    buffer_load_dwordx4 v[124:127], v5, s[28:31], s48 offen offset:256 sc1
    v_mfma_f32_16x16x32_bf16 v[8:11], v[48:51], v[176:179], v[8:11]
    ds_read_b128 v[88:91], v7 offset:44032
    v_mfma_f32_16x16x32_bf16 v[12:15], v[52:55], v[176:179], v[12:15]
    ds_read_b128 v[92:95], v7 offset:45056
    s_add_u32 s52, s52, 4096
    buffer_load_dwordx4 v[232:235], v2, s[28:31], s52 offen offset:0 sc1
    v_mfma_f32_16x16x32_bf16 v[16:19], v[56:59], v[176:179], v[16:19]
    ds_read_b128 v[96:99], v7 offset:46080
    v_mfma_f32_16x16x32_bf16 v[20:23], v[60:63], v[176:179], v[20:23]
    ds_read_b128 v[100:103], v7 offset:47104
    v_mfma_f32_16x16x32_bf16 v[24:27], v[64:67], v[176:179], v[24:27]
    ds_read_b128 v[104:107], v7 offset:48128
    s_waitcnt lgkmcnt(5)
    v_mfma_f32_16x16x32_bf16 v[8:11], v[68:71], v[180:183], v[8:11]
    ds_read_b128 v[48:51], v7 offset:49152
    v_mfma_f32_16x16x32_bf16 v[12:15], v[72:75], v[180:183], v[12:15]
    ds_read_b128 v[52:55], v7 offset:50176
    buffer_load_dwordx4 v[236:239], v2, s[28:31], s52 offen offset:2048 sc1
    v_mfma_f32_16x16x32_bf16 v[16:19], v[76:79], v[180:183], v[16:19]
    ds_read_b128 v[56:59], v7 offset:51200
    v_mfma_f32_16x16x32_bf16 v[20:23], v[80:83], v[180:183], v[20:23]
    ds_read_b128 v[60:63], v7 offset:52224
    v_mfma_f32_16x16x32_bf16 v[24:27], v[84:87], v[180:183], v[24:27]
    ds_read_b128 v[64:67], v7 offset:53248
    s_waitcnt lgkmcnt(5)
    s_waitcnt lgkmcnt(0)
    s_barrier
    v_mfma_f32_16x16x32_bf16 v[8:11], v[88:91], v[184:187], v[8:11]
    ds_read_b128 v[68:71], v7 offset:54272
    v_mfma_f32_16x16x32_bf16 v[12:15], v[92:95], v[184:187], v[12:15]
    ds_read_b128 v[72:75], v7 offset:55296
    v_mfma_f32_16x16x32_bf16 v[16:19], v[96:99], v[184:187], v[16:19]
    ds_read_b128 v[76:79], v7 offset:56320
    v_mfma_f32_16x16x32_bf16 v[20:23], v[100:103], v[184:187], v[20:23]
    ds_read_b128 v[80:83], v7 offset:57344
    v_mfma_f32_16x16x32_bf16 v[24:27], v[104:107], v[184:187], v[24:27]
    ds_read_b128 v[84:87], v7 offset:58368
    v_mfma_f32_16x16x32_bf16 v[8:11], v[48:51], v[188:191], v[8:11]
    ds_read_b128 v[88:91], v7 offset:59392
    v_mfma_f32_16x16x32_bf16 v[12:15], v[52:55], v[188:191], v[12:15]
    ds_read_b128 v[92:95], v7 offset:60416
    s_add_u32 s52, s52, 4096
    buffer_load_dwordx4 v[240:243], v2, s[28:31], s52 offen offset:0 sc1
    v_mfma_f32_16x16x32_bf16 v[16:19], v[56:59], v[188:191], v[16:19]
    ds_read_b128 v[96:99], v7 offset:61440
    v_mfma_f32_16x16x32_bf16 v[20:23], v[60:63], v[188:191], v[20:23]
    ds_read_b128 v[100:103], v7 offset:62464
    v_mfma_f32_16x16x32_bf16 v[24:27], v[64:67], v[188:191], v[24:27]
    ds_read_b128 v[104:107], v7 offset:63488
    s_waitcnt lgkmcnt(5)
    s_waitcnt vmcnt(17)
    v_mfma_f32_16x16x32_bf16 v[8:11], v[68:71], v[192:195], v[8:11]
    ds_read_b128 v[48:51], v7 offset:64512
    v_mfma_f32_16x16x32_bf16 v[12:15], v[72:75], v[192:195], v[12:15]
    ds_read_b128 v[52:55], v1 offset:0
    buffer_load_dwordx4 v[244:247], v2, s[28:31], s52 offen offset:2048 sc1
    v_mfma_f32_16x16x32_bf16 v[16:19], v[76:79], v[192:195], v[16:19]
    ds_read_b128 v[56:59], v1 offset:1024
    v_mfma_f32_16x16x32_bf16 v[20:23], v[80:83], v[192:195], v[20:23]
    ds_read_b128 v[60:63], v1 offset:2048
    v_mfma_f32_16x16x32_bf16 v[24:27], v[84:87], v[192:195], v[24:27]
    ds_read_b128 v[64:67], v1 offset:3072
    s_waitcnt lgkmcnt(5)
    s_waitcnt vmcnt(17)
    v_mfma_f32_16x16x32_bf16 v[8:11], v[88:91], v[196:199], v[8:11]
    ds_read_b128 v[68:71], v1 offset:4096
    v_mfma_f32_16x16x32_bf16 v[12:15], v[92:95], v[196:199], v[12:15]
    ds_read_b128 v[72:75], v1 offset:5120
    s_add_u32 s52, s52, 4096
    buffer_load_dwordx4 v[248:251], v2, s[28:31], s52 offen offset:0 sc1
    v_mfma_f32_16x16x32_bf16 v[16:19], v[96:99], v[196:199], v[16:19]
    ds_read_b128 v[76:79], v1 offset:6144
    v_mfma_f32_16x16x32_bf16 v[20:23], v[100:103], v[196:199], v[20:23]
    ds_read_b128 v[80:83], v1 offset:7168
    v_mfma_f32_16x16x32_bf16 v[24:27], v[104:107], v[196:199], v[24:27]
    ds_read_b128 v[84:87], v1 offset:8192
    s_waitcnt lgkmcnt(5)
    s_waitcnt lgkmcnt(0)
    s_barrier
    s_waitcnt vmcnt(17)
    v_mfma_f32_16x16x32_bf16 v[8:11], v[48:51], v[200:203], v[8:11]
    ds_read_b128 v[88:91], v1 offset:9216
    v_mfma_f32_16x16x32_bf16 v[12:15], v[52:55], v[200:203], v[12:15]
    ds_read_b128 v[92:95], v1 offset:10240
    buffer_load_dwordx4 v[252:255], v2, s[28:31], s52 offen offset:2048 sc1
    v_mfma_f32_16x16x32_bf16 v[16:19], v[56:59], v[200:203], v[16:19]
    ds_read_b128 v[96:99], v1 offset:11264
    v_mfma_f32_16x16x32_bf16 v[20:23], v[60:63], v[200:203], v[20:23]
    ds_read_b128 v[100:103], v1 offset:12288
    v_mfma_f32_16x16x32_bf16 v[24:27], v[64:67], v[200:203], v[24:27]
    ds_read_b128 v[104:107], v1 offset:13312
    s_waitcnt vmcnt(17)
    v_mfma_f32_16x16x32_bf16 v[8:11], v[68:71], v[204:207], v[8:11]
    ds_read_b128 v[48:51], v1 offset:14336
    v_mfma_f32_16x16x32_bf16 v[12:15], v[72:75], v[204:207], v[12:15]
    ds_read_b128 v[52:55], v1 offset:15360
    v_mfma_f32_16x16x32_bf16 v[16:19], v[76:79], v[204:207], v[16:19]
    ds_read_b128 v[56:59], v1 offset:16384
    v_mfma_f32_16x16x32_bf16 v[20:23], v[80:83], v[204:207], v[20:23]
    ds_read_b128 v[60:63], v1 offset:17408
    v_mfma_f32_16x16x32_bf16 v[24:27], v[84:87], v[204:207], v[24:27]
    ds_read_b128 v[64:67], v1 offset:18432
    s_waitcnt lgkmcnt(5)
    s_waitcnt vmcnt(16)
    v_mfma_f32_16x16x32_bf16 v[8:11], v[88:91], v[208:211], v[8:11]
    ds_read_b128 v[68:71], v1 offset:19456
    v_mfma_f32_16x16x32_bf16 v[12:15], v[92:95], v[208:211], v[12:15]
    ds_read_b128 v[72:75], v1 offset:20480
    s_add_u32 s52, s52, 4096
    buffer_load_dwordx4 v[128:131], v2, s[28:31], s52 offen offset:0 sc1
    v_mfma_f32_16x16x32_bf16 v[16:19], v[96:99], v[208:211], v[16:19]
    ds_read_b128 v[76:79], v1 offset:21504
    v_mfma_f32_16x16x32_bf16 v[20:23], v[100:103], v[208:211], v[20:23]
    ds_read_b128 v[80:83], v1 offset:22528
    v_mfma_f32_16x16x32_bf16 v[24:27], v[104:107], v[208:211], v[24:27]
    ds_read_b128 v[84:87], v1 offset:23552
    s_waitcnt lgkmcnt(5)
    s_waitcnt vmcnt(16)
    v_mfma_f32_16x16x32_bf16 v[8:11], v[48:51], v[212:215], v[8:11]
    ds_read_b128 v[88:91], v1 offset:24576
    v_mfma_f32_16x16x32_bf16 v[12:15], v[52:55], v[212:215], v[12:15]
    ds_read_b128 v[92:95], v1 offset:25600
    buffer_load_dwordx4 v[132:135], v2, s[28:31], s52 offen offset:2048 sc1
    v_mfma_f32_16x16x32_bf16 v[16:19], v[56:59], v[212:215], v[16:19]
    ds_read_b128 v[96:99], v1 offset:26624
    v_mfma_f32_16x16x32_bf16 v[20:23], v[60:63], v[212:215], v[20:23]
    ds_read_b128 v[100:103], v1 offset:27648
    v_mfma_f32_16x16x32_bf16 v[24:27], v[64:67], v[212:215], v[24:27]
    ds_read_b128 v[104:107], v1 offset:28672
    s_waitcnt lgkmcnt(5)
    s_waitcnt lgkmcnt(0)
    s_barrier
    s_waitcnt vmcnt(16)
    v_mfma_f32_16x16x32_bf16 v[8:11], v[68:71], v[216:219], v[8:11]
    ds_read_b128 v[48:51], v3 offset:58368
    v_mfma_f32_16x16x32_bf16 v[12:15], v[72:75], v[216:219], v[12:15]
    ds_read_b128 v[52:55], v3 offset:59392
    s_add_u32 s52, s52, 4096
    buffer_load_dwordx4 v[136:139], v2, s[28:31], s52 offen offset:0 sc1
    v_mfma_f32_16x16x32_bf16 v[16:19], v[76:79], v[216:219], v[16:19]
    ds_read_b128 v[56:59], v3 offset:60416
    v_mfma_f32_16x16x32_bf16 v[20:23], v[80:83], v[216:219], v[20:23]
    ds_read_b128 v[60:63], v3 offset:61440
    v_mfma_f32_16x16x32_bf16 v[24:27], v[84:87], v[216:219], v[24:27]
    ds_read_b128 v[64:67], v3 offset:62464
    s_waitcnt vmcnt(16)
    v_mfma_f32_16x16x32_bf16 v[8:11], v[88:91], v[220:223], v[8:11]
    ds_read_b128 v[68:71], v3 offset:63488
    v_mfma_f32_16x16x32_bf16 v[12:15], v[92:95], v[220:223], v[12:15]
    ds_read_b128 v[72:75], v3 offset:64512
    v_mfma_f32_16x16x32_bf16 v[16:19], v[96:99], v[220:223], v[16:19]
    ds_read_b128 v[76:79], v7 offset:0
    v_mfma_f32_16x16x32_bf16 v[20:23], v[100:103], v[220:223], v[20:23]
    ds_read_b128 v[80:83], v7 offset:1024
    v_mfma_f32_16x16x32_bf16 v[24:27], v[104:107], v[220:223], v[24:27]
    ds_read_b128 v[84:87], v7 offset:2048
    s_waitcnt lgkmcnt(5)
    s_waitcnt vmcnt(15)
    v_mfma_f32_16x16x32_bf16 v[8:11], v[48:51], v[224:227], v[8:11]
    ds_read_b128 v[88:91], v7 offset:3072
    v_mfma_f32_16x16x32_bf16 v[12:15], v[52:55], v[224:227], v[12:15]
    ds_read_b128 v[92:95], v7 offset:4096
    buffer_load_dwordx4 v[140:143], v2, s[28:31], s52 offen offset:2048 sc1
    v_mfma_f32_16x16x32_bf16 v[16:19], v[56:59], v[224:227], v[16:19]
    ds_read_b128 v[96:99], v7 offset:5120
    v_mfma_f32_16x16x32_bf16 v[20:23], v[60:63], v[224:227], v[20:23]
    ds_read_b128 v[100:103], v7 offset:6144
    v_mfma_f32_16x16x32_bf16 v[24:27], v[64:67], v[224:227], v[24:27]
    ds_read_b128 v[104:107], v7 offset:7168
    s_waitcnt lgkmcnt(5)
    s_waitcnt vmcnt(15)
    v_mfma_f32_16x16x32_bf16 v[8:11], v[68:71], v[228:231], v[8:11]
    ds_read_b128 v[48:51], v7 offset:8192
    v_mfma_f32_16x16x32_bf16 v[12:15], v[72:75], v[228:231], v[12:15]
    ds_read_b128 v[52:55], v7 offset:9216
    s_add_u32 s52, s52, 4096
    buffer_load_dwordx4 v[144:147], v2, s[28:31], s52 offen offset:0 sc1
    v_mfma_f32_16x16x32_bf16 v[16:19], v[76:79], v[228:231], v[16:19]
    ds_read_b128 v[56:59], v7 offset:10240
    v_mfma_f32_16x16x32_bf16 v[20:23], v[80:83], v[228:231], v[20:23]
    ds_read_b128 v[60:63], v7 offset:11264
    v_mfma_f32_16x16x32_bf16 v[24:27], v[84:87], v[228:231], v[24:27]
    ds_read_b128 v[64:67], v7 offset:12288
    s_waitcnt lgkmcnt(5)
    s_waitcnt lgkmcnt(0)
    s_barrier
    s_waitcnt vmcnt(10)
    v_mfma_f32_16x16x32_bf16 v[8:11], v[88:91], v[232:235], v[8:11]
    ds_read_b128 v[68:71], v3 offset:17408
    v_mfma_f32_16x16x32_bf16 v[12:15], v[92:95], v[232:235], v[12:15]
    ds_read_b128 v[72:75], v3 offset:18432
    buffer_load_dwordx4 v[148:151], v2, s[28:31], s52 offen offset:2048 sc1
    v_mfma_f32_16x16x32_bf16 v[16:19], v[96:99], v[232:235], v[16:19]
    ds_read_b128 v[76:79], v3 offset:19456
    v_mfma_f32_16x16x32_bf16 v[20:23], v[100:103], v[232:235], v[20:23]
    ds_read_b128 v[80:83], v3 offset:20480
    v_mfma_f32_16x16x32_bf16 v[24:27], v[104:107], v[232:235], v[24:27]
    ds_read_b128 v[84:87], v3 offset:21504
    s_waitcnt vmcnt(10)
    v_mfma_f32_16x16x32_bf16 v[8:11], v[48:51], v[236:239], v[8:11]
    ds_read_b128 v[88:91], v3 offset:22528
    v_mfma_f32_16x16x32_bf16 v[12:15], v[52:55], v[236:239], v[12:15]
    ds_read_b128 v[92:95], v3 offset:23552
    s_add_u32 s52, s52, 4096
    buffer_load_dwordx4 v[152:155], v2, s[28:31], s52 offen offset:0 sc1
    v_mfma_f32_16x16x32_bf16 v[16:19], v[56:59], v[236:239], v[16:19]
    ds_read_b128 v[96:99], v3 offset:24576
    v_mfma_f32_16x16x32_bf16 v[20:23], v[60:63], v[236:239], v[20:23]
    ds_read_b128 v[100:103], v3 offset:25600
    v_mfma_f32_16x16x32_bf16 v[24:27], v[64:67], v[236:239], v[24:27]
    ds_read_b128 v[104:107], v3 offset:26624
    s_waitcnt lgkmcnt(5)
    s_waitcnt vmcnt(10)
    v_mfma_f32_16x16x32_bf16 v[8:11], v[68:71], v[240:243], v[8:11]
    ds_read_b128 v[48:51], v3 offset:27648
    v_mfma_f32_16x16x32_bf16 v[12:15], v[72:75], v[240:243], v[12:15]
    ds_read_b128 v[52:55], v3 offset:28672
    v_mfma_f32_16x16x32_bf16 v[16:19], v[76:79], v[240:243], v[16:19]
    ds_read_b128 v[56:59], v3 offset:29696
    v_mfma_f32_16x16x32_bf16 v[20:23], v[80:83], v[240:243], v[20:23]
    ds_read_b128 v[60:63], v3 offset:30720
    v_mfma_f32_16x16x32_bf16 v[24:27], v[84:87], v[240:243], v[24:27]
    ds_read_b128 v[64:67], v3 offset:31744
    s_waitcnt lgkmcnt(5)
    s_waitcnt vmcnt(9)
    v_mfma_f32_16x16x32_bf16 v[8:11], v[88:91], v[244:247], v[8:11]
    ds_read_b128 v[68:71], v3 offset:32768
    v_mfma_f32_16x16x32_bf16 v[12:15], v[92:95], v[244:247], v[12:15]
    ds_read_b128 v[72:75], v3 offset:33792
    buffer_load_dwordx4 v[156:159], v2, s[28:31], s52 offen offset:2048 sc1
    v_mfma_f32_16x16x32_bf16 v[16:19], v[96:99], v[244:247], v[16:19]
    ds_read_b128 v[76:79], v3 offset:34816
    v_mfma_f32_16x16x32_bf16 v[20:23], v[100:103], v[244:247], v[20:23]
    ds_read_b128 v[80:83], v3 offset:35840
    v_mfma_f32_16x16x32_bf16 v[24:27], v[104:107], v[244:247], v[24:27]
    ds_read_b128 v[84:87], v3 offset:36864
    s_waitcnt lgkmcnt(5)
    s_waitcnt lgkmcnt(0)
    s_barrier
    s_waitcnt vmcnt(9)
    v_mfma_f32_16x16x32_bf16 v[8:11], v[48:51], v[248:251], v[8:11]
    ds_read_b128 v[88:91], v3 offset:37888
    v_mfma_f32_16x16x32_bf16 v[12:15], v[52:55], v[248:251], v[12:15]
    ds_read_b128 v[92:95], v3 offset:38912
    s_add_u32 s52, s52, 4096
    buffer_load_dwordx4 v[160:163], v2, s[28:31], s52 offen offset:0 sc1
    v_mfma_f32_16x16x32_bf16 v[16:19], v[56:59], v[248:251], v[16:19]
    ds_read_b128 v[96:99], v3 offset:39936
    v_mfma_f32_16x16x32_bf16 v[20:23], v[60:63], v[248:251], v[20:23]
    ds_read_b128 v[100:103], v3 offset:40960
    v_mfma_f32_16x16x32_bf16 v[24:27], v[64:67], v[248:251], v[24:27]
    ds_read_b128 v[104:107], v3 offset:41984
    s_waitcnt vmcnt(9)
    v_mfma_f32_16x16x32_bf16 v[8:11], v[68:71], v[252:255], v[8:11]
    ds_read_b128 v[48:51], v3 offset:43008
    v_mfma_f32_16x16x32_bf16 v[12:15], v[72:75], v[252:255], v[12:15]
    ds_read_b128 v[52:55], v3 offset:44032
    buffer_load_dwordx4 v[164:167], v2, s[28:31], s52 offen offset:2048 sc1
    v_mfma_f32_16x16x32_bf16 v[16:19], v[76:79], v[252:255], v[16:19]
    ds_read_b128 v[56:59], v3 offset:45056
    v_mfma_f32_16x16x32_bf16 v[20:23], v[80:83], v[252:255], v[20:23]
    ds_read_b128 v[60:63], v3 offset:46080
    v_mfma_f32_16x16x32_bf16 v[24:27], v[84:87], v[252:255], v[24:27]
    ds_read_b128 v[64:67], v3 offset:47104
    s_waitcnt lgkmcnt(5)
    s_waitcnt vmcnt(9)
    v_mfma_f32_16x16x32_bf16 v[8:11], v[88:91], v[128:131], v[8:11]
    ds_read_b128 v[68:71], v3 offset:48128
    v_mfma_f32_16x16x32_bf16 v[12:15], v[92:95], v[128:131], v[12:15]
    ds_read_b128 v[72:75], v3 offset:49152
    s_add_u32 s52, s52, 4096
    buffer_load_dwordx4 v[168:171], v2, s[28:31], s52 offen offset:0 sc1
    v_mfma_f32_16x16x32_bf16 v[16:19], v[96:99], v[128:131], v[16:19]
    ds_read_b128 v[76:79], v3 offset:50176
    v_mfma_f32_16x16x32_bf16 v[20:23], v[100:103], v[128:131], v[20:23]
    ds_read_b128 v[80:83], v3 offset:51200
    v_mfma_f32_16x16x32_bf16 v[24:27], v[104:107], v[128:131], v[24:27]
    ds_read_b128 v[84:87], v3 offset:52224
    s_waitcnt lgkmcnt(5)
    s_waitcnt vmcnt(9)
    v_mfma_f32_16x16x32_bf16 v[8:11], v[48:51], v[132:135], v[8:11]
    ds_read_b128 v[88:91], v3 offset:53248
    v_mfma_f32_16x16x32_bf16 v[12:15], v[52:55], v[132:135], v[12:15]
    ds_read_b128 v[92:95], v3 offset:54272
    v_mfma_f32_16x16x32_bf16 v[16:19], v[56:59], v[132:135], v[16:19]
    ds_read_b128 v[96:99], v3 offset:55296
    v_mfma_f32_16x16x32_bf16 v[20:23], v[60:63], v[132:135], v[20:23]
    ds_read_b128 v[100:103], v3 offset:56320
    v_mfma_f32_16x16x32_bf16 v[24:27], v[64:67], v[132:135], v[24:27]
    ds_read_b128 v[104:107], v3 offset:57344
    s_waitcnt lgkmcnt(5)
    s_waitcnt lgkmcnt(0)
    s_barrier
    s_waitcnt vmcnt(8)
    v_mfma_f32_16x16x32_bf16 v[8:11], v[68:71], v[136:139], v[8:11]
    ds_read_b128 v[48:51], v7 offset:13312
    v_mfma_f32_16x16x32_bf16 v[12:15], v[72:75], v[136:139], v[12:15]
    ds_read_b128 v[52:55], v7 offset:14336
    buffer_load_dwordx4 v[172:175], v2, s[28:31], s52 offen offset:2048 sc1
    v_mfma_f32_16x16x32_bf16 v[16:19], v[76:79], v[136:139], v[16:19]
    ds_read_b128 v[56:59], v7 offset:15360
    v_mfma_f32_16x16x32_bf16 v[20:23], v[80:83], v[136:139], v[20:23]
    ds_read_b128 v[60:63], v7 offset:16384
    v_mfma_f32_16x16x32_bf16 v[24:27], v[84:87], v[136:139], v[24:27]
    ds_read_b128 v[64:67], v7 offset:17408
    s_waitcnt vmcnt(8)
    v_mfma_f32_16x16x32_bf16 v[8:11], v[88:91], v[140:143], v[8:11]
    ds_read_b128 v[68:71], v7 offset:18432
    v_mfma_f32_16x16x32_bf16 v[12:15], v[92:95], v[140:143], v[12:15]
    ds_read_b128 v[72:75], v7 offset:19456
    s_add_u32 s52, s52, 4096
    buffer_load_dwordx4 v[176:179], v2, s[28:31], s52 offen offset:0 sc1
    v_mfma_f32_16x16x32_bf16 v[16:19], v[96:99], v[140:143], v[16:19]
    ds_read_b128 v[76:79], v7 offset:20480
    v_mfma_f32_16x16x32_bf16 v[20:23], v[100:103], v[140:143], v[20:23]
    ds_read_b128 v[80:83], v7 offset:21504
    v_mfma_f32_16x16x32_bf16 v[24:27], v[104:107], v[140:143], v[24:27]
    ds_read_b128 v[84:87], v7 offset:22528
    s_waitcnt lgkmcnt(5)
    s_waitcnt vmcnt(8)
    v_mfma_f32_16x16x32_bf16 v[8:11], v[48:51], v[144:147], v[8:11]
    ds_read_b128 v[88:91], v7 offset:23552
    v_mfma_f32_16x16x32_bf16 v[12:15], v[52:55], v[144:147], v[12:15]
    ds_read_b128 v[92:95], v7 offset:24576
    buffer_load_dwordx4 v[180:183], v2, s[28:31], s52 offen offset:2048 sc1
    v_mfma_f32_16x16x32_bf16 v[16:19], v[56:59], v[144:147], v[16:19]
    ds_read_b128 v[96:99], v7 offset:25600
    v_mfma_f32_16x16x32_bf16 v[20:23], v[60:63], v[144:147], v[20:23]
    ds_read_b128 v[100:103], v7 offset:26624
    v_mfma_f32_16x16x32_bf16 v[24:27], v[64:67], v[144:147], v[24:27]
    ds_read_b128 v[104:107], v7 offset:27648
    s_waitcnt lgkmcnt(5)
    s_waitcnt vmcnt(8)
    v_mfma_f32_16x16x32_bf16 v[8:11], v[68:71], v[148:151], v[8:11]
    ds_read_b128 v[48:51], v7 offset:28672
    v_mfma_f32_16x16x32_bf16 v[12:15], v[72:75], v[148:151], v[12:15]
    ds_read_b128 v[52:55], v7 offset:29696
    s_add_u32 s52, s52, 4096
    buffer_load_dwordx4 v[184:187], v2, s[28:31], s52 offen offset:0 sc1
    v_mfma_f32_16x16x32_bf16 v[16:19], v[76:79], v[148:151], v[16:19]
    ds_read_b128 v[56:59], v7 offset:30720
    v_mfma_f32_16x16x32_bf16 v[20:23], v[80:83], v[148:151], v[20:23]
    ds_read_b128 v[60:63], v7 offset:31744
    v_mfma_f32_16x16x32_bf16 v[24:27], v[84:87], v[148:151], v[24:27]
    ds_read_b128 v[64:67], v7 offset:32768
    s_waitcnt lgkmcnt(5)
    s_waitcnt lgkmcnt(0)
    s_barrier
    s_waitcnt vmcnt(8)
    v_mfma_f32_16x16x32_bf16 v[8:11], v[88:91], v[152:155], v[8:11]
    ds_read_b128 v[68:71], v7 offset:33792
    v_mfma_f32_16x16x32_bf16 v[12:15], v[92:95], v[152:155], v[12:15]
    ds_read_b128 v[72:75], v7 offset:34816
    v_mfma_f32_16x16x32_bf16 v[16:19], v[96:99], v[152:155], v[16:19]
    ds_read_b128 v[76:79], v7 offset:35840
    v_mfma_f32_16x16x32_bf16 v[20:23], v[100:103], v[152:155], v[20:23]
    ds_read_b128 v[80:83], v7 offset:36864
    v_mfma_f32_16x16x32_bf16 v[24:27], v[104:107], v[152:155], v[24:27]
    ds_read_b128 v[84:87], v7 offset:37888
    s_waitcnt vmcnt(7)
    v_mfma_f32_16x16x32_bf16 v[8:11], v[48:51], v[156:159], v[8:11]
    ds_read_b128 v[88:91], v7 offset:38912
    v_mfma_f32_16x16x32_bf16 v[12:15], v[52:55], v[156:159], v[12:15]
    ds_read_b128 v[92:95], v7 offset:39936
    buffer_load_dwordx4 v[188:191], v2, s[28:31], s52 offen offset:2048 sc1
    v_mfma_f32_16x16x32_bf16 v[16:19], v[56:59], v[156:159], v[16:19]
    ds_read_b128 v[96:99], v7 offset:40960
    v_mfma_f32_16x16x32_bf16 v[20:23], v[60:63], v[156:159], v[20:23]
    ds_read_b128 v[100:103], v7 offset:41984
    v_mfma_f32_16x16x32_bf16 v[24:27], v[64:67], v[156:159], v[24:27]
    ds_read_b128 v[104:107], v7 offset:43008
    s_waitcnt lgkmcnt(5)
    s_waitcnt vmcnt(7)
    v_mfma_f32_16x16x32_bf16 v[8:11], v[68:71], v[160:163], v[8:11]
    ds_read_b128 v[48:51], v7 offset:44032
    v_mfma_f32_16x16x32_bf16 v[12:15], v[72:75], v[160:163], v[12:15]
    ds_read_b128 v[52:55], v7 offset:45056
    s_add_u32 s52, s52, 4096
    buffer_load_dwordx4 v[192:195], v2, s[28:31], s52 offen offset:0 sc1
    v_mfma_f32_16x16x32_bf16 v[16:19], v[76:79], v[160:163], v[16:19]
    ds_read_b128 v[56:59], v7 offset:46080
    v_mfma_f32_16x16x32_bf16 v[20:23], v[80:83], v[160:163], v[20:23]
    ds_read_b128 v[60:63], v7 offset:47104
    v_mfma_f32_16x16x32_bf16 v[24:27], v[84:87], v[160:163], v[24:27]
    ds_read_b128 v[64:67], v7 offset:48128
    s_waitcnt lgkmcnt(5)
    s_waitcnt vmcnt(7)
    v_mfma_f32_16x16x32_bf16 v[8:11], v[88:91], v[164:167], v[8:11]
    ds_read_b128 v[68:71], v7 offset:49152
    v_mfma_f32_16x16x32_bf16 v[12:15], v[92:95], v[164:167], v[12:15]
    ds_read_b128 v[72:75], v7 offset:50176
    buffer_load_dwordx4 v[196:199], v2, s[28:31], s52 offen offset:2048 sc1
    v_mfma_f32_16x16x32_bf16 v[16:19], v[96:99], v[164:167], v[16:19]
    ds_read_b128 v[76:79], v7 offset:51200
    v_mfma_f32_16x16x32_bf16 v[20:23], v[100:103], v[164:167], v[20:23]
    ds_read_b128 v[80:83], v7 offset:52224
    v_mfma_f32_16x16x32_bf16 v[24:27], v[104:107], v[164:167], v[24:27]
    ds_read_b128 v[84:87], v7 offset:53248
    s_waitcnt lgkmcnt(5)
    s_waitcnt lgkmcnt(0)
    s_barrier
    s_waitcnt vmcnt(7)
    v_mfma_f32_16x16x32_bf16 v[8:11], v[48:51], v[168:171], v[8:11]
    ds_read_b128 v[88:91], v7 offset:54272
    v_mfma_f32_16x16x32_bf16 v[12:15], v[52:55], v[168:171], v[12:15]
    ds_read_b128 v[92:95], v7 offset:55296
    s_add_u32 s52, s52, 4096
    buffer_load_dwordx4 v[200:203], v2, s[28:31], s52 offen offset:0 sc1
    v_mfma_f32_16x16x32_bf16 v[16:19], v[56:59], v[168:171], v[16:19]
    ds_read_b128 v[96:99], v7 offset:56320
    v_mfma_f32_16x16x32_bf16 v[20:23], v[60:63], v[168:171], v[20:23]
    ds_read_b128 v[100:103], v7 offset:57344
    v_mfma_f32_16x16x32_bf16 v[24:27], v[64:67], v[168:171], v[24:27]
    ds_read_b128 v[104:107], v7 offset:58368
    s_waitcnt vmcnt(7)
    v_mfma_f32_16x16x32_bf16 v[8:11], v[68:71], v[172:175], v[8:11]
    ds_read_b128 v[48:51], v7 offset:59392
    v_mfma_f32_16x16x32_bf16 v[12:15], v[72:75], v[172:175], v[12:15]
    ds_read_b128 v[52:55], v7 offset:60416
    v_mfma_f32_16x16x32_bf16 v[16:19], v[76:79], v[172:175], v[16:19]
    ds_read_b128 v[56:59], v7 offset:61440
    v_mfma_f32_16x16x32_bf16 v[20:23], v[80:83], v[172:175], v[20:23]
    ds_read_b128 v[60:63], v7 offset:62464
    v_mfma_f32_16x16x32_bf16 v[24:27], v[84:87], v[172:175], v[24:27]
    ds_read_b128 v[64:67], v7 offset:63488
    s_waitcnt lgkmcnt(5)
    s_waitcnt vmcnt(6)
    v_mfma_f32_16x16x32_bf16 v[8:11], v[88:91], v[176:179], v[8:11]
    ds_read_b128 v[68:71], v7 offset:64512
    v_mfma_f32_16x16x32_bf16 v[12:15], v[92:95], v[176:179], v[12:15]
    ds_read_b128 v[72:75], v1 offset:0
    buffer_load_dwordx4 v[204:207], v2, s[28:31], s52 offen offset:2048 sc1
    v_mfma_f32_16x16x32_bf16 v[16:19], v[96:99], v[176:179], v[16:19]
    ds_read_b128 v[76:79], v1 offset:1024
    v_mfma_f32_16x16x32_bf16 v[20:23], v[100:103], v[176:179], v[20:23]
    ds_read_b128 v[80:83], v1 offset:2048
    v_mfma_f32_16x16x32_bf16 v[24:27], v[104:107], v[176:179], v[24:27]
    ds_read_b128 v[84:87], v1 offset:3072
hop_pad_15:
    s_cbranch_execz hop_back
    s_waitcnt lgkmcnt(5)
    s_waitcnt vmcnt(6)
    v_mfma_f32_16x16x32_bf16 v[8:11], v[48:51], v[180:183], v[8:11]
    ds_read_b128 v[88:91], v1 offset:4096
    v_mfma_f32_16x16x32_bf16 v[12:15], v[52:55], v[180:183], v[12:15]
    ds_read_b128 v[92:95], v1 offset:5120
    s_add_u32 s52, s52, 4096
    buffer_load_dwordx4 v[208:211], v2, s[28:31], s52 offen offset:0 sc1
    v_mfma_f32_16x16x32_bf16 v[16:19], v[56:59], v[180:183], v[16:19]
    ds_read_b128 v[96:99], v1 offset:6144
    v_mfma_f32_16x16x32_bf16 v[20:23], v[60:63], v[180:183], v[20:23]
    ds_read_b128 v[100:103], v1 offset:7168
    v_mfma_f32_16x16x32_bf16 v[24:27], v[64:67], v[180:183], v[24:27]
    ds_read_b128 v[104:107], v1 offset:8192
    s_waitcnt lgkmcnt(5)
    s_waitcnt lgkmcnt(0)
    s_barrier
    s_waitcnt vmcnt(6)
    v_mfma_f32_16x16x32_bf16 v[8:11], v[68:71], v[184:187], v[8:11]
    ds_read_b128 v[48:51], v1 offset:9216
    v_mfma_f32_16x16x32_bf16 v[12:15], v[72:75], v[184:187], v[12:15]
    ds_read_b128 v[52:55], v1 offset:10240
    buffer_load_dwordx4 v[212:215], v2, s[28:31], s52 offen offset:2048 sc1
    v_mfma_f32_16x16x32_bf16 v[16:19], v[76:79], v[184:187], v[16:19]
    ds_read_b128 v[56:59], v1 offset:11264
    v_mfma_f32_16x16x32_bf16 v[20:23], v[80:83], v[184:187], v[20:23]
    ds_read_b128 v[60:63], v1 offset:12288
    v_mfma_f32_16x16x32_bf16 v[24:27], v[84:87], v[184:187], v[24:27]
    ds_read_b128 v[64:67], v1 offset:13312
    s_waitcnt vmcnt(6)
    v_mfma_f32_16x16x32_bf16 v[8:11], v[88:91], v[188:191], v[8:11]
    ds_read_b128 v[68:71], v1 offset:14336
    v_mfma_f32_16x16x32_bf16 v[12:15], v[92:95], v[188:191], v[12:15]
    ds_read_b128 v[72:75], v1 offset:15360
    v_mfma_f32_16x16x32_bf16 v[16:19], v[96:99], v[188:191], v[16:19]
    ds_read_b128 v[76:79], v1 offset:16384
    v_mfma_f32_16x16x32_bf16 v[20:23], v[100:103], v[188:191], v[20:23]
    ds_read_b128 v[80:83], v1 offset:17408
    v_mfma_f32_16x16x32_bf16 v[24:27], v[104:107], v[188:191], v[24:27]
    ds_read_b128 v[84:87], v1 offset:18432
    s_waitcnt lgkmcnt(5)
    s_waitcnt vmcnt(5)
    v_mfma_f32_16x16x32_bf16 v[8:11], v[48:51], v[192:195], v[8:11]
    ds_read_b128 v[88:91], v1 offset:19456
    v_mfma_f32_16x16x32_bf16 v[12:15], v[52:55], v[192:195], v[12:15]
    ds_read_b128 v[92:95], v1 offset:20480
    v_mfma_f32_16x16x32_bf16 v[16:19], v[56:59], v[192:195], v[16:19]
    ds_read_b128 v[96:99], v1 offset:21504
    v_mfma_f32_16x16x32_bf16 v[20:23], v[60:63], v[192:195], v[20:23]
    ds_read_b128 v[100:103], v1 offset:22528
    v_mfma_f32_16x16x32_bf16 v[24:27], v[64:67], v[192:195], v[24:27]
    ds_read_b128 v[104:107], v1 offset:23552
    s_waitcnt lgkmcnt(5)
    s_waitcnt vmcnt(4)
    v_mfma_f32_16x16x32_bf16 v[8:11], v[68:71], v[196:199], v[8:11]
    ds_read_b128 v[48:51], v1 offset:24576
    v_mfma_f32_16x16x32_bf16 v[12:15], v[72:75], v[196:199], v[12:15]
    ds_read_b128 v[52:55], v1 offset:25600
    v_mfma_f32_16x16x32_bf16 v[16:19], v[76:79], v[196:199], v[16:19]
    ds_read_b128 v[56:59], v1 offset:26624
    v_mfma_f32_16x16x32_bf16 v[20:23], v[80:83], v[196:199], v[20:23]
    ds_read_b128 v[60:63], v1 offset:27648
    v_mfma_f32_16x16x32_bf16 v[24:27], v[84:87], v[196:199], v[24:27]
    ds_read_b128 v[64:67], v1 offset:28672
    s_waitcnt lgkmcnt(5)
    s_waitcnt lgkmcnt(0)
    s_barrier
    s_waitcnt vmcnt(3)
    v_mfma_f32_16x16x32_bf16 v[8:11], v[88:91], v[200:203], v[8:11]
    ds_read_b128 v[68:71], v3 offset:58368
    v_mfma_f32_16x16x32_bf16 v[12:15], v[92:95], v[200:203], v[12:15]
    ds_read_b128 v[72:75], v3 offset:59392
    v_mfma_f32_16x16x32_bf16 v[16:19], v[96:99], v[200:203], v[16:19]
    ds_read_b128 v[76:79], v3 offset:60416
    v_mfma_f32_16x16x32_bf16 v[20:23], v[100:103], v[200:203], v[20:23]
    ds_read_b128 v[80:83], v3 offset:61440
    v_mfma_f32_16x16x32_bf16 v[24:27], v[104:107], v[200:203], v[24:27]
    ds_read_b128 v[84:87], v3 offset:62464
    s_waitcnt vmcnt(2)
    v_mfma_f32_16x16x32_bf16 v[8:11], v[48:51], v[204:207], v[8:11]
    ds_read_b128 v[88:91], v3 offset:63488
    v_mfma_f32_16x16x32_bf16 v[12:15], v[52:55], v[204:207], v[12:15]
    ds_read_b128 v[92:95], v3 offset:64512
    v_mfma_f32_16x16x32_bf16 v[16:19], v[56:59], v[204:207], v[16:19]
    ds_read_b128 v[96:99], v7 offset:0
    v_mfma_f32_16x16x32_bf16 v[20:23], v[60:63], v[204:207], v[20:23]
    ds_read_b128 v[100:103], v7 offset:1024
    v_mfma_f32_16x16x32_bf16 v[24:27], v[64:67], v[204:207], v[24:27]
    ds_read_b128 v[104:107], v7 offset:2048
    s_waitcnt lgkmcnt(5)
    v_lshlrev_b32 v48, 16, v28
    v_and_b32 v49, 0xffff0000, v28
    v_lshlrev_b32 v50, 16, v29
    v_and_b32 v51, 0xffff0000, v29
    v_lshlrev_b32 v52, 16, v30
    v_and_b32 v53, 0xffff0000, v30
    v_lshlrev_b32 v54, 16, v31
    v_and_b32 v55, 0xffff0000, v31
    v_lshlrev_b32 v56, 16, v32
    v_and_b32 v57, 0xffff0000, v32
    v_lshlrev_b32 v58, 16, v33
    v_and_b32 v59, 0xffff0000, v33
    v_lshlrev_b32 v60, 16, v34
    v_and_b32 v61, 0xffff0000, v34
    v_lshlrev_b32 v62, 16, v35
    v_and_b32 v63, 0xffff0000, v35
    v_lshlrev_b32 v64, 16, v36
    v_and_b32 v65, 0xffff0000, v36
    v_lshlrev_b32 v66, 16, v37
    v_and_b32 v67, 0xffff0000, v37
    s_waitcnt vmcnt(1)
    v_mfma_f32_16x16x32_bf16 v[8:11], v[68:71], v[208:211], v[8:11]
    v_mfma_f32_16x16x32_bf16 v[12:15], v[72:75], v[208:211], v[12:15]
    v_mfma_f32_16x16x32_bf16 v[16:19], v[76:79], v[208:211], v[16:19]
    v_mfma_f32_16x16x32_bf16 v[20:23], v[80:83], v[208:211], v[20:23]
    v_mfma_f32_16x16x32_bf16 v[24:27], v[84:87], v[208:211], v[24:27]
    s_waitcnt lgkmcnt(0)
    s_waitcnt vmcnt(0)
    v_mfma_f32_16x16x32_bf16 v[8:11], v[88:91], v[212:215], v[8:11]
    v_mfma_f32_16x16x32_bf16 v[12:15], v[92:95], v[212:215], v[12:15]
    v_mfma_f32_16x16x32_bf16 v[16:19], v[96:99], v[212:215], v[16:19]
    v_mfma_f32_16x16x32_bf16 v[20:23], v[100:103], v[212:215], v[20:23]
    v_mfma_f32_16x16x32_bf16 v[24:27], v[104:107], v[212:215], v[24:27]
    s_nop 3
    v_pk_fma_f32 v[8:9], v[8:9], v[108:109], v[48:49]
    v_pk_fma_f32 v[10:11], v[10:11], v[110:111], v[50:51]
    v_cvt_pk_bf16_f32 v28, v8, v9
    v_cvt_pk_bf16_f32 v29, v10, v11
    v_pk_fma_f32 v[12:13], v[12:13], v[112:113], v[52:53]
    v_pk_fma_f32 v[14:15], v[14:15], v[114:115], v[54:55]
    v_cvt_pk_bf16_f32 v30, v12, v13
    v_cvt_pk_bf16_f32 v31, v14, v15
    s_nop 0
    v_permlane16_swap_b32 v28, v30
    v_permlane16_swap_b32 v29, v31
    buffer_store_dwordx4 v[28:31], v40, s[32:35], s46 offen offset:0
    v_pk_fma_f32 v[16:17], v[16:17], v[116:117], v[56:57]
    v_pk_fma_f32 v[18:19], v[18:19], v[118:119], v[58:59]
    v_cvt_pk_bf16_f32 v32, v16, v17
    v_cvt_pk_bf16_f32 v33, v18, v19
    v_pk_fma_f32 v[20:21], v[20:21], v[120:121], v[60:61]
    v_pk_fma_f32 v[22:23], v[22:23], v[122:123], v[62:63]
    v_cvt_pk_bf16_f32 v34, v20, v21
    v_cvt_pk_bf16_f32 v35, v22, v23
    s_nop 0
    v_permlane16_swap_b32 v32, v34
    v_permlane16_swap_b32 v33, v35
    buffer_store_dwordx4 v[32:35], v40, s[32:35], s46 offen offset:64
    v_pk_fma_f32 v[24:25], v[24:25], v[124:125], v[64:65]
    v_pk_fma_f32 v[26:27], v[26:27], v[126:127], v[66:67]
    v_cvt_pk_bf16_f32 v36, v24, v25
    v_cvt_pk_bf16_f32 v37, v26, v27
    buffer_store_dwordx2 v[36:37], v4, s[32:35], s46 offen offset:128
    s_endpgm
adaLN_cond__sliding_block__swiglu_ffn__prompt_kernel_ld2_6:
hop_pad_16:
    s_cbranch_execz hop_back
    v_lshlrev_b32 v1, 4, v0
    s_mul_i32 s40, s66, 5120
    s_lshl_b32 s41, s66, 12
    s_mul_i32 s42, s63, 102400
    s_add_u32 s42, s42, s40
    s_add_u32 s42, s42, 1048576
    s_mul_i32 s44, s61, 40960
    s_add_u32 s44, s44, 5242880
    s_add_u32 s44, s44, s40
    s_waitcnt vmcnt(0)
    v_mov_b32 v250, 162848
    v_mov_b32 v251, 1
    s_mov_b64 exec, 1
    ds_add_rtn_u32 v251, v250, v251
    s_mov_b64 exec, -1
    s_waitcnt lgkmcnt(0)
    v_readfirstlane_b32 s56, v251
    s_nop 0
    s_cmp_lg_u32 s56, 3
    s_cbranch_scc1 adaLN_cond__sliding_block__swiglu_ffn__prompt_kernel_sig_92
    s_lshl_b32 s57, s24, 7
    s_add_u32 s57, s57, 798720
    s_atomic_add_x2 s[10:11], s[26:27], s57
adaLN_cond__sliding_block__swiglu_ffn__prompt_kernel_sig_92:
    s_cmp_lg_u32 s66, 0
    s_cbranch_scc1 adaLN_cond__sliding_block__swiglu_ffn__prompt_kernel_r2_93
    s_waitcnt lgkmcnt(0)
    s_sub_u32 s68, s68, s64
    s_subb_u32 s69, s69, s65
    s_cmp_eq_u64 s[68:69], 16
    s_cbranch_scc1 adaLN_cond__sliding_block__swiglu_ffn__prompt_kernel_r2_93
    s_lshl_b32 s57, s60, 7
    s_add_u32 s57, s57, 813056
    s_waitcnt lgkmcnt(0)
    s_mov_b32 s56, 0
adaLN_cond__sliding_block__swiglu_ffn__prompt_kernel_poll_94:
    s_mov_b64 s[58:59], 0
    s_atomic_add_x2 s[58:59], s[26:27], s57 glc
    s_waitcnt lgkmcnt(0)
    s_sub_u32 s58, s58, s64
    s_subb_u32 s59, s59, s65
    s_cmp_eq_u64 s[58:59], 16
    s_cbranch_scc1 adaLN_cond__sliding_block__swiglu_ffn__prompt_kernel_pdone_95
    s_add_u32 s56, s56, 1
    s_sleep 1
    s_cmp_lt_u32 s56, 0x8000
    s_cbranch_scc1 adaLN_cond__sliding_block__swiglu_ffn__prompt_kernel_poll_94
adaLN_cond__sliding_block__swiglu_ffn__prompt_kernel_pdone_95:
adaLN_cond__sliding_block__swiglu_ffn__prompt_kernel_r2_93:
    s_barrier
    s_cmp_lg_u32 s66, 0
    s_cbranch_scc1 adaLN_cond__sliding_block__swiglu_ffn__prompt_kernel_pa_96
    s_lshl_b32 s57, s60, 7
    s_add_u32 s57, s57, 798720
    s_waitcnt lgkmcnt(0)
    s_mov_b32 s56, 0
adaLN_cond__sliding_block__swiglu_ffn__prompt_kernel_poll_98:
    s_mov_b64 s[58:59], 0
    s_atomic_add_x2 s[58:59], s[26:27], s57 glc
    s_waitcnt lgkmcnt(0)
    s_sub_u32 s58, s58, s64
    s_subb_u32 s59, s59, s65
    s_cmp_eq_u64 s[58:59], 16
    s_cbranch_scc1 adaLN_cond__sliding_block__swiglu_ffn__prompt_kernel_pdone_99
    s_add_u32 s56, s56, 1
    s_sleep 1
    s_cmp_lt_u32 s56, 0x8000
    s_cbranch_scc1 adaLN_cond__sliding_block__swiglu_ffn__prompt_kernel_poll_98
adaLN_cond__sliding_block__swiglu_ffn__prompt_kernel_pdone_99:
    s_barrier
adaLN_cond__sliding_block__swiglu_ffn__prompt_kernel_pa_96:
    s_sleep 2
    s_add_u32 s50, s42, 81920
    s_add_u32 s51, s42, 86016
    s_add_u32 m0, s40, 58368
    s_nop 0
    buffer_load_dwordx4 v1, s[28:31], s50 offen sc1 lds
    buffer_load_dwordx4 v1, s[28:31], s50 offen offset:1024 sc1 lds
    buffer_load_dwordx4 v1, s[28:31], s50 offen offset:2048 sc1 lds
    buffer_load_dwordx4 v1, s[28:31], s50 offen offset:3072 sc1 lds
    s_add_u32 m0, s40, 62464
    s_nop 0
    buffer_load_dwordx4 v1, s[28:31], s51 offen sc1 lds
    s_add_u32 s50, s44, 0
    s_add_u32 s51, s44, 4096
    s_add_u32 m0, s40, 17408
    s_nop 0
    buffer_load_dwordx4 v1, s[28:31], s50 offen sc1 lds
    buffer_load_dwordx4 v1, s[28:31], s50 offen offset:1024 sc1 lds
    buffer_load_dwordx4 v1, s[28:31], s50 offen offset:2048 sc1 lds
    buffer_load_dwordx4 v1, s[28:31], s50 offen offset:3072 sc1 lds
    s_add_u32 m0, s40, 21504
    s_nop 0
    buffer_load_dwordx4 v1, s[28:31], s51 offen sc1 lds
    s_add_u32 s50, s44, 655360
    s_add_u32 s51, s44, 659456
    s_add_u32 m0, s40, 37888
    s_nop 0
    buffer_load_dwordx4 v1, s[28:31], s50 offen sc1 lds
    buffer_load_dwordx4 v1, s[28:31], s50 offen offset:1024 sc1 lds
    buffer_load_dwordx4 v1, s[28:31], s50 offen offset:2048 sc1 lds
    buffer_load_dwordx4 v1, s[28:31], s50 offen offset:3072 sc1 lds
    s_add_u32 m0, s40, 41984
    s_nop 0
    buffer_load_dwordx4 v1, s[28:31], s51 offen sc1 lds
    s_cmp_eq_u32 s66, 0
    s_cbranch_scc1 adaLN_cond__sliding_block__swiglu_ffn__prompt_kernel_pb_97
    s_barrier
adaLN_cond__sliding_block__swiglu_ffn__prompt_kernel_pb_97:
    s_barrier
    s_add_u32 s50, s44, 20480
    s_add_u32 s51, s44, 24576
    s_add_u32 m0, s40, 78848
    s_nop 0
    buffer_load_dwordx4 v1, s[28:31], s50 offen sc1 lds
    buffer_load_dwordx4 v1, s[28:31], s50 offen offset:1024 sc1 lds
    buffer_load_dwordx4 v1, s[28:31], s50 offen offset:2048 sc1 lds
    buffer_load_dwordx4 v1, s[28:31], s50 offen offset:3072 sc1 lds
    s_add_u32 m0, s40, 82944
    s_nop 0
    buffer_load_dwordx4 v1, s[28:31], s51 offen sc1 lds
    s_waitcnt vmcnt(15)
    s_barrier
    s_add_u32 s50, s44, 675840
    s_add_u32 s51, s44, 679936
    s_add_u32 m0, s40, 99328
    s_nop 0
    buffer_load_dwordx4 v1, s[28:31], s50 offen sc1 lds
    buffer_load_dwordx4 v1, s[28:31], s50 offen offset:1024 sc1 lds
    buffer_load_dwordx4 v1, s[28:31], s50 offen offset:2048 sc1 lds
    buffer_load_dwordx4 v1, s[28:31], s50 offen offset:3072 sc1 lds
    s_add_u32 m0, s40, 103424
    s_nop 0
    buffer_load_dwordx4 v1, s[28:31], s51 offen sc1 lds
    s_barrier
    s_add_u32 s50, s44, 1310720
    s_add_u32 s51, s44, 1314816
    s_add_u32 m0, s40, 119808
    s_nop 0
    buffer_load_dwordx4 v1, s[28:31], s50 offen sc1 lds
    buffer_load_dwordx4 v1, s[28:31], s50 offen offset:1024 sc1 lds
    buffer_load_dwordx4 v1, s[28:31], s50 offen offset:2048 sc1 lds
    buffer_load_dwordx4 v1, s[28:31], s50 offen offset:3072 sc1 lds
    s_add_u32 m0, s40, 123904
    s_nop 0
    buffer_load_dwordx4 v1, s[28:31], s51 offen sc1 lds
    s_mul_i32 s42, s63, 276480
    s_add_u32 s42, s42, 2097152
    s_add_u32 s42, s42, s40
    s_barrier
    s_add_u32 s50, s44, 1331200
    s_add_u32 s51, s44, 1335296
    s_add_u32 m0, s40, 140288
    s_nop 0
    buffer_load_dwordx4 v1, s[28:31], s50 offen sc1 lds
    buffer_load_dwordx4 v1, s[28:31], s50 offen offset:1024 sc1 lds
    buffer_load_dwordx4 v1, s[28:31], s50 offen offset:2048 sc1 lds
    buffer_load_dwordx4 v1, s[28:31], s50 offen offset:3072 sc1 lds
    s_add_u32 m0, s40, 144384
    s_nop 0
    buffer_load_dwordx4 v1, s[28:31], s51 offen sc1 lds
    s_barrier
    s_add_u32 s50, s44, 1966080
    s_add_u32 s51, s44, 1970176
    s_add_u32 m0, s40, 58368
    s_nop 0
    buffer_load_dwordx4 v1, s[28:31], s50 offen sc1 lds
    buffer_load_dwordx4 v1, s[28:31], s50 offen offset:1024 sc1 lds
    buffer_load_dwordx4 v1, s[28:31], s50 offen offset:2048 sc1 lds
    buffer_load_dwordx4 v1, s[28:31], s50 offen offset:3072 sc1 lds
    s_add_u32 m0, s40, 62464
    s_nop 0
    buffer_load_dwordx4 v1, s[28:31], s51 offen sc1 lds
    s_waitcnt vmcnt(25)
    s_barrier
    s_waitcnt vmcnt(15)
    s_barrier
    s_waitcnt vmcnt(10)
    s_barrier
    s_add_u32 s50, s44, 1986560
    s_add_u32 s51, s44, 1990656
    s_add_u32 m0, s40, 17408
    s_nop 0
    buffer_load_dwordx4 v1, s[28:31], s50 offen sc1 lds
    buffer_load_dwordx4 v1, s[28:31], s50 offen offset:1024 sc1 lds
    buffer_load_dwordx4 v1, s[28:31], s50 offen offset:2048 sc1 lds
    buffer_load_dwordx4 v1, s[28:31], s50 offen offset:3072 sc1 lds
    s_add_u32 m0, s40, 21504
    s_nop 0
    buffer_load_dwordx4 v1, s[28:31], s51 offen sc1 lds
    s_waitcnt vmcnt(10)
    s_barrier
    s_add_u32 s50, s44, 2621440
    s_add_u32 s51, s44, 2625536
    s_add_u32 m0, s40, 37888
    s_nop 0
    buffer_load_dwordx4 v1, s[28:31], s50 offen sc1 lds
    buffer_load_dwordx4 v1, s[28:31], s50 offen offset:1024 sc1 lds
    buffer_load_dwordx4 v1, s[28:31], s50 offen offset:2048 sc1 lds
    buffer_load_dwordx4 v1, s[28:31], s50 offen offset:3072 sc1 lds
    s_add_u32 m0, s40, 41984
    s_nop 0
    buffer_load_dwordx4 v1, s[28:31], s51 offen sc1 lds
    s_add_u32 s50, s44, 2641920
    s_add_u32 s51, s44, 2646016
    s_add_u32 m0, s40, 78848
    s_nop 0
    buffer_load_dwordx4 v1, s[28:31], s50 offen sc1 lds
    buffer_load_dwordx4 v1, s[28:31], s50 offen offset:1024 sc1 lds
    buffer_load_dwordx4 v1, s[28:31], s50 offen offset:2048 sc1 lds
    buffer_load_dwordx4 v1, s[28:31], s50 offen offset:3072 sc1 lds
    s_add_u32 m0, s40, 82944
    s_nop 0
    buffer_load_dwordx4 v1, s[28:31], s51 offen sc1 lds
    s_waitcnt vmcnt(15)
    s_barrier
    s_add_u32 s50, s44, 3276800
    s_add_u32 s51, s44, 3280896
    s_add_u32 m0, s40, 99328
    s_nop 0
    buffer_load_dwordx4 v1, s[28:31], s50 offen sc1 lds
    buffer_load_dwordx4 v1, s[28:31], s50 offen offset:1024 sc1 lds
    buffer_load_dwordx4 v1, s[28:31], s50 offen offset:2048 sc1 lds
    buffer_load_dwordx4 v1, s[28:31], s50 offen offset:3072 sc1 lds
    s_add_u32 m0, s40, 103424
    s_nop 0
    buffer_load_dwordx4 v1, s[28:31], s51 offen sc1 lds
    s_add_u32 s50, s44, 3297280
    s_add_u32 s51, s44, 3301376
    s_add_u32 m0, s40, 119808
    s_nop 0
    buffer_load_dwordx4 v1, s[28:31], s50 offen sc1 lds
    buffer_load_dwordx4 v1, s[28:31], s50 offen offset:1024 sc1 lds
    buffer_load_dwordx4 v1, s[28:31], s50 offen offset:2048 sc1 lds
    buffer_load_dwordx4 v1, s[28:31], s50 offen offset:3072 sc1 lds
    s_add_u32 m0, s40, 123904
    s_nop 0
    buffer_load_dwordx4 v1, s[28:31], s51 offen sc1 lds
    s_waitcnt vmcnt(20)
    s_barrier
    s_cmp_ge_u32 s61, 12
    s_cselect_b32 s44, 0x40000000, s44
    s_add_u32 s50, s44, 3932160
    s_add_u32 s51, s44, 3936256
    s_add_u32 m0, s40, 140288
    s_nop 0
    buffer_load_dwordx4 v1, s[28:31], s50 offen sc1 lds
    buffer_load_dwordx4 v1, s[28:31], s50 offen offset:1024 sc1 lds
    buffer_load_dwordx4 v1, s[28:31], s50 offen offset:2048 sc1 lds
    buffer_load_dwordx4 v1, s[28:31], s50 offen offset:3072 sc1 lds
    s_add_u32 m0, s40, 144384
    s_nop 0
    buffer_load_dwordx4 v1, s[28:31], s51 offen sc1 lds
    s_waitcnt vmcnt(20)
    s_barrier
    s_add_u32 s50, s44, 3952640
    s_add_u32 s51, s44, 3956736
    s_add_u32 m0, s40, 58368
    s_nop 0
    buffer_load_dwordx4 v1, s[28:31], s50 offen sc1 lds
    buffer_load_dwordx4 v1, s[28:31], s50 offen offset:1024 sc1 lds
    buffer_load_dwordx4 v1, s[28:31], s50 offen offset:2048 sc1 lds
    buffer_load_dwordx4 v1, s[28:31], s50 offen offset:3072 sc1 lds
    s_add_u32 m0, s40, 62464
    s_nop 0
    buffer_load_dwordx4 v1, s[28:31], s51 offen sc1 lds
    s_waitcnt vmcnt(20)
    s_barrier
    s_cmp_lg_u32 s66, 3
    s_cbranch_scc1 adaLN_cond__sliding_block__swiglu_ffn__prompt_kernel_sg_100
    s_lshl_b32 s57, s60, 7
    s_add_u32 s57, s57, 804864
    s_atomic_add_x2 s[10:11], s[26:27], s57
adaLN_cond__sliding_block__swiglu_ffn__prompt_kernel_sg_100:
    s_add_u32 s50, s42, 0
    s_add_u32 s51, s42, 4096
    s_add_u32 m0, s40, 17408
    s_nop 0
    buffer_load_dwordx4 v1, s[28:31], s50 offen sc1 lds
    buffer_load_dwordx4 v1, s[28:31], s50 offen offset:1024 sc1 lds
    buffer_load_dwordx4 v1, s[28:31], s50 offen offset:2048 sc1 lds
    buffer_load_dwordx4 v1, s[28:31], s50 offen offset:3072 sc1 lds
    s_add_u32 m0, s40, 21504
    s_nop 0
    buffer_load_dwordx4 v1, s[28:31], s51 offen sc1 lds
    s_waitcnt vmcnt(20)
    s_barrier
    s_add_u32 s50, s42, 20480
    s_add_u32 s51, s42, 24576
    s_add_u32 m0, s40, 37888
    s_nop 0
    buffer_load_dwordx4 v1, s[28:31], s50 offen sc1 lds
    buffer_load_dwordx4 v1, s[28:31], s50 offen offset:1024 sc1 lds
    buffer_load_dwordx4 v1, s[28:31], s50 offen offset:2048 sc1 lds
    buffer_load_dwordx4 v1, s[28:31], s50 offen offset:3072 sc1 lds
    s_add_u32 m0, s40, 41984
    s_nop 0
    buffer_load_dwordx4 v1, s[28:31], s51 offen sc1 lds
    s_waitcnt vmcnt(20)
    s_barrier
    s_cmp_lg_u32 s66, 0
    s_cbranch_scc1 adaLN_cond__sliding_block__swiglu_ffn__prompt_kernel_ak_101
    s_lshl_b32 s57, s60, 7
    s_add_u32 s57, s57, 804864
    s_mov_b64 s[46:47], 0
    s_atomic_add_x2 s[46:47], s[26:27], s57 glc
adaLN_cond__sliding_block__swiglu_ffn__prompt_kernel_ak_101:
    s_add_u32 s50, s42, 40960
    s_add_u32 s51, s42, 45056
    s_add_u32 m0, s40, 78848
    s_nop 0
    buffer_load_dwordx4 v1, s[28:31], s50 offen sc1 lds
    buffer_load_dwordx4 v1, s[28:31], s50 offen offset:1024 sc1 lds
    buffer_load_dwordx4 v1, s[28:31], s50 offen offset:2048 sc1 lds
    buffer_load_dwordx4 v1, s[28:31], s50 offen offset:3072 sc1 lds
    s_add_u32 m0, s40, 82944
    s_nop 0
    buffer_load_dwordx4 v1, s[28:31], s51 offen sc1 lds
    s_cmp_lg_u32 s66, 0
    s_cbranch_scc1 adaLN_cond__sliding_block__swiglu_ffn__prompt_kernel_ok_102
    s_waitcnt lgkmcnt(0)
    s_sub_u32 s46, s46, s64
    s_subb_u32 s47, s47, s65
    s_cmp_eq_u64 s[46:47], 16
    s_cbranch_scc1 adaLN_cond__sliding_block__swiglu_ffn__prompt_kernel_ok_102
    s_lshl_b32 s57, s60, 7
    s_add_u32 s57, s57, 804864
    s_waitcnt lgkmcnt(0)
    s_mov_b32 s56, 0
adaLN_cond__sliding_block__swiglu_ffn__prompt_kernel_poll_103:
    s_mov_b64 s[58:59], 0
    s_atomic_add_x2 s[58:59], s[26:27], s57 glc
    s_waitcnt lgkmcnt(0)
    s_sub_u32 s58, s58, s64
    s_subb_u32 s59, s59, s65
    s_cmp_eq_u64 s[58:59], 16
    s_cbranch_scc1 adaLN_cond__sliding_block__swiglu_ffn__prompt_kernel_pdone_104
    s_add_u32 s56, s56, 1
    s_sleep 1
    s_cmp_lt_u32 s56, 0x8000
    s_cbranch_scc1 adaLN_cond__sliding_block__swiglu_ffn__prompt_kernel_poll_103
adaLN_cond__sliding_block__swiglu_ffn__prompt_kernel_pdone_104:
adaLN_cond__sliding_block__swiglu_ffn__prompt_kernel_ok_102:
    s_waitcnt vmcnt(20)
    s_barrier
    s_cmp_lg_u32 s66, 3
    s_cbranch_scc1 adaLN_cond__sliding_block__swiglu_ffn__prompt_kernel_sg_105
    s_lshl_b32 s57, s60, 7
    s_add_u32 s57, s57, 806912
    s_atomic_add_x2 s[10:11], s[26:27], s57
adaLN_cond__sliding_block__swiglu_ffn__prompt_kernel_sg_105:
    s_add_u32 s50, s42, 61440
    s_add_u32 s51, s42, 65536
    s_add_u32 m0, s40, 99328
    s_nop 0
    buffer_load_dwordx4 v1, s[28:31], s50 offen sc1 lds
    buffer_load_dwordx4 v1, s[28:31], s50 offen offset:1024 sc1 lds
    buffer_load_dwordx4 v1, s[28:31], s50 offen offset:2048 sc1 lds
    buffer_load_dwordx4 v1, s[28:31], s50 offen offset:3072 sc1 lds
    s_add_u32 m0, s40, 103424
    s_nop 0
    buffer_load_dwordx4 v1, s[28:31], s51 offen sc1 lds
    s_waitcnt vmcnt(20)
    s_barrier
    s_add_u32 s50, s42, 81920
    s_add_u32 s51, s42, 86016
    s_add_u32 m0, s40, 119808
    s_nop 0
    buffer_load_dwordx4 v1, s[28:31], s50 offen sc1 lds
    buffer_load_dwordx4 v1, s[28:31], s50 offen offset:1024 sc1 lds
    buffer_load_dwordx4 v1, s[28:31], s50 offen offset:2048 sc1 lds
    buffer_load_dwordx4 v1, s[28:31], s50 offen offset:3072 sc1 lds
    s_add_u32 m0, s40, 123904
    s_nop 0
    buffer_load_dwordx4 v1, s[28:31], s51 offen sc1 lds
    s_waitcnt vmcnt(20)
    s_barrier
    s_cmp_lg_u32 s66, 0
    s_cbranch_scc1 adaLN_cond__sliding_block__swiglu_ffn__prompt_kernel_ak_106
    s_lshl_b32 s57, s60, 7
    s_add_u32 s57, s57, 806912
    s_mov_b64 s[46:47], 0
    s_atomic_add_x2 s[46:47], s[26:27], s57 glc
adaLN_cond__sliding_block__swiglu_ffn__prompt_kernel_ak_106:
    s_add_u32 s50, s42, 102400
    s_add_u32 s51, s42, 106496
    s_add_u32 m0, s40, 140288
    s_nop 0
    buffer_load_dwordx4 v1, s[28:31], s50 offen sc1 lds
    buffer_load_dwordx4 v1, s[28:31], s50 offen offset:1024 sc1 lds
    buffer_load_dwordx4 v1, s[28:31], s50 offen offset:2048 sc1 lds
    buffer_load_dwordx4 v1, s[28:31], s50 offen offset:3072 sc1 lds
    s_add_u32 m0, s40, 144384
    s_nop 0
    buffer_load_dwordx4 v1, s[28:31], s51 offen sc1 lds
    s_cmp_lg_u32 s66, 0
    s_cbranch_scc1 adaLN_cond__sliding_block__swiglu_ffn__prompt_kernel_ok_107
    s_waitcnt lgkmcnt(0)
    s_sub_u32 s46, s46, s64
    s_subb_u32 s47, s47, s65
    s_cmp_eq_u64 s[46:47], 16
    s_cbranch_scc1 adaLN_cond__sliding_block__swiglu_ffn__prompt_kernel_ok_107
    s_lshl_b32 s57, s60, 7
    s_add_u32 s57, s57, 806912
    s_waitcnt lgkmcnt(0)
    s_mov_b32 s56, 0
adaLN_cond__sliding_block__swiglu_ffn__prompt_kernel_poll_108:
    s_mov_b64 s[58:59], 0
    s_atomic_add_x2 s[58:59], s[26:27], s57 glc
    s_waitcnt lgkmcnt(0)
    s_sub_u32 s58, s58, s64
    s_subb_u32 s59, s59, s65
    s_cmp_eq_u64 s[58:59], 16
    s_cbranch_scc1 adaLN_cond__sliding_block__swiglu_ffn__prompt_kernel_pdone_109
    s_add_u32 s56, s56, 1
    s_sleep 1
    s_cmp_lt_u32 s56, 0x8000
    s_cbranch_scc1 adaLN_cond__sliding_block__swiglu_ffn__prompt_kernel_poll_108
adaLN_cond__sliding_block__swiglu_ffn__prompt_kernel_pdone_109:
adaLN_cond__sliding_block__swiglu_ffn__prompt_kernel_ok_107:
    s_waitcnt vmcnt(20)
    s_barrier
    s_add_u32 s50, s42, 122880
    s_add_u32 s51, s42, 126976
    s_add_u32 m0, s40, 58368
    s_nop 0
    buffer_load_dwordx4 v1, s[28:31], s50 offen sc1 lds
    buffer_load_dwordx4 v1, s[28:31], s50 offen offset:1024 sc1 lds
    buffer_load_dwordx4 v1, s[28:31], s50 offen offset:2048 sc1 lds
    buffer_load_dwordx4 v1, s[28:31], s50 offen offset:3072 sc1 lds
    s_add_u32 m0, s40, 62464
    s_nop 0
    buffer_load_dwordx4 v1, s[28:31], s51 offen sc1 lds
    s_waitcnt vmcnt(20)
    s_barrier
    s_cmp_lg_u32 s66, 3
    s_cbranch_scc1 adaLN_cond__sliding_block__swiglu_ffn__prompt_kernel_sg_110
    s_lshl_b32 s57, s60, 7
    s_add_u32 s57, s57, 808960
    s_atomic_add_x2 s[10:11], s[26:27], s57
adaLN_cond__sliding_block__swiglu_ffn__prompt_kernel_sg_110:
    s_waitcnt vmcnt(15)
    s_barrier
    s_add_u32 s50, s42, 143360
    s_add_u32 s51, s42, 147456
    s_add_u32 m0, s40, 17408
    s_nop 0
    buffer_load_dwordx4 v1, s[28:31], s50 offen sc1 lds
    buffer_load_dwordx4 v1, s[28:31], s50 offen offset:1024 sc1 lds
    buffer_load_dwordx4 v1, s[28:31], s50 offen offset:2048 sc1 lds
    buffer_load_dwordx4 v1, s[28:31], s50 offen offset:3072 sc1 lds
    s_add_u32 m0, s40, 21504
    s_nop 0
    buffer_load_dwordx4 v1, s[28:31], s51 offen sc1 lds
    s_waitcnt vmcnt(15)
    s_barrier
    s_cmp_lg_u32 s66, 0
    s_cbranch_scc1 adaLN_cond__sliding_block__swiglu_ffn__prompt_kernel_ak_111
    s_lshl_b32 s57, s60, 7
    s_add_u32 s57, s57, 808960
    s_mov_b64 s[46:47], 0
    s_atomic_add_x2 s[46:47], s[26:27], s57 glc
adaLN_cond__sliding_block__swiglu_ffn__prompt_kernel_ak_111:
    s_add_u32 s50, s42, 163840
    s_add_u32 s51, s42, 167936
    s_add_u32 m0, s40, 37888
    s_nop 0
    buffer_load_dwordx4 v1, s[28:31], s50 offen sc1 lds
    buffer_load_dwordx4 v1, s[28:31], s50 offen offset:1024 sc1 lds
    buffer_load_dwordx4 v1, s[28:31], s50 offen offset:2048 sc1 lds
    buffer_load_dwordx4 v1, s[28:31], s50 offen offset:3072 sc1 lds
    s_add_u32 m0, s40, 41984
    s_nop 0
    buffer_load_dwordx4 v1, s[28:31], s51 offen sc1 lds
    s_cmp_lg_u32 s66, 0
    s_cbranch_scc1 adaLN_cond__sliding_block__swiglu_ffn__prompt_kernel_ok_112
    s_waitcnt lgkmcnt(0)
    s_sub_u32 s46, s46, s64
    s_subb_u32 s47, s47, s65
    s_cmp_eq_u64 s[46:47], 16
    s_cbranch_scc1 adaLN_cond__sliding_block__swiglu_ffn__prompt_kernel_ok_112
    s_lshl_b32 s57, s60, 7
    s_add_u32 s57, s57, 808960
    s_waitcnt lgkmcnt(0)
    s_mov_b32 s56, 0
adaLN_cond__sliding_block__swiglu_ffn__prompt_kernel_poll_113:
    s_mov_b64 s[58:59], 0
    s_atomic_add_x2 s[58:59], s[26:27], s57 glc
    s_waitcnt lgkmcnt(0)
    s_sub_u32 s58, s58, s64
    s_subb_u32 s59, s59, s65
    s_cmp_eq_u64 s[58:59], 16
    s_cbranch_scc1 adaLN_cond__sliding_block__swiglu_ffn__prompt_kernel_pdone_114
    s_add_u32 s56, s56, 1
    s_sleep 1
    s_cmp_lt_u32 s56, 0x8000
    s_cbranch_scc1 adaLN_cond__sliding_block__swiglu_ffn__prompt_kernel_poll_113
adaLN_cond__sliding_block__swiglu_ffn__prompt_kernel_pdone_114:
adaLN_cond__sliding_block__swiglu_ffn__prompt_kernel_ok_112:
    s_waitcnt vmcnt(15)
    s_barrier
    s_waitcnt vmcnt(10)
    s_barrier
    s_add_u32 s50, s42, 184320
    s_add_u32 s51, s42, 188416
    s_add_u32 m0, s40, 78848
    s_nop 0
    buffer_load_dwordx4 v1, s[28:31], s50 offen sc1 lds
    buffer_load_dwordx4 v1, s[28:31], s50 offen offset:1024 sc1 lds
    buffer_load_dwordx4 v1, s[28:31], s50 offen offset:2048 sc1 lds
    buffer_load_dwordx4 v1, s[28:31], s50 offen offset:3072 sc1 lds
    s_add_u32 m0, s40, 82944
    s_nop 0
    buffer_load_dwordx4 v1, s[28:31], s51 offen sc1 lds
hop_pad_17:
    s_cbranch_execz hop_back
    s_waitcnt vmcnt(10)
    s_barrier
    s_add_u32 s50, s42, 204800
    s_add_u32 s51, s42, 208896
    s_add_u32 m0, s40, 99328
    s_nop 0
    buffer_load_dwordx4 v1, s[28:31], s50 offen sc1 lds
    buffer_load_dwordx4 v1, s[28:31], s50 offen offset:1024 sc1 lds
    buffer_load_dwordx4 v1, s[28:31], s50 offen offset:2048 sc1 lds
    buffer_load_dwordx4 v1, s[28:31], s50 offen offset:3072 sc1 lds
    s_add_u32 m0, s40, 103424
    s_nop 0
    buffer_load_dwordx4 v1, s[28:31], s51 offen sc1 lds
    s_waitcnt vmcnt(10)
    s_barrier
    s_waitcnt vmcnt(5)
    s_barrier
    s_add_u32 s50, s42, 225280
    s_add_u32 s51, s42, 229376
    s_add_u32 m0, s40, 119808
    s_nop 0
    buffer_load_dwordx4 v1, s[28:31], s50 offen sc1 lds
    buffer_load_dwordx4 v1, s[28:31], s50 offen offset:1024 sc1 lds
    buffer_load_dwordx4 v1, s[28:31], s50 offen offset:2048 sc1 lds
    buffer_load_dwordx4 v1, s[28:31], s50 offen offset:3072 sc1 lds
    s_add_u32 m0, s40, 123904
    s_nop 0
    buffer_load_dwordx4 v1, s[28:31], s51 offen sc1 lds
    s_waitcnt vmcnt(5)
    s_barrier
    s_add_u32 s50, s42, 245760
    s_add_u32 s51, s42, 249856
    s_add_u32 m0, s40, 140288
    s_nop 0
    buffer_load_dwordx4 v1, s[28:31], s50 offen sc1 lds
    buffer_load_dwordx4 v1, s[28:31], s50 offen offset:1024 sc1 lds
    buffer_load_dwordx4 v1, s[28:31], s50 offen offset:2048 sc1 lds
    buffer_load_dwordx4 v1, s[28:31], s50 offen offset:3072 sc1 lds
    s_add_u32 m0, s40, 144384
    s_nop 0
    buffer_load_dwordx4 v1, s[28:31], s51 offen sc1 lds
    s_waitcnt vmcnt(5)
    s_barrier
    s_cmp_ge_u32 s66, 2
    s_cselect_b32 s42, 0x40000000, s42
    s_add_u32 s50, s42, 266240
    s_add_u32 s51, s42, 270336
    s_add_u32 m0, s40, 58368
    s_nop 0
    buffer_load_dwordx4 v1, s[28:31], s50 offen sc1 lds
    buffer_load_dwordx4 v1, s[28:31], s50 offen offset:1024 sc1 lds
    buffer_load_dwordx4 v1, s[28:31], s50 offen offset:2048 sc1 lds
    buffer_load_dwordx4 v1, s[28:31], s50 offen offset:3072 sc1 lds
    s_add_u32 m0, s40, 62464
    s_nop 0
    buffer_load_dwordx4 v1, s[28:31], s51 offen sc1 lds
    s_waitcnt vmcnt(5)
    s_barrier
    s_waitcnt vmcnt(0)
    s_barrier
adaLN_cond__sliding_block__swiglu_ffn__prompt_kernel_end_1:
    s_endpgm
.section .rodata,"a"
.p2align 6
.amdhsa_kernel adaLN_cond__sliding_block__swiglu_ffn__prompt_kernel
  .amdhsa_next_free_vgpr 256
  .amdhsa_next_free_sgpr 102
  .amdhsa_accum_offset 256
  .amdhsa_group_segment_fixed_size 0
  .amdhsa_kernarg_size 96
  .amdhsa_user_sgpr_count 2
  .amdhsa_user_sgpr_kernarg_segment_ptr 1
  .amdhsa_system_sgpr_workgroup_id_x 1
  .amdhsa_float_denorm_mode_32 3
  .amdhsa_float_denorm_mode_16_64 3
.end_amdhsa_kernel
```
